```python
import torch

def _softmax(x, axis=-1):
    return torch.softmax(x, dim=axis)
def _gelu(x):
    return torch.nn.functional.gelu(x, approximate="tanh")
def _silu(x):
    return torch.nn.functional.silu(x)
def _sigmoid(x):
    return torch.sigmoid(x)
def _layernorm(x, axis=-1, eps=1e-5):
    m = x.mean(dim=axis, keepdim=True)
    v = x.var(dim=axis, keepdim=True, unbiased=False)
    return (x - m) / torch.sqrt(v + eps)
def _scatter_add(tgt, idx, src, axis=0):
    return tgt.clone().index_add_(axis, idx, src)
def _segment_sum(src, seg, n):
    out = torch.zeros((n,) + src.shape[1:], dtype=src.dtype)
    return out.index_add_(0, seg, src)
def _pad(x, pw):
    flat = tuple(v for pair in reversed(pw) for v in pair)
    return torch.nn.functional.pad(x, flat)

kernel_name = 'standalone__gqa_block_cached__near_ridge'

def setup_inputs():

    _w = (lambda a: (lambda t: t.to(torch.bfloat16) if t.is_floating_point() else t)(torch.as_tensor(a)))
    B, Sq, D = 16, 96, 576
    Hq, Hkv, Sk, Dh = 32, 16, 512, 128
    assert Hq % Hkv == 0, (Hq, Hkv)
    return {
        "x": _w((lambda *s: torch.randn(*s, dtype=torch.bfloat16) * 0.8)(B, Sq, D)),
        "k_cache": _w((lambda *s: torch.randn(*s, dtype=torch.bfloat16) * 0.8)(B, Hkv, Sk, Dh)),
        "v_cache": _w((lambda *s: torch.randn(*s, dtype=torch.bfloat16) * 0.05)(B, Hkv, Sk, Dh)),
        "wq": _w((lambda *s: torch.randn(*s, dtype=torch.bfloat16) * 0.8)(D, Hq * Dh) * (D ** -0.5)),
        "wo": _w((lambda *s: torch.randn(*s, dtype=torch.bfloat16) * 0.05)(Hq * Dh, D) * ((Hq * Dh) ** -0.5)),
    }

def reference(x, k_cache, v_cache, wq, wo):
    B, Sq, D = x.shape
    Hq, Dh = 32, 128
    Hkv = k_cache.shape[1]
    rep = Hq // Hkv
    q = (lambda x, *d: x.permute(*d))((x @ wq).reshape(B, Sq, Hq, Dh), 0, 2, 1, 3)
    k = (lambda x, n, axis: torch.repeat_interleave(x, n, dim=axis))(k_cache, rep, axis=1)
    v = (lambda x, n, axis: torch.repeat_interleave(x, n, dim=axis))(v_cache, rep, axis=1)
    scores = torch.einsum("bhqd,bhkd->bhqk", q, k) * (Dh ** -0.5)
    p = _softmax(scores, axis=-1)
    o = torch.einsum("bhqk,bhkd->bhqd", p, v)
    return (lambda x, *d: x.permute(*d))(o, 0, 2, 1, 3).reshape(B, Sq, Hq * Dh) @ wo
```

```asm
; @launch grid=(256,1,1) block=(512,1,1) lds=163840
.amdgcn_target "amdgcn-amd-amdhsa--gfx950"
.text
.p2align 12
.globl standalone__gqa_block_cached__near_ridge_kernel
.p2align 8
.type standalone__gqa_block_cached__near_ridge_kernel,@function
standalone__gqa_block_cached__near_ridge_kernel:
s_cmp_ge_u32 s2, 256
s_cbranch_scc1 L_done
s_load_dwordx16 s[4:19], s[0:1], 0
v_lshrrev_b32 v1, 6, v0
v_and_b32 v252, 63, v0
s_and_b32 s58, s2, 1
s_lshl_b32 s58, s58, 3
s_bfe_u32 s55, s2, 0x30003
s_add_u32 s48, s58, s55
v_readfirstlane_b32 s50, v1
s_bfe_u32 s58, s2, 0x20001
s_lshl_b32 s58, s58, 2
s_lshr_b32 s59, s2, 6
s_add_u32 s49, s58, s59
s_lshl_b32 s58, s48, 4
s_add_u32 s58, s58, s49
s_lshl_b32 s64, s58, 17
s_mul_i32 s69, s58, 110592
s_mul_i32 s65, s48, 110592
s_lshl_b32 s66, s49, 9
s_mul_i32 s67, s49, 294912
s_cmp_lt_u32 s50, 4
s_cbranch_scc0 L_loader
s_getpc_b64 s[60:61]
L_pc:
s_sub_u32 s60, s60, L_pc-standalone__gqa_block_cached__near_ridge_kernel
s_subb_u32 s61, s61, 0
s_bfe_u32 s59, s2, 0x10003
s_lshl_b32 s59, s59, 2
s_add_u32 s58, s50, s59
s_lshl_b32 s58, s58, 6
v_add_u32 v253, s58, v252
v_lshlrev_b32 v253, 7, v253
v_min_u32 v253, L_done-standalone__gqa_block_cached__near_ridge_kernel, v253
global_load_dword v196, v253, s[60:61]
s_mov_b64 exec, 0
s_cmp_eq_u32 s50, 0
s_cbranch_scc1 L_t0_0
s_cmp_eq_u32 s50, 1
s_cbranch_scc1 L_t0_1
s_cmp_eq_u32 s50, 2
s_cbranch_scc1 L_t0_2
L_t0_3:
s_call_b64 s[100:101], L_pg4
s_mov_b64 exec, -1
s_branch L_compute
L_t0_0:
s_call_b64 s[100:101], L_pg3
s_mov_b64 exec, -1
s_branch L_compute
L_t0_1:
s_call_b64 s[100:101], L_pg1
s_mov_b64 exec, -1
s_branch L_compute
L_t0_2:
s_mov_b64 exec, -1
s_branch L_compute
L_te0:
L_ret:
s_setpc_b64 s[100:101]
L_loader:
s_sub_u32 s68, s50, 4
v_and_b32 v6, 3, v252
v_bfe_u32 v7, v252, 2, 2
v_lshrrev_b32 v8, 4, v252
s_and_b32 s58, s68, 1
v_xor_b32 v1, s58, v6
v_lshlrev_b32 v1, 4, v1
v_lshl_add_u32 v1, v8, 6, v1
v_lshl_add_u32 v1, v7, 13, v1
s_lshl_b32 s59, s68, 16
v_add_u32 v1, s59, v1
v_and_b32 v9, 1, v8
s_lshl_b32 s59, s58, 1
v_add_u32 v9, s59, v9
v_sub_u32 v9, 0, v9
v_and_b32 v9, 3, v9
v_xor_b32 v9, v9, v6
v_lshlrev_b32 v9, 4, v9
v_lshrrev_b32 v10, 5, v252
v_lshl_add_u32 v9, v10, 6, v9
v_bfe_u32 v11, v252, 2, 3
s_lshl_b32 s59, s68, 3
v_add_u32 v11, s59, v11
s_movk_i32 s63, 1152
v_mad_u32_u24 v2, v11, s63, v9
s_lshl_b32 s70, s68, 10
s_lshl_b32 s71, s68, 12
s_bfe_u32 s60, s2, 0x30003
s_lshr_b32 s59, s2, 6
s_add_u32 s60, s60, s59
s_add_u32 s61, s60, 0
s_mul_i32 s58, s61, 86
s_lshr_b32 s58, s58, 8
s_mul_i32 s58, s58, 3
s_sub_u32 s61, s61, s58
s_lshl_b32 s61, s61, 7
s_add_u32 s61, s61, s65
s_add_u32 s62, s60, 0
s_mul_i32 s58, s62, 86
s_lshr_b32 s58, s58, 8
s_mul_i32 s58, s58, 3
s_sub_u32 s62, s62, s58
s_lshl_b32 s62, s62, 19
s_add_u32 s62, s62, s66
s_waitcnt lgkmcnt(0)
s_mov_b32 s20, s4
s_and_b32 s21, s5, 0xffff
s_mov_b32 s22, 0x1b0000
s_mov_b32 s23, 0x20000
s_mov_b32 s32, s10
s_and_b32 s33, s11, 0xffff
s_mov_b32 s34, 0x480000
s_mov_b32 s35, 0x20000
s_add_u32 m0, s70, 65536
s_nop 0
buffer_load_dwordx4 v2, s[20:23], s61 offen lds
s_add_u32 m0, s70, 69632
s_add_u32 s58, s61, 36864
buffer_load_dwordx4 v2, s[20:23], s58 offen lds
s_add_u32 m0, s70, 73728
s_add_u32 s58, s61, 73728
buffer_load_dwordx4 v2, s[20:23], s58 offen lds
s_add_u32 m0, s71, 0
s_nop 0
buffer_load_dwordx4 v1, s[32:35], s62 offen lds
s_add_u32 m0, s71, 1024
s_add_u32 s58, s62, 256
buffer_load_dwordx4 v1, s[32:35], s58 offen lds
s_add_u32 m0, s71, 2048
s_add_u32 s58, s62, 32768
buffer_load_dwordx4 v1, s[32:35], s58 offen lds
s_add_u32 m0, s71, 3072
s_add_u32 s58, s62, 33024
buffer_load_dwordx4 v1, s[32:35], s58 offen lds
s_add_u32 m0, s71, 16384
s_add_u32 s58, s62, 262144
buffer_load_dwordx4 v1, s[32:35], s58 offen lds
s_add_u32 m0, s71, 17408
s_add_u32 s58, s62, 262400
buffer_load_dwordx4 v1, s[32:35], s58 offen lds
s_add_u32 m0, s71, 18432
s_add_u32 s58, s62, 294912
buffer_load_dwordx4 v1, s[32:35], s58 offen lds
s_add_u32 m0, s71, 19456
s_add_u32 s58, s62, 295168
buffer_load_dwordx4 v1, s[32:35], s58 offen lds
s_add_u32 s61, s60, 1
s_mul_i32 s58, s61, 86
s_lshr_b32 s58, s58, 8
s_mul_i32 s58, s58, 3
s_sub_u32 s61, s61, s58
s_lshl_b32 s61, s61, 7
s_add_u32 s61, s61, s65
s_add_u32 m0, s70, 77824
s_nop 0
buffer_load_dwordx4 v2, s[20:23], s61 offen lds
s_add_u32 m0, s70, 81920
s_add_u32 s58, s61, 36864
buffer_load_dwordx4 v2, s[20:23], s58 offen lds
s_add_u32 m0, s70, 86016
s_add_u32 s58, s61, 73728
buffer_load_dwordx4 v2, s[20:23], s58 offen lds
s_add_u32 s62, s60, 1
s_mul_i32 s58, s62, 86
s_lshr_b32 s58, s58, 8
s_mul_i32 s58, s58, 3
s_sub_u32 s62, s62, s58
s_lshl_b32 s62, s62, 19
s_add_u32 s62, s62, s66
s_add_u32 m0, s71, 32768
s_nop 0
buffer_load_dwordx4 v1, s[32:35], s62 offen lds
s_add_u32 m0, s71, 33792
s_add_u32 s58, s62, 256
buffer_load_dwordx4 v1, s[32:35], s58 offen lds
s_add_u32 m0, s71, 34816
s_add_u32 s58, s62, 32768
buffer_load_dwordx4 v1, s[32:35], s58 offen lds
s_add_u32 m0, s71, 35840
s_add_u32 s58, s62, 33024
buffer_load_dwordx4 v1, s[32:35], s58 offen lds
s_mov_b32 s24, s6
s_and_b32 s25, s7, 0xffff
s_mov_b32 s26, 0x2000000
s_mov_b32 s27, 0x20000
s_mov_b32 s28, s8
s_and_b32 s29, s9, 0xffff
s_mov_b32 s30, 0x2000000
s_mov_b32 s31, 0x20000
s_mov_b32 s36, s12
s_and_b32 s37, s13, 0xffff
s_mov_b32 s38, 0x480000
s_mov_b32 s39, 0x20000
s_mov_b32 s40, s18
s_and_b32 s41, s19, 0xffff
s_mov_b32 s42, 0x10000000
s_mov_b32 s43, 0x20000
s_mov_b32 s44, s14
s_and_b32 s45, s15, 0xffff
s_mov_b32 s46, 0x1b0000
s_mov_b32 s47, 0x20000
s_mov_b32 s96, s16
s_and_b32 s97, s17, 0xffff
s_mov_b32 s98, 0x100
s_mov_b32 s99, 0x20000
s_and_b32 s58, s68, 1
v_and_b32 v9, 1, v8
v_lshlrev_b32 v9, 1, v9
v_xor_b32 v9, v9, v6
v_lshlrev_b32 v9, 4, v9
v_lshl_add_u32 v9, v10, 6, v9
v_mad_u32_u24 v5, v11, s63, v9
s_sub_u32 s59, 0, s68
s_and_b32 s59, s59, 3
v_lshlrev_b32 v9, 8, v7
v_lshl_add_u32 v9, v8, 6, v9
v_add_u32 v9, s70, v9
v_xor_b32 v10, s59, v6
v_lshl_add_u32 v3, v10, 4, v9
s_lshl_b32 s59, s58, 1
v_xor_b32 v10, s59, v6
v_lshl_add_u32 v4, v10, 4, v9
s_lshl_b32 s56, s68, 11
s_add_u32 s56, s56, s64
v_mul_u32_u24 v12, 4608, v8
v_and_b32 v9, 15, v252
v_mul_u32_u24 v10, 12, v9
s_mul_i32 s58, s68, 192
s_add_u32 s58, s58, 384
v_add3_u32 v12, v12, v10, s58
s_mov_b32 s94, 0x05040100
s_mov_b32 s95, 0x07060302
v_lshrrev_b32 v10, 3, v9
v_and_b32 v9, 7, v9
v_lshlrev_b32 v9, 4, v9
v_lshl_add_u32 v9, v10, 10, v9
s_mul_i32 s58, s68, 12
s_add_u32 s58, s58, 24
v_mad_u32_u24 v10, v8, 3, s58
v_lshrrev_b32 v11, 3, v10
v_mul_u32_u24 v11, 12288, v11
v_and_b32 v13, 7, v10
v_lshl_add_u32 v13, v13, 7, v11
v_add_u32 v13, v13, v9
v_add_u32 v10, 1, v10
v_lshrrev_b32 v11, 3, v10
v_mul_u32_u24 v11, 12288, v11
v_and_b32 v14, 7, v10
v_lshl_add_u32 v14, v14, 7, v11
v_add_u32 v14, v14, v9
v_add_u32 v10, 1, v10
v_lshrrev_b32 v11, 3, v10
v_mul_u32_u24 v11, 12288, v11
v_and_b32 v15, 7, v10
v_lshl_add_u32 v15, v15, 7, v11
v_add_u32 v15, v15, v9
s_waitcnt vmcnt(11)
s_barrier
s_add_u32 s61, s60, 2
s_mul_i32 s58, s61, 86
s_lshr_b32 s58, s58, 8
s_mul_i32 s58, s58, 3
s_sub_u32 s61, s61, s58
s_lshl_b32 s61, s61, 7
s_add_u32 s61, s61, s65
s_add_u32 m0, s70, 90112
s_nop 0
buffer_load_dwordx4 v2, s[20:23], s61 offen lds
s_add_u32 m0, s70, 94208
s_add_u32 s58, s61, 36864
buffer_load_dwordx4 v2, s[20:23], s58 offen lds
s_add_u32 m0, s70, 98304
s_add_u32 s58, s61, 73728
buffer_load_dwordx4 v2, s[20:23], s58 offen lds
s_add_u32 m0, s71, 49152
s_add_u32 s58, s62, 262144
buffer_load_dwordx4 v1, s[32:35], s58 offen lds
s_add_u32 m0, s71, 50176
s_add_u32 s58, s62, 262400
buffer_load_dwordx4 v1, s[32:35], s58 offen lds
s_add_u32 m0, s71, 51200
s_add_u32 s58, s62, 294912
buffer_load_dwordx4 v1, s[32:35], s58 offen lds
s_add_u32 m0, s71, 52224
s_add_u32 s58, s62, 295168
buffer_load_dwordx4 v1, s[32:35], s58 offen lds
s_add_u32 s62, s60, 2
s_mul_i32 s58, s62, 86
s_lshr_b32 s58, s58, 8
s_mul_i32 s58, s58, 3
s_sub_u32 s62, s62, s58
s_lshl_b32 s62, s62, 19
s_add_u32 s62, s62, s66
s_add_u32 m0, s71, 106496
s_nop 0
buffer_load_dwordx4 v1, s[32:35], s62 offen lds
s_add_u32 m0, s71, 107520
s_add_u32 s58, s62, 256
buffer_load_dwordx4 v1, s[32:35], s58 offen lds
s_add_u32 m0, s71, 108544
s_add_u32 s58, s62, 32768
buffer_load_dwordx4 v1, s[32:35], s58 offen lds
s_add_u32 m0, s71, 109568
s_add_u32 s58, s62, 33024
buffer_load_dwordx4 v1, s[32:35], s58 offen lds
s_waitcnt vmcnt(18)
s_barrier
s_add_u32 m0, s71, 131072
s_add_u32 s58, s62, 262144
buffer_load_dwordx4 v1, s[32:35], s58 offen lds
s_add_u32 m0, s71, 132096
s_add_u32 s58, s62, 262400
buffer_load_dwordx4 v1, s[32:35], s58 offen lds
s_add_u32 m0, s71, 133120
s_add_u32 s58, s62, 294912
buffer_load_dwordx4 v1, s[32:35], s58 offen lds
s_add_u32 m0, s71, 134144
s_add_u32 s58, s62, 295168
buffer_load_dwordx4 v1, s[32:35], s58 offen lds
s_add_u32 s62, s60, 0
s_mul_i32 s58, s62, 86
s_lshr_b32 s58, s58, 8
s_mul_i32 s58, s58, 3
s_sub_u32 s62, s62, s58
s_lshl_b32 s62, s62, 19
s_add_u32 s62, s62, s66
s_add_u32 s62, s62, 1572864
s_add_u32 m0, s71, 147456
s_nop 0
buffer_load_dwordx4 v1, s[32:35], s62 offen lds
s_add_u32 m0, s71, 148480
s_add_u32 s58, s62, 256
buffer_load_dwordx4 v1, s[32:35], s58 offen lds
s_add_u32 m0, s71, 149504
s_add_u32 s58, s62, 32768
buffer_load_dwordx4 v1, s[32:35], s58 offen lds
s_add_u32 m0, s71, 150528
s_add_u32 s58, s62, 33024
buffer_load_dwordx4 v1, s[32:35], s58 offen lds
s_waitcnt vmcnt(19)
s_barrier
s_add_u32 s61, s60, 0
s_mul_i32 s58, s61, 86
s_lshr_b32 s58, s58, 8
s_mul_i32 s58, s58, 3
s_sub_u32 s61, s61, s58
s_lshl_b32 s61, s61, 7
s_add_u32 s61, s61, s65
s_add_u32 s61, s61, 384
s_add_u32 m0, s70, 65536
s_nop 0
buffer_load_dwordx4 v2, s[20:23], s61 offen lds
s_add_u32 m0, s70, 69632
s_add_u32 s58, s61, 36864
buffer_load_dwordx4 v2, s[20:23], s58 offen lds
s_add_u32 m0, s70, 73728
s_add_u32 s58, s61, 73728
buffer_load_dwordx4 v2, s[20:23], s58 offen lds
s_add_u32 m0, s71, 0
s_add_u32 s58, s62, 262144
buffer_load_dwordx4 v1, s[32:35], s58 offen lds
s_add_u32 m0, s71, 1024
s_add_u32 s58, s62, 262400
buffer_load_dwordx4 v1, s[32:35], s58 offen lds
s_add_u32 m0, s71, 2048
s_add_u32 s58, s62, 294912
buffer_load_dwordx4 v1, s[32:35], s58 offen lds
s_add_u32 m0, s71, 3072
s_add_u32 s58, s62, 295168
buffer_load_dwordx4 v1, s[32:35], s58 offen lds
s_waitcnt vmcnt(19)
s_barrier
s_waitcnt vmcnt(15)
s_barrier
s_add_u32 s61, s60, 1
s_mul_i32 s58, s61, 86
s_lshr_b32 s58, s58, 8
s_mul_i32 s58, s58, 3
s_sub_u32 s61, s61, s58
s_lshl_b32 s61, s61, 7
s_add_u32 s61, s61, s65
s_add_u32 s61, s61, 384
s_add_u32 m0, s70, 77824
s_nop 0
buffer_load_dwordx4 v2, s[20:23], s61 offen lds
s_add_u32 m0, s70, 81920
s_add_u32 s58, s61, 36864
buffer_load_dwordx4 v2, s[20:23], s58 offen lds
s_add_u32 m0, s70, 86016
s_add_u32 s58, s61, 73728
buffer_load_dwordx4 v2, s[20:23], s58 offen lds
s_add_u32 s62, s60, 1
s_mul_i32 s58, s62, 86
s_lshr_b32 s58, s58, 8
s_mul_i32 s58, s58, 3
s_sub_u32 s62, s62, s58
s_lshl_b32 s62, s62, 19
s_add_u32 s62, s62, s66
s_add_u32 s62, s62, 1572864
s_add_u32 m0, s71, 16384
s_nop 0
buffer_load_dwordx4 v1, s[32:35], s62 offen lds
s_add_u32 m0, s71, 17408
s_add_u32 s58, s62, 256
buffer_load_dwordx4 v1, s[32:35], s58 offen lds
s_add_u32 m0, s71, 18432
s_add_u32 s58, s62, 32768
buffer_load_dwordx4 v1, s[32:35], s58 offen lds
s_add_u32 m0, s71, 19456
s_add_u32 s58, s62, 33024
buffer_load_dwordx4 v1, s[32:35], s58 offen lds
s_waitcnt vmcnt(18)
s_barrier
s_add_u32 m0, s71, 32768
s_add_u32 s58, s62, 262144
buffer_load_dwordx4 v1, s[32:35], s58 offen lds
s_add_u32 m0, s71, 33792
s_add_u32 s58, s62, 262400
buffer_load_dwordx4 v1, s[32:35], s58 offen lds
s_add_u32 m0, s71, 34816
s_add_u32 s58, s62, 294912
buffer_load_dwordx4 v1, s[32:35], s58 offen lds
s_add_u32 m0, s71, 35840
s_add_u32 s58, s62, 295168
buffer_load_dwordx4 v1, s[32:35], s58 offen lds
s_add_u32 s62, s60, 2
s_mul_i32 s58, s62, 86
s_lshr_b32 s58, s58, 8
s_mul_i32 s58, s58, 3
s_sub_u32 s62, s62, s58
s_lshl_b32 s62, s62, 19
s_add_u32 s62, s62, s66
s_add_u32 s62, s62, 1572864
s_add_u32 m0, s71, 49152
s_nop 0
buffer_load_dwordx4 v1, s[32:35], s62 offen lds
s_add_u32 m0, s71, 50176
s_add_u32 s58, s62, 256
buffer_load_dwordx4 v1, s[32:35], s58 offen lds
s_add_u32 m0, s71, 51200
s_add_u32 s58, s62, 32768
buffer_load_dwordx4 v1, s[32:35], s58 offen lds
s_add_u32 m0, s71, 52224
s_add_u32 s58, s62, 33024
buffer_load_dwordx4 v1, s[32:35], s58 offen lds
s_waitcnt vmcnt(19)
s_barrier
s_add_u32 s61, s60, 2
s_mul_i32 s58, s61, 86
s_lshr_b32 s58, s58, 8
s_mul_i32 s58, s58, 3
s_sub_u32 s61, s61, s58
s_lshl_b32 s61, s61, 7
s_add_u32 s61, s61, s65
s_add_u32 s61, s61, 384
s_add_u32 m0, s70, 90112
s_nop 0
buffer_load_dwordx4 v2, s[20:23], s61 offen lds
s_add_u32 m0, s70, 94208
s_add_u32 s58, s61, 36864
buffer_load_dwordx4 v2, s[20:23], s58 offen lds
s_add_u32 m0, s70, 98304
s_add_u32 s58, s61, 73728
buffer_load_dwordx4 v2, s[20:23], s58 offen lds
s_add_u32 m0, s71, 106496
s_add_u32 s58, s62, 262144
buffer_load_dwordx4 v1, s[32:35], s58 offen lds
s_add_u32 m0, s71, 107520
s_add_u32 s58, s62, 262400
buffer_load_dwordx4 v1, s[32:35], s58 offen lds
s_add_u32 m0, s71, 108544
s_add_u32 s58, s62, 294912
buffer_load_dwordx4 v1, s[32:35], s58 offen lds
s_add_u32 m0, s71, 109568
s_add_u32 s58, s62, 295168
buffer_load_dwordx4 v1, s[32:35], s58 offen lds
s_waitcnt vmcnt(22)
s_barrier
s_add_u32 s62, s60, 0
s_mul_i32 s58, s62, 86
s_lshr_b32 s58, s58, 8
s_mul_i32 s58, s58, 3
s_sub_u32 s62, s62, s58
s_lshl_b32 s62, s62, 19
s_add_u32 s62, s62, s66
s_add_u32 s62, s62, 3145728
s_add_u32 m0, s71, 131072
s_nop 0
buffer_load_dwordx4 v1, s[32:35], s62 offen lds
s_add_u32 m0, s71, 132096
s_add_u32 s58, s62, 256
buffer_load_dwordx4 v1, s[32:35], s58 offen lds
s_add_u32 m0, s71, 133120
s_add_u32 s58, s62, 32768
buffer_load_dwordx4 v1, s[32:35], s58 offen lds
s_add_u32 m0, s71, 134144
s_add_u32 s58, s62, 33024
buffer_load_dwordx4 v1, s[32:35], s58 offen lds
s_waitcnt vmcnt(19)
s_barrier
s_add_u32 s61, s60, 0
s_mul_i32 s58, s61, 86
s_lshr_b32 s58, s58, 8
s_mul_i32 s58, s58, 3
s_sub_u32 s61, s61, s58
s_lshl_b32 s61, s61, 7
s_add_u32 s61, s61, s65
s_add_u32 s61, s61, 768
s_add_u32 m0, s70, 65536
s_nop 0
buffer_load_dwordx4 v2, s[20:23], s61 offen lds
s_add_u32 m0, s70, 69632
s_add_u32 s58, s61, 36864
buffer_load_dwordx4 v2, s[20:23], s58 offen lds
s_add_u32 m0, s70, 73728
s_add_u32 s58, s61, 73728
buffer_load_dwordx4 v2, s[20:23], s58 offen lds
s_add_u32 m0, s71, 147456
s_add_u32 s58, s62, 262144
buffer_load_dwordx4 v1, s[32:35], s58 offen lds
s_add_u32 m0, s71, 148480
s_add_u32 s58, s62, 262400
buffer_load_dwordx4 v1, s[32:35], s58 offen lds
s_add_u32 m0, s71, 149504
s_add_u32 s58, s62, 294912
buffer_load_dwordx4 v1, s[32:35], s58 offen lds
s_add_u32 m0, s71, 150528
s_add_u32 s58, s62, 295168
buffer_load_dwordx4 v1, s[32:35], s58 offen lds
s_waitcnt vmcnt(22)
s_barrier
s_waitcnt vmcnt(15)
s_barrier
s_add_u32 s61, s60, 1
s_mul_i32 s58, s61, 86
s_lshr_b32 s58, s58, 8
s_mul_i32 s58, s58, 3
s_sub_u32 s61, s61, s58
s_lshl_b32 s61, s61, 7
s_add_u32 s61, s61, s65
s_add_u32 s61, s61, 768
s_add_u32 m0, s70, 77824
s_nop 0
buffer_load_dwordx4 v2, s[20:23], s61 offen lds
s_add_u32 m0, s70, 81920
s_add_u32 s58, s61, 36864
buffer_load_dwordx4 v2, s[20:23], s58 offen lds
s_add_u32 m0, s70, 86016
s_add_u32 s58, s61, 73728
buffer_load_dwordx4 v2, s[20:23], s58 offen lds
s_add_u32 s62, s60, 1
s_mul_i32 s58, s62, 86
s_lshr_b32 s58, s58, 8
s_mul_i32 s58, s58, 3
s_sub_u32 s62, s62, s58
s_lshl_b32 s62, s62, 19
s_add_u32 s62, s62, s66
s_add_u32 s62, s62, 3145728
s_add_u32 m0, s71, 0
s_nop 0
buffer_load_dwordx4 v1, s[32:35], s62 offen lds
s_add_u32 m0, s71, 1024
s_add_u32 s58, s62, 256
buffer_load_dwordx4 v1, s[32:35], s58 offen lds
s_add_u32 m0, s71, 2048
s_add_u32 s58, s62, 32768
buffer_load_dwordx4 v1, s[32:35], s58 offen lds
s_add_u32 m0, s71, 3072
s_add_u32 s58, s62, 33024
buffer_load_dwordx4 v1, s[32:35], s58 offen lds
s_waitcnt vmcnt(18)
s_barrier
s_add_u32 m0, s71, 16384
s_add_u32 s58, s62, 262144
buffer_load_dwordx4 v1, s[32:35], s58 offen lds
s_add_u32 m0, s71, 17408
s_add_u32 s58, s62, 262400
buffer_load_dwordx4 v1, s[32:35], s58 offen lds
s_add_u32 m0, s71, 18432
s_add_u32 s58, s62, 294912
buffer_load_dwordx4 v1, s[32:35], s58 offen lds
s_add_u32 m0, s71, 19456
s_add_u32 s58, s62, 295168
buffer_load_dwordx4 v1, s[32:35], s58 offen lds
s_add_u32 s62, s60, 2
s_mul_i32 s58, s62, 86
s_lshr_b32 s58, s58, 8
s_mul_i32 s58, s58, 3
s_sub_u32 s62, s62, s58
s_lshl_b32 s62, s62, 19
s_add_u32 s62, s62, s66
s_add_u32 s62, s62, 3145728
s_add_u32 m0, s71, 32768
s_nop 0
buffer_load_dwordx4 v1, s[32:35], s62 offen lds
s_add_u32 m0, s71, 33792
s_add_u32 s58, s62, 256
buffer_load_dwordx4 v1, s[32:35], s58 offen lds
s_add_u32 m0, s71, 34816
s_add_u32 s58, s62, 32768
buffer_load_dwordx4 v1, s[32:35], s58 offen lds
s_add_u32 m0, s71, 35840
s_add_u32 s58, s62, 33024
buffer_load_dwordx4 v1, s[32:35], s58 offen lds
s_waitcnt vmcnt(19)
s_barrier
s_add_u32 s61, s60, 2
s_mul_i32 s58, s61, 86
s_lshr_b32 s58, s58, 8
s_mul_i32 s58, s58, 3
s_sub_u32 s61, s61, s58
s_lshl_b32 s61, s61, 7
s_add_u32 s61, s61, s65
s_add_u32 s61, s61, 768
s_add_u32 m0, s70, 90112
s_nop 0
buffer_load_dwordx4 v2, s[20:23], s61 offen lds
s_add_u32 m0, s70, 94208
s_add_u32 s58, s61, 36864
buffer_load_dwordx4 v2, s[20:23], s58 offen lds
s_add_u32 m0, s70, 98304
s_add_u32 s58, s61, 73728
buffer_load_dwordx4 v2, s[20:23], s58 offen lds
s_add_u32 m0, s71, 49152
s_add_u32 s58, s62, 262144
buffer_load_dwordx4 v1, s[32:35], s58 offen lds
s_add_u32 m0, s71, 50176
s_add_u32 s58, s62, 262400
buffer_load_dwordx4 v1, s[32:35], s58 offen lds
s_add_u32 m0, s71, 51200
s_add_u32 s58, s62, 294912
buffer_load_dwordx4 v1, s[32:35], s58 offen lds
s_add_u32 m0, s71, 52224
s_add_u32 s58, s62, 295168
buffer_load_dwordx4 v1, s[32:35], s58 offen lds
s_waitcnt vmcnt(22)
s_barrier
s_add_u32 m0, s70, 106496
s_nop 0
buffer_load_dwordx4 v3, s[24:27], s64 offen nt lds
s_add_u32 m0, s70, 110592
s_add_u32 s58, s64, 4096
buffer_load_dwordx4 v3, s[24:27], s58 offen nt lds
s_add_u32 m0, s70, 122880
s_add_u32 s58, s64, 8192
buffer_load_dwordx4 v3, s[24:27], s58 offen nt lds
s_add_u32 m0, s70, 126976
s_add_u32 s58, s64, 12288
buffer_load_dwordx4 v3, s[24:27], s58 offen nt lds
s_waitcnt vmcnt(19)
s_barrier
s_add_u32 m0, s70, 139264
L_pg1:
s_cbranch_execz L_ret
s_add_u32 s58, s64, 16384
buffer_load_dwordx4 v3, s[24:27], s58 offen nt lds
s_add_u32 m0, s70, 143360
s_add_u32 s58, s64, 20480
buffer_load_dwordx4 v3, s[24:27], s58 offen nt lds
s_add_u32 m0, s70, 131072
s_nop 0
buffer_load_dwordx4 v4, s[28:31], s64 offen nt lds
s_add_u32 m0, s70, 135168
s_add_u32 s58, s64, 4096
buffer_load_dwordx4 v4, s[28:31], s58 offen nt lds
s_waitcnt vmcnt(19)
s_barrier
s_add_u32 m0, s70, 155648
s_add_u32 s58, s64, 24576
buffer_load_dwordx4 v3, s[24:27], s58 offen nt lds
s_add_u32 m0, s70, 159744
s_add_u32 s58, s64, 28672
buffer_load_dwordx4 v3, s[24:27], s58 offen nt lds
s_add_u32 m0, s70, 147456
s_add_u32 s58, s64, 8192
buffer_load_dwordx4 v4, s[28:31], s58 offen nt lds
s_add_u32 m0, s70, 151552
s_add_u32 s58, s64, 12288
buffer_load_dwordx4 v4, s[28:31], s58 offen nt lds
s_waitcnt vmcnt(16)
s_barrier
s_add_u32 m0, s70, 73728
s_add_u32 s58, s64, 32768
buffer_load_dwordx4 v3, s[24:27], s58 offen nt lds
s_add_u32 m0, s70, 77824
s_add_u32 s58, s64, 36864
buffer_load_dwordx4 v3, s[24:27], s58 offen nt lds
s_add_u32 m0, s70, 65536
s_add_u32 s58, s64, 16384
buffer_load_dwordx4 v4, s[28:31], s58 offen nt lds
s_add_u32 m0, s70, 69632
s_add_u32 s58, s64, 20480
buffer_load_dwordx4 v4, s[28:31], s58 offen nt lds
s_waitcnt vmcnt(16)
s_barrier
s_barrier
s_add_u32 m0, s70, 90112
s_add_u32 s58, s64, 40960
buffer_load_dwordx4 v3, s[24:27], s58 offen nt lds
s_add_u32 m0, s70, 94208
s_add_u32 s58, s64, 45056
buffer_load_dwordx4 v3, s[24:27], s58 offen nt lds
s_add_u32 m0, s70, 81920
s_add_u32 s58, s64, 24576
buffer_load_dwordx4 v4, s[28:31], s58 offen nt lds
s_add_u32 m0, s70, 86016
s_add_u32 s58, s64, 28672
buffer_load_dwordx4 v4, s[28:31], s58 offen nt lds
s_waitcnt vmcnt(18)
s_barrier
s_waitcnt vmcnt(16)
s_barrier
s_add_u32 s53, s67, 0
buffer_load_dwordx3 v[60:62], v12, s[36:39], s53 offen offset:0
buffer_load_dwordx3 v[64:66], v12, s[36:39], s53 offen offset:1152
buffer_load_dwordx3 v[68:70], v12, s[36:39], s53 offen offset:2304
buffer_load_dwordx3 v[72:74], v12, s[36:39], s53 offen offset:3456
s_add_u32 s53, s67, 18432
buffer_load_dwordx3 v[76:78], v12, s[36:39], s53 offen offset:0
s_waitcnt vmcnt(17)
s_barrier
s_add_u32 m0, s70, 106496
s_add_u32 s58, s64, 49152
buffer_load_dwordx4 v3, s[24:27], s58 offen nt lds
s_add_u32 m0, s70, 110592
s_add_u32 s58, s64, 53248
buffer_load_dwordx4 v3, s[24:27], s58 offen nt lds
s_add_u32 m0, s70, 98304
s_add_u32 s58, s64, 32768
buffer_load_dwordx4 v4, s[28:31], s58 offen nt lds
buffer_load_dwordx3 v[80:82], v12, s[36:39], s53 offen offset:1152
buffer_load_dwordx3 v[84:86], v12, s[36:39], s53 offen offset:2304
buffer_load_dwordx3 v[88:90], v12, s[36:39], s53 offen offset:3456
s_add_u32 s53, s67, 36864
buffer_load_dwordx3 v[92:94], v12, s[36:39], s53 offen offset:0
buffer_load_dwordx3 v[96:98], v12, s[36:39], s53 offen offset:1152
s_waitcnt vmcnt(21)
s_barrier
s_add_u32 m0, s70, 102400
s_add_u32 s58, s64, 36864
buffer_load_dwordx4 v4, s[28:31], s58 offen nt lds
s_add_u32 m0, s70, 122880
s_add_u32 s58, s64, 57344
buffer_load_dwordx4 v3, s[24:27], s58 offen nt lds
s_add_u32 m0, s70, 126976
s_add_u32 s58, s64, 61440
buffer_load_dwordx4 v3, s[24:27], s58 offen nt lds
buffer_load_dwordx3 v[100:102], v12, s[36:39], s53 offen offset:2304
buffer_load_dwordx3 v[104:106], v12, s[36:39], s53 offen offset:3456
s_add_u32 s53, s67, 55296
buffer_load_dwordx3 v[108:110], v12, s[36:39], s53 offen offset:0
buffer_load_dwordx3 v[112:114], v12, s[36:39], s53 offen offset:1152
buffer_load_dwordx3 v[116:118], v12, s[36:39], s53 offen offset:2304
buffer_load_dwordx3 v[120:122], v12, s[36:39], s53 offen offset:3456
s_waitcnt vmcnt(26)
s_barrier
s_add_u32 m0, s70, 114688
s_add_u32 s58, s64, 40960
buffer_load_dwordx4 v4, s[28:31], s58 offen nt lds
s_add_u32 m0, s70, 118784
s_add_u32 s58, s64, 45056
buffer_load_dwordx4 v4, s[28:31], s58 offen nt lds
s_add_u32 m0, s70, 139264
s_add_u32 s58, s64, 65536
buffer_load_dwordx4 v3, s[24:27], s58 offen nt lds
s_add_u32 m0, s70, 143360
s_add_u32 s58, s64, 69632
buffer_load_dwordx4 v3, s[24:27], s58 offen nt lds
s_add_u32 s53, s67, 73728
buffer_load_dwordx3 v[124:126], v12, s[36:39], s53 offen offset:0
buffer_load_dwordx3 v[128:130], v12, s[36:39], s53 offen offset:1152
buffer_load_dwordx3 v[132:134], v12, s[36:39], s53 offen offset:2304
buffer_load_dwordx3 v[136:138], v12, s[36:39], s53 offen offset:3456
s_waitcnt vmcnt(19)
v_perm_b32 v16, v64, v60, s94
v_perm_b32 v20, v64, v60, s95
v_perm_b32 v24, v65, v61, s94
v_perm_b32 v28, v65, v61, s95
v_perm_b32 v32, v66, v62, s94
v_perm_b32 v36, v66, v62, s95
v_perm_b32 v17, v72, v68, s94
v_perm_b32 v21, v72, v68, s95
v_perm_b32 v25, v73, v69, s94
v_perm_b32 v29, v73, v69, s95
v_perm_b32 v33, v74, v70, s94
v_perm_b32 v37, v74, v70, s95
v_perm_b32 v18, v80, v76, s94
v_perm_b32 v22, v80, v76, s95
v_perm_b32 v26, v81, v77, s94
v_perm_b32 v30, v81, v77, s95
v_perm_b32 v34, v82, v78, s94
v_perm_b32 v38, v82, v78, s95
v_perm_b32 v19, v88, v84, s94
v_perm_b32 v23, v88, v84, s95
v_perm_b32 v27, v89, v85, s94
v_perm_b32 v31, v89, v85, s95
v_perm_b32 v35, v90, v86, s94
v_perm_b32 v39, v90, v86, s95
s_barrier
s_add_u32 m0, s70, 131072
s_add_u32 s58, s64, 49152
buffer_load_dwordx4 v4, s[28:31], s58 offen nt lds
s_add_u32 m0, s70, 135168
s_add_u32 s58, s64, 53248
buffer_load_dwordx4 v4, s[28:31], s58 offen nt lds
s_add_u32 m0, s70, 155648
s_add_u32 s58, s64, 73728
buffer_load_dwordx4 v3, s[24:27], s58 offen nt lds
s_add_u32 s53, s67, 92160
buffer_load_dwordx3 v[140:142], v12, s[36:39], s53 offen offset:0
buffer_load_dwordx3 v[144:146], v12, s[36:39], s53 offen offset:1152
buffer_load_dwordx3 v[148:150], v12, s[36:39], s53 offen offset:2304
buffer_load_dwordx3 v[152:154], v12, s[36:39], s53 offen offset:3456
s_add_u32 s53, s67, 110592
buffer_load_dwordx3 v[156:158], v12, s[36:39], s53 offen offset:0
s_waitcnt vmcnt(16)
v_perm_b32 v40, v96, v92, s94
v_perm_b32 v44, v96, v92, s95
v_perm_b32 v48, v97, v93, s94
v_perm_b32 v52, v97, v93, s95
v_perm_b32 v56, v98, v94, s94
v_perm_b32 v60, v98, v94, s95
v_perm_b32 v41, v104, v100, s94
v_perm_b32 v45, v104, v100, s95
v_perm_b32 v49, v105, v101, s94
v_perm_b32 v53, v105, v101, s95
v_perm_b32 v57, v106, v102, s94
v_perm_b32 v61, v106, v102, s95
v_perm_b32 v42, v112, v108, s94
v_perm_b32 v46, v112, v108, s95
v_perm_b32 v50, v113, v109, s94
v_perm_b32 v54, v113, v109, s95
v_perm_b32 v58, v114, v110, s94
v_perm_b32 v62, v114, v110, s95
v_perm_b32 v43, v120, v116, s94
v_perm_b32 v47, v120, v116, s95
v_perm_b32 v51, v121, v117, s94
v_perm_b32 v55, v121, v117, s95
v_perm_b32 v59, v122, v118, s94
v_perm_b32 v63, v122, v118, s95
s_barrier
s_add_u32 m0, s70, 159744
s_add_u32 s58, s64, 77824
buffer_load_dwordx4 v3, s[24:27], s58 offen nt lds
s_add_u32 m0, s70, 147456
s_add_u32 s58, s64, 57344
buffer_load_dwordx4 v4, s[28:31], s58 offen nt lds
s_add_u32 m0, s70, 151552
s_add_u32 s58, s64, 61440
buffer_load_dwordx4 v4, s[28:31], s58 offen nt lds
buffer_load_dwordx3 v[160:162], v12, s[36:39], s53 offen offset:1152
buffer_load_dwordx3 v[164:166], v12, s[36:39], s53 offen offset:2304
buffer_load_dwordx3 v[168:170], v12, s[36:39], s53 offen offset:3456
s_add_u32 s53, s67, 129024
buffer_load_dwordx3 v[172:174], v12, s[36:39], s53 offen offset:0
buffer_load_dwordx3 v[176:178], v12, s[36:39], s53 offen offset:1152
buffer_load_dwordx3 v[180:182], v12, s[36:39], s53 offen offset:2304
s_waitcnt vmcnt(23)
s_barrier
s_add_u32 m0, s70, 73728
s_add_u32 s58, s64, 81920
buffer_load_dwordx4 v3, s[24:27], s58 offen nt lds
s_add_u32 m0, s70, 77824
s_add_u32 s58, s64, 86016
buffer_load_dwordx4 v3, s[24:27], s58 offen nt lds
s_add_u32 m0, s70, 65536
s_add_u32 s58, s64, 65536
buffer_load_dwordx4 v4, s[28:31], s58 offen nt lds
s_add_u32 m0, s70, 69632
s_add_u32 s58, s64, 69632
buffer_load_dwordx4 v4, s[28:31], s58 offen nt lds
buffer_load_dwordx3 v[184:186], v12, s[36:39], s53 offen offset:3456
s_add_u32 s53, s67, 147456
buffer_load_dwordx3 v[188:190], v12, s[36:39], s53 offen offset:0
buffer_load_dwordx3 v[192:194], v12, s[36:39], s53 offen offset:1152
buffer_load_dwordx3 v[196:198], v12, s[36:39], s53 offen offset:2304
s_waitcnt vmcnt(18)
v_perm_b32 v64, v128, v124, s94
v_perm_b32 v68, v128, v124, s95
v_perm_b32 v72, v129, v125, s94
v_perm_b32 v76, v129, v125, s95
v_perm_b32 v80, v130, v126, s94
v_perm_b32 v84, v130, v126, s95
v_perm_b32 v65, v136, v132, s94
v_perm_b32 v69, v136, v132, s95
v_perm_b32 v73, v137, v133, s94
v_perm_b32 v77, v137, v133, s95
v_perm_b32 v81, v138, v134, s94
v_perm_b32 v85, v138, v134, s95
v_perm_b32 v66, v144, v140, s94
v_perm_b32 v70, v144, v140, s95
v_perm_b32 v74, v145, v141, s94
v_perm_b32 v78, v145, v141, s95
v_perm_b32 v82, v146, v142, s94
v_perm_b32 v86, v146, v142, s95
v_perm_b32 v67, v152, v148, s94
v_perm_b32 v71, v152, v148, s95
v_perm_b32 v75, v153, v149, s94
v_perm_b32 v79, v153, v149, s95
v_perm_b32 v83, v154, v150, s94
v_perm_b32 v87, v154, v150, s95
s_barrier
s_add_u32 m0, s70, 90112
s_add_u32 s58, s64, 90112
buffer_load_dwordx4 v3, s[24:27], s58 offen nt lds
s_add_u32 m0, s70, 94208
s_add_u32 s58, s64, 94208
buffer_load_dwordx4 v3, s[24:27], s58 offen nt lds
s_add_u32 m0, s70, 81920
s_add_u32 s58, s64, 73728
buffer_load_dwordx4 v4, s[28:31], s58 offen nt lds
buffer_load_dwordx3 v[200:202], v12, s[36:39], s53 offen offset:3456
s_add_u32 s53, s67, 165888
buffer_load_dwordx3 v[204:206], v12, s[36:39], s53 offen offset:0
buffer_load_dwordx3 v[208:210], v12, s[36:39], s53 offen offset:1152
buffer_load_dwordx3 v[212:214], v12, s[36:39], s53 offen offset:2304
buffer_load_dwordx3 v[216:218], v12, s[36:39], s53 offen offset:3456
s_waitcnt vmcnt(22)
s_barrier
s_add_u32 m0, s70, 86016
s_add_u32 s58, s64, 77824
buffer_load_dwordx4 v4, s[28:31], s58 offen nt lds
s_add_u32 m0, s70, 106496
s_add_u32 s58, s64, 98304
buffer_load_dwordx4 v3, s[24:27], s58 offen nt lds
s_add_u32 m0, s70, 110592
s_add_u32 s58, s64, 102400
buffer_load_dwordx4 v3, s[24:27], s58 offen nt lds
s_add_u32 s53, s67, 184320
buffer_load_dwordx3 v[220:222], v12, s[36:39], s53 offen offset:0
buffer_load_dwordx3 v[224:226], v12, s[36:39], s53 offen offset:1152
buffer_load_dwordx3 v[228:230], v12, s[36:39], s53 offen offset:2304
buffer_load_dwordx3 v[232:234], v12, s[36:39], s53 offen offset:3456
s_add_u32 s53, s67, 202752
buffer_load_dwordx3 v[236:238], v12, s[36:39], s53 offen offset:0
buffer_load_dwordx3 v[240:242], v12, s[36:39], s53 offen offset:1152
s_waitcnt vmcnt(20)
v_perm_b32 v88, v160, v156, s94
v_perm_b32 v92, v160, v156, s95
v_perm_b32 v96, v161, v157, s94
v_perm_b32 v100, v161, v157, s95
v_perm_b32 v104, v162, v158, s94
v_perm_b32 v108, v162, v158, s95
v_perm_b32 v89, v168, v164, s94
v_perm_b32 v93, v168, v164, s95
v_perm_b32 v97, v169, v165, s94
v_perm_b32 v101, v169, v165, s95
v_perm_b32 v105, v170, v166, s94
v_perm_b32 v109, v170, v166, s95
v_perm_b32 v90, v176, v172, s94
v_perm_b32 v94, v176, v172, s95
v_perm_b32 v98, v177, v173, s94
v_perm_b32 v102, v177, v173, s95
v_perm_b32 v106, v178, v174, s94
v_perm_b32 v110, v178, v174, s95
v_perm_b32 v91, v184, v180, s94
v_perm_b32 v95, v184, v180, s95
v_perm_b32 v99, v185, v181, s94
v_perm_b32 v103, v185, v181, s95
v_perm_b32 v107, v186, v182, s94
v_perm_b32 v111, v186, v182, s95
s_barrier
s_add_u32 m0, s70, 98304
s_add_u32 s58, s64, 81920
buffer_load_dwordx4 v4, s[28:31], s58 offen nt lds
s_add_u32 m0, s70, 102400
s_add_u32 s58, s64, 86016
buffer_load_dwordx4 v4, s[28:31], s58 offen nt lds
s_add_u32 m0, s70, 122880
s_add_u32 s58, s64, 106496
buffer_load_dwordx4 v3, s[24:27], s58 offen nt lds
s_add_u32 m0, s70, 126976
s_add_u32 s58, s64, 110592
buffer_load_dwordx4 v3, s[24:27], s58 offen nt lds
buffer_load_dwordx3 v[244:246], v12, s[36:39], s53 offen offset:2304
buffer_load_dwordx3 v[248:250], v12, s[36:39], s53 offen offset:3456
s_add_u32 m0, s70, 0
s_nop 0
buffer_load_dwordx4 v5, s[36:39], s67 offen lds
s_add_u32 m0, s70, 4096
s_add_u32 s58, s67, 36864
buffer_load_dwordx4 v5, s[36:39], s58 offen lds
s_waitcnt vmcnt(17)
v_perm_b32 v112, v192, v188, s94
v_perm_b32 v116, v192, v188, s95
v_perm_b32 v120, v193, v189, s94
v_perm_b32 v124, v193, v189, s95
v_perm_b32 v128, v194, v190, s94
v_perm_b32 v132, v194, v190, s95
v_perm_b32 v113, v200, v196, s94
v_perm_b32 v117, v200, v196, s95
v_perm_b32 v121, v201, v197, s94
v_perm_b32 v125, v201, v197, s95
v_perm_b32 v129, v202, v198, s94
v_perm_b32 v133, v202, v198, s95
v_perm_b32 v114, v208, v204, s94
v_perm_b32 v118, v208, v204, s95
v_perm_b32 v122, v209, v205, s94
v_perm_b32 v126, v209, v205, s95
v_perm_b32 v130, v210, v206, s94
v_perm_b32 v134, v210, v206, s95
v_perm_b32 v115, v216, v212, s94
v_perm_b32 v119, v216, v212, s95
v_perm_b32 v123, v217, v213, s94
v_perm_b32 v127, v217, v213, s95
v_perm_b32 v131, v218, v214, s94
v_perm_b32 v135, v218, v214, s95
s_waitcnt vmcnt(16)
s_barrier
s_add_u32 m0, s70, 114688
s_add_u32 s58, s64, 90112
buffer_load_dwordx4 v4, s[28:31], s58 offen nt lds
s_add_u32 m0, s70, 118784
s_add_u32 s58, s64, 94208
buffer_load_dwordx4 v4, s[28:31], s58 offen nt lds
s_add_u32 m0, s70, 139264
s_add_u32 s58, s64, 114688
buffer_load_dwordx4 v3, s[24:27], s58 offen nt lds
s_add_u32 m0, s70, 8192
s_add_u32 s58, s67, 73728
buffer_load_dwordx4 v5, s[36:39], s58 offen lds
s_add_u32 m0, s70, 12288
s_add_u32 s58, s67, 110592
buffer_load_dwordx4 v5, s[36:39], s58 offen lds
s_add_u32 m0, s70, 16384
s_add_u32 s58, s67, 147456
buffer_load_dwordx4 v5, s[36:39], s58 offen lds
s_add_u32 m0, s70, 20480
s_add_u32 s58, s67, 184320
buffer_load_dwordx4 v5, s[36:39], s58 offen lds
s_add_u32 m0, s70, 24576
s_add_u32 s58, s67, 221184
buffer_load_dwordx4 v5, s[36:39], s58 offen lds
s_waitcnt vmcnt(14)
s_barrier
s_add_u32 m0, s70, 143360
s_add_u32 s58, s64, 118784
buffer_load_dwordx4 v3, s[24:27], s58 offen nt lds
s_add_u32 m0, s70, 131072
s_add_u32 s58, s64, 98304
buffer_load_dwordx4 v4, s[28:31], s58 offen nt lds
s_add_u32 m0, s70, 135168
s_add_u32 s58, s64, 102400
buffer_load_dwordx4 v4, s[28:31], s58 offen nt lds
s_add_u32 m0, s70, 28672
s_add_u32 s58, s67, 258048
buffer_load_dwordx4 v5, s[36:39], s58 offen lds
s_add_u32 m0, s70, 32768
s_add_u32 s58, s67, 128
buffer_load_dwordx4 v5, s[36:39], s58 offen lds
s_add_u32 m0, s70, 36864
s_add_u32 s58, s67, 36992
buffer_load_dwordx4 v5, s[36:39], s58 offen lds
s_add_u32 m0, s70, 40960
s_add_u32 s58, s67, 73856
buffer_load_dwordx4 v5, s[36:39], s58 offen lds
s_add_u32 m0, s70, 45056
s_add_u32 s58, s67, 110720
buffer_load_dwordx4 v5, s[36:39], s58 offen lds
s_add_u32 m0, s70, 49152
s_add_u32 s58, s67, 147584
buffer_load_dwordx4 v5, s[36:39], s58 offen lds
s_waitcnt vmcnt(19)
v_perm_b32 v136, v224, v220, s94
v_perm_b32 v140, v224, v220, s95
v_perm_b32 v144, v225, v221, s94
v_perm_b32 v148, v225, v221, s95
v_perm_b32 v152, v226, v222, s94
v_perm_b32 v156, v226, v222, s95
v_perm_b32 v137, v232, v228, s94
v_perm_b32 v141, v232, v228, s95
v_perm_b32 v145, v233, v229, s94
v_perm_b32 v149, v233, v229, s95
v_perm_b32 v153, v234, v230, s94
v_perm_b32 v157, v234, v230, s95
v_perm_b32 v138, v240, v236, s94
v_perm_b32 v142, v240, v236, s95
v_perm_b32 v146, v241, v237, s94
v_perm_b32 v150, v241, v237, s95
v_perm_b32 v154, v242, v238, s94
v_perm_b32 v158, v242, v238, s95
v_perm_b32 v139, v248, v244, s94
v_perm_b32 v143, v248, v244, s95
v_perm_b32 v147, v249, v245, s94
v_perm_b32 v151, v249, v245, s95
v_perm_b32 v155, v250, v246, s94
v_perm_b32 v159, v250, v246, s95
s_waitcnt vmcnt(15)
s_barrier
s_add_u32 m0, s70, 155648
s_add_u32 s58, s64, 122880
buffer_load_dwordx4 v3, s[24:27], s58 offen nt lds
s_add_u32 m0, s70, 159744
s_add_u32 s58, s64, 126976
buffer_load_dwordx4 v3, s[24:27], s58 offen nt lds
s_add_u32 m0, s70, 147456
s_add_u32 s58, s64, 106496
buffer_load_dwordx4 v4, s[28:31], s58 offen nt lds
s_add_u32 m0, s70, 151552
s_add_u32 s58, s64, 110592
buffer_load_dwordx4 v4, s[28:31], s58 offen nt lds
s_add_u32 m0, s70, 53248
s_add_u32 s58, s67, 184448
buffer_load_dwordx4 v5, s[36:39], s58 offen lds
s_add_u32 m0, s70, 57344
s_add_u32 s58, s67, 221312
buffer_load_dwordx4 v5, s[36:39], s58 offen lds
s_add_u32 m0, s70, 61440
s_add_u32 s58, s67, 258176
buffer_load_dwordx4 v5, s[36:39], s58 offen lds
s_add_u32 s53, s67, 221184
buffer_load_dwordx3 v[188:190], v12, s[36:39], s53 offen offset:0
s_waitcnt vmcnt(14)
s_barrier
s_add_u32 m0, s70, 65536
s_add_u32 s58, s64, 114688
buffer_load_dwordx4 v4, s[28:31], s58 offen nt lds
s_add_u32 m0, s70, 69632
s_add_u32 s58, s64, 118784
buffer_load_dwordx4 v4, s[28:31], s58 offen nt lds
s_add_u32 m0, s70, 73728
s_add_u32 s58, s64, 122880
buffer_load_dwordx4 v4, s[28:31], s58 offen nt lds
buffer_load_dwordx3 v[192:194], v12, s[36:39], s53 offen offset:1152
buffer_load_dwordx3 v[196:198], v12, s[36:39], s53 offen offset:2304
buffer_load_dwordx3 v[200:202], v12, s[36:39], s53 offen offset:3456
s_add_u32 s53, s67, 239616
buffer_load_dwordx3 v[204:206], v12, s[36:39], s53 offen offset:0
buffer_load_dwordx3 v[208:210], v12, s[36:39], s53 offen offset:1152
s_waitcnt vmcnt(12)
s_barrier
s_add_u32 m0, s70, 77824
s_add_u32 s58, s64, 126976
buffer_load_dwordx4 v4, s[28:31], s58 offen nt lds
buffer_load_dwordx3 v[212:214], v12, s[36:39], s53 offen offset:2304
buffer_load_dwordx3 v[216:218], v12, s[36:39], s53 offen offset:3456
s_add_u32 s53, s67, 258048
buffer_load_dwordx3 v[220:222], v12, s[36:39], s53 offen offset:0
buffer_load_dwordx3 v[224:226], v12, s[36:39], s53 offen offset:1152
buffer_load_dwordx3 v[228:230], v12, s[36:39], s53 offen offset:2304
buffer_load_dwordx3 v[232:234], v12, s[36:39], s53 offen offset:3456
s_waitcnt vmcnt(13)
s_barrier
s_add_u32 s53, s67, 276480
buffer_load_dwordx3 v[236:238], v12, s[36:39], s53 offen offset:0
buffer_load_dwordx3 v[240:242], v12, s[36:39], s53 offen offset:1152
buffer_load_dwordx3 v[244:246], v12, s[36:39], s53 offen offset:2304
buffer_load_dwordx3 v[248:250], v12, s[36:39], s53 offen offset:3456
s_waitcnt vmcnt(10)
s_barrier
v_lshlrev_b32 v9, 2, v252
v_add_u32 v9, 65536, v9
v_mov_b32 v10, 0
ds_write_b32 v9, v10
s_add_u32 m0, s70, 81920
s_add_u32 s58, s67, 256
buffer_load_dwordx4 v5, s[36:39], s58 offen lds
s_add_u32 m0, s70, 86016
s_add_u32 s58, s67, 37120
buffer_load_dwordx4 v5, s[36:39], s58 offen lds
s_add_u32 m0, s70, 90112
s_add_u32 s58, s67, 73984
buffer_load_dwordx4 v5, s[36:39], s58 offen lds
s_add_u32 m0, s70, 94208
s_add_u32 s58, s67, 110848
buffer_load_dwordx4 v5, s[36:39], s58 offen lds
s_add_u32 m0, s70, 98304
s_add_u32 s58, s67, 147712
buffer_load_dwordx4 v5, s[36:39], s58 offen lds
s_add_u32 m0, s70, 102400
s_add_u32 s58, s67, 184576
buffer_load_dwordx4 v5, s[36:39], s58 offen lds
s_add_u32 m0, s70, 106496
s_add_u32 s58, s67, 221440
buffer_load_dwordx4 v5, s[36:39], s58 offen lds
s_add_u32 m0, s70, 110592
s_add_u32 s58, s67, 258304
buffer_load_dwordx4 v5, s[36:39], s58 offen lds
s_waitcnt vmcnt(16)
v_perm_b32 v160, v192, v188, s94
v_perm_b32 v164, v192, v188, s95
v_perm_b32 v168, v193, v189, s94
v_perm_b32 v172, v193, v189, s95
v_perm_b32 v176, v194, v190, s94
v_perm_b32 v180, v194, v190, s95
v_perm_b32 v161, v200, v196, s94
v_perm_b32 v165, v200, v196, s95
v_perm_b32 v169, v201, v197, s94
v_perm_b32 v173, v201, v197, s95
v_perm_b32 v177, v202, v198, s94
v_perm_b32 v181, v202, v198, s95
v_perm_b32 v162, v208, v204, s94
L_pg2:
s_cbranch_execz L_ret
v_perm_b32 v166, v208, v204, s95
v_perm_b32 v170, v209, v205, s94
v_perm_b32 v174, v209, v205, s95
v_perm_b32 v178, v210, v206, s94
v_perm_b32 v182, v210, v206, s95
v_perm_b32 v163, v216, v212, s94
v_perm_b32 v167, v216, v212, s95
v_perm_b32 v171, v217, v213, s94
v_perm_b32 v175, v217, v213, s95
v_perm_b32 v179, v218, v214, s94
v_perm_b32 v183, v218, v214, s95
s_waitcnt vmcnt(8)
v_perm_b32 v184, v224, v220, s94
v_perm_b32 v188, v224, v220, s95
v_perm_b32 v192, v225, v221, s94
v_perm_b32 v196, v225, v221, s95
v_perm_b32 v200, v226, v222, s94
v_perm_b32 v204, v226, v222, s95
v_perm_b32 v185, v232, v228, s94
v_perm_b32 v189, v232, v228, s95
v_perm_b32 v193, v233, v229, s94
v_perm_b32 v197, v233, v229, s95
v_perm_b32 v201, v234, v230, s94
v_perm_b32 v205, v234, v230, s95
v_perm_b32 v186, v240, v236, s94
v_perm_b32 v190, v240, v236, s95
v_perm_b32 v194, v241, v237, s94
v_perm_b32 v198, v241, v237, s95
v_perm_b32 v202, v242, v238, s94
v_perm_b32 v206, v242, v238, s95
v_perm_b32 v187, v248, v244, s94
v_perm_b32 v191, v248, v244, s95
v_perm_b32 v195, v249, v245, s94
v_perm_b32 v199, v249, v245, s95
v_perm_b32 v203, v250, v246, s94
v_perm_b32 v207, v250, v246, s95
v_lshlrev_b32 v12, 4, v252
v_add_u32 v12, 114688, v12
s_mov_b32 s62, s69
v_mov_b32 v248, 1
v_mov_b32 v249, 65536
s_waitcnt lgkmcnt(0)
s_waitcnt vmcnt(0)
s_barrier
ds_read_b128 v[232:235], v12 offset:0
ds_read_b128 v[236:239], v12 offset:3072
ds_read_b128 v[240:243], v12 offset:6144
ds_read_b128 v[244:247], v12 offset:9216
s_waitcnt lgkmcnt(3)
v_mfma_f32_16x16x32_bf16 v[208:211], v[16:19], v[232:235], 0
s_waitcnt lgkmcnt(2)
v_mfma_f32_16x16x32_bf16 v[208:211], v[40:43], v[236:239], v[208:211]
v_mfma_f32_16x16x32_bf16 v[212:215], v[20:23], v[232:235], 0
v_mfma_f32_16x16x32_bf16 v[212:215], v[44:47], v[236:239], v[212:215]
v_mfma_f32_16x16x32_bf16 v[216:219], v[24:27], v[232:235], 0
v_mfma_f32_16x16x32_bf16 v[216:219], v[48:51], v[236:239], v[216:219]
v_mfma_f32_16x16x32_bf16 v[220:223], v[28:31], v[232:235], 0
v_mfma_f32_16x16x32_bf16 v[220:223], v[52:55], v[236:239], v[220:223]
v_mfma_f32_16x16x32_bf16 v[224:227], v[32:35], v[232:235], 0
v_mfma_f32_16x16x32_bf16 v[224:227], v[56:59], v[236:239], v[224:227]
v_mfma_f32_16x16x32_bf16 v[228:231], v[36:39], v[232:235], 0
ds_read_b128 v[232:235], v12 offset:24576
v_mfma_f32_16x16x32_bf16 v[228:231], v[60:63], v[236:239], v[228:231]
ds_read_b128 v[236:239], v12 offset:27648
s_waitcnt lgkmcnt(3)
v_mfma_f32_16x16x32_bf16 v[208:211], v[64:67], v[240:243], v[208:211]
s_waitcnt lgkmcnt(2)
v_mfma_f32_16x16x32_bf16 v[208:211], v[88:91], v[244:247], v[208:211]
v_mfma_f32_16x16x32_bf16 v[212:215], v[68:71], v[240:243], v[212:215]
v_mfma_f32_16x16x32_bf16 v[212:215], v[92:95], v[244:247], v[212:215]
v_mfma_f32_16x16x32_bf16 v[216:219], v[72:75], v[240:243], v[216:219]
v_mfma_f32_16x16x32_bf16 v[216:219], v[96:99], v[244:247], v[216:219]
v_mfma_f32_16x16x32_bf16 v[220:223], v[76:79], v[240:243], v[220:223]
v_mfma_f32_16x16x32_bf16 v[220:223], v[100:103], v[244:247], v[220:223]
v_mfma_f32_16x16x32_bf16 v[224:227], v[80:83], v[240:243], v[224:227]
v_mfma_f32_16x16x32_bf16 v[224:227], v[104:107], v[244:247], v[224:227]
v_mfma_f32_16x16x32_bf16 v[228:231], v[84:87], v[240:243], v[228:231]
ds_read_b128 v[240:243], v12 offset:30720
v_mfma_f32_16x16x32_bf16 v[228:231], v[108:111], v[244:247], v[228:231]
ds_read_b128 v[244:247], v12 offset:33792
s_waitcnt lgkmcnt(3)
v_mfma_f32_16x16x32_bf16 v[208:211], v[112:115], v[232:235], v[208:211]
s_waitcnt lgkmcnt(2)
v_mfma_f32_16x16x32_bf16 v[208:211], v[136:139], v[236:239], v[208:211]
v_mfma_f32_16x16x32_bf16 v[212:215], v[116:119], v[232:235], v[212:215]
v_mfma_f32_16x16x32_bf16 v[212:215], v[140:143], v[236:239], v[212:215]
v_mfma_f32_16x16x32_bf16 v[216:219], v[120:123], v[232:235], v[216:219]
v_mfma_f32_16x16x32_bf16 v[216:219], v[144:147], v[236:239], v[216:219]
v_mfma_f32_16x16x32_bf16 v[220:223], v[124:127], v[232:235], v[220:223]
v_mfma_f32_16x16x32_bf16 v[220:223], v[148:151], v[236:239], v[220:223]
v_mfma_f32_16x16x32_bf16 v[224:227], v[128:131], v[232:235], v[224:227]
v_mfma_f32_16x16x32_bf16 v[224:227], v[152:155], v[236:239], v[224:227]
v_mfma_f32_16x16x32_bf16 v[228:231], v[132:135], v[232:235], v[228:231]
ds_read_b128 v[232:235], v12 offset:1024
v_mfma_f32_16x16x32_bf16 v[228:231], v[156:159], v[236:239], v[228:231]
ds_read_b128 v[236:239], v12 offset:4096
s_waitcnt lgkmcnt(3)
v_mfma_f32_16x16x32_bf16 v[208:211], v[160:163], v[240:243], v[208:211]
s_waitcnt lgkmcnt(2)
v_mfma_f32_16x16x32_bf16 v[208:211], v[184:187], v[244:247], v[208:211]
v_mfma_f32_16x16x32_bf16 v[212:215], v[164:167], v[240:243], v[212:215]
v_mfma_f32_16x16x32_bf16 v[212:215], v[188:191], v[244:247], v[212:215]
v_mfma_f32_16x16x32_bf16 v[216:219], v[168:171], v[240:243], v[216:219]
v_mfma_f32_16x16x32_bf16 v[216:219], v[192:195], v[244:247], v[216:219]
v_mfma_f32_16x16x32_bf16 v[220:223], v[172:175], v[240:243], v[220:223]
v_mfma_f32_16x16x32_bf16 v[220:223], v[196:199], v[244:247], v[220:223]
v_mfma_f32_16x16x32_bf16 v[224:227], v[176:179], v[240:243], v[224:227]
v_mfma_f32_16x16x32_bf16 v[224:227], v[200:203], v[244:247], v[224:227]
v_mfma_f32_16x16x32_bf16 v[228:231], v[180:183], v[240:243], v[228:231]
ds_read_b128 v[240:243], v12 offset:7168
v_cvt_pk_bf16_f32 v0, v208, v212
v_cvt_pk_bf16_f32 v3, v209, v213
v_mfma_f32_16x16x32_bf16 v[228:231], v[204:207], v[244:247], v[228:231]
ds_read_b128 v[244:247], v12 offset:10240
v_cvt_pk_bf16_f32 v6, v210, v214
v_cvt_pk_bf16_f32 v9, v211, v215
s_waitcnt lgkmcnt(3)
v_mfma_f32_16x16x32_bf16 v[208:211], v[16:19], v[232:235], 0
s_waitcnt lgkmcnt(2)
v_mfma_f32_16x16x32_bf16 v[208:211], v[40:43], v[236:239], v[208:211]
v_cvt_pk_bf16_f32 v1, v216, v220
v_cvt_pk_bf16_f32 v4, v217, v221
v_mfma_f32_16x16x32_bf16 v[212:215], v[20:23], v[232:235], 0
v_cvt_pk_bf16_f32 v7, v218, v222
v_cvt_pk_bf16_f32 v10, v219, v223
v_mfma_f32_16x16x32_bf16 v[212:215], v[44:47], v[236:239], v[212:215]
v_mfma_f32_16x16x32_bf16 v[216:219], v[24:27], v[232:235], 0
v_mfma_f32_16x16x32_bf16 v[216:219], v[48:51], v[236:239], v[216:219]
v_cvt_pk_bf16_f32 v2, v224, v228
v_cvt_pk_bf16_f32 v5, v225, v229
v_mfma_f32_16x16x32_bf16 v[220:223], v[28:31], v[232:235], 0
v_cvt_pk_bf16_f32 v8, v226, v230
v_cvt_pk_bf16_f32 v11, v227, v231
v_mfma_f32_16x16x32_bf16 v[220:223], v[52:55], v[236:239], v[220:223]
buffer_store_dwordx4 v[0:3], v13, s[40:43], s62 offen sc0 sc1
v_mfma_f32_16x16x32_bf16 v[224:227], v[32:35], v[232:235], 0
buffer_store_dwordx4 v[4:7], v14, s[40:43], s62 offen sc0 sc1
v_mfma_f32_16x16x32_bf16 v[224:227], v[56:59], v[236:239], v[224:227]
buffer_store_dwordx4 v[8:11], v15, s[40:43], s62 offen sc0 sc1
v_mfma_f32_16x16x32_bf16 v[228:231], v[36:39], v[232:235], 0
ds_read_b128 v[232:235], v12 offset:25600
s_add_u32 s62, s62, 2048
v_mfma_f32_16x16x32_bf16 v[228:231], v[60:63], v[236:239], v[228:231]
ds_read_b128 v[236:239], v12 offset:28672
s_waitcnt lgkmcnt(3)
v_mfma_f32_16x16x32_bf16 v[208:211], v[64:67], v[240:243], v[208:211]
s_waitcnt lgkmcnt(2)
v_mfma_f32_16x16x32_bf16 v[208:211], v[88:91], v[244:247], v[208:211]
v_mfma_f32_16x16x32_bf16 v[212:215], v[68:71], v[240:243], v[212:215]
v_mfma_f32_16x16x32_bf16 v[212:215], v[92:95], v[244:247], v[212:215]
v_mfma_f32_16x16x32_bf16 v[216:219], v[72:75], v[240:243], v[216:219]
v_mfma_f32_16x16x32_bf16 v[216:219], v[96:99], v[244:247], v[216:219]
v_mfma_f32_16x16x32_bf16 v[220:223], v[76:79], v[240:243], v[220:223]
v_mfma_f32_16x16x32_bf16 v[220:223], v[100:103], v[244:247], v[220:223]
v_mfma_f32_16x16x32_bf16 v[224:227], v[80:83], v[240:243], v[224:227]
v_mfma_f32_16x16x32_bf16 v[224:227], v[104:107], v[244:247], v[224:227]
v_mfma_f32_16x16x32_bf16 v[228:231], v[84:87], v[240:243], v[228:231]
ds_read_b128 v[240:243], v12 offset:31744
v_mfma_f32_16x16x32_bf16 v[228:231], v[108:111], v[244:247], v[228:231]
ds_read_b128 v[244:247], v12 offset:34816
s_waitcnt lgkmcnt(3)
v_mfma_f32_16x16x32_bf16 v[208:211], v[112:115], v[232:235], v[208:211]
s_waitcnt lgkmcnt(2)
v_mfma_f32_16x16x32_bf16 v[208:211], v[136:139], v[236:239], v[208:211]
v_mfma_f32_16x16x32_bf16 v[212:215], v[116:119], v[232:235], v[212:215]
v_mfma_f32_16x16x32_bf16 v[212:215], v[140:143], v[236:239], v[212:215]
v_mfma_f32_16x16x32_bf16 v[216:219], v[120:123], v[232:235], v[216:219]
v_mfma_f32_16x16x32_bf16 v[216:219], v[144:147], v[236:239], v[216:219]
v_mfma_f32_16x16x32_bf16 v[220:223], v[124:127], v[232:235], v[220:223]
v_mfma_f32_16x16x32_bf16 v[220:223], v[148:151], v[236:239], v[220:223]
v_mfma_f32_16x16x32_bf16 v[224:227], v[128:131], v[232:235], v[224:227]
v_mfma_f32_16x16x32_bf16 v[224:227], v[152:155], v[236:239], v[224:227]
v_mfma_f32_16x16x32_bf16 v[228:231], v[132:135], v[232:235], v[228:231]
ds_read_b128 v[232:235], v12 offset:2048
v_mfma_f32_16x16x32_bf16 v[228:231], v[156:159], v[236:239], v[228:231]
ds_read_b128 v[236:239], v12 offset:5120
s_waitcnt lgkmcnt(3)
v_mfma_f32_16x16x32_bf16 v[208:211], v[160:163], v[240:243], v[208:211]
s_waitcnt lgkmcnt(2)
v_mfma_f32_16x16x32_bf16 v[208:211], v[184:187], v[244:247], v[208:211]
v_mfma_f32_16x16x32_bf16 v[212:215], v[164:167], v[240:243], v[212:215]
v_mfma_f32_16x16x32_bf16 v[212:215], v[188:191], v[244:247], v[212:215]
v_mfma_f32_16x16x32_bf16 v[216:219], v[168:171], v[240:243], v[216:219]
v_mfma_f32_16x16x32_bf16 v[216:219], v[192:195], v[244:247], v[216:219]
v_mfma_f32_16x16x32_bf16 v[220:223], v[172:175], v[240:243], v[220:223]
v_mfma_f32_16x16x32_bf16 v[220:223], v[196:199], v[244:247], v[220:223]
v_mfma_f32_16x16x32_bf16 v[224:227], v[176:179], v[240:243], v[224:227]
v_mfma_f32_16x16x32_bf16 v[224:227], v[200:203], v[244:247], v[224:227]
v_mfma_f32_16x16x32_bf16 v[228:231], v[180:183], v[240:243], v[228:231]
ds_read_b128 v[240:243], v12 offset:8192
v_cvt_pk_bf16_f32 v0, v208, v212
v_cvt_pk_bf16_f32 v3, v209, v213
v_mfma_f32_16x16x32_bf16 v[228:231], v[204:207], v[244:247], v[228:231]
ds_read_b128 v[244:247], v12 offset:11264
v_cvt_pk_bf16_f32 v6, v210, v214
v_cvt_pk_bf16_f32 v9, v211, v215
s_waitcnt lgkmcnt(3)
v_mfma_f32_16x16x32_bf16 v[208:211], v[16:19], v[232:235], 0
s_waitcnt lgkmcnt(2)
v_mfma_f32_16x16x32_bf16 v[208:211], v[40:43], v[236:239], v[208:211]
v_cvt_pk_bf16_f32 v1, v216, v220
v_cvt_pk_bf16_f32 v4, v217, v221
v_mfma_f32_16x16x32_bf16 v[212:215], v[20:23], v[232:235], 0
v_cvt_pk_bf16_f32 v7, v218, v222
v_cvt_pk_bf16_f32 v10, v219, v223
v_mfma_f32_16x16x32_bf16 v[212:215], v[44:47], v[236:239], v[212:215]
v_mfma_f32_16x16x32_bf16 v[216:219], v[24:27], v[232:235], 0
v_mfma_f32_16x16x32_bf16 v[216:219], v[48:51], v[236:239], v[216:219]
v_cvt_pk_bf16_f32 v2, v224, v228
v_cvt_pk_bf16_f32 v5, v225, v229
v_mfma_f32_16x16x32_bf16 v[220:223], v[28:31], v[232:235], 0
v_cvt_pk_bf16_f32 v8, v226, v230
v_cvt_pk_bf16_f32 v11, v227, v231
v_mfma_f32_16x16x32_bf16 v[220:223], v[52:55], v[236:239], v[220:223]
buffer_store_dwordx4 v[0:3], v13, s[40:43], s62 offen sc0 sc1
v_mfma_f32_16x16x32_bf16 v[224:227], v[32:35], v[232:235], 0
buffer_store_dwordx4 v[4:7], v14, s[40:43], s62 offen sc0 sc1
v_mfma_f32_16x16x32_bf16 v[224:227], v[56:59], v[236:239], v[224:227]
buffer_store_dwordx4 v[8:11], v15, s[40:43], s62 offen sc0 sc1
v_mfma_f32_16x16x32_bf16 v[228:231], v[36:39], v[232:235], 0
ds_read_b128 v[232:235], v12 offset:26624
s_add_u32 s62, s62, 2048
v_mfma_f32_16x16x32_bf16 v[228:231], v[60:63], v[236:239], v[228:231]
ds_read_b128 v[236:239], v12 offset:29696
s_waitcnt lgkmcnt(3)
v_mfma_f32_16x16x32_bf16 v[208:211], v[64:67], v[240:243], v[208:211]
s_waitcnt lgkmcnt(2)
v_mfma_f32_16x16x32_bf16 v[208:211], v[88:91], v[244:247], v[208:211]
v_mfma_f32_16x16x32_bf16 v[212:215], v[68:71], v[240:243], v[212:215]
v_mfma_f32_16x16x32_bf16 v[212:215], v[92:95], v[244:247], v[212:215]
v_mfma_f32_16x16x32_bf16 v[216:219], v[72:75], v[240:243], v[216:219]
v_mfma_f32_16x16x32_bf16 v[216:219], v[96:99], v[244:247], v[216:219]
v_mfma_f32_16x16x32_bf16 v[220:223], v[76:79], v[240:243], v[220:223]
v_mfma_f32_16x16x32_bf16 v[220:223], v[100:103], v[244:247], v[220:223]
v_mfma_f32_16x16x32_bf16 v[224:227], v[80:83], v[240:243], v[224:227]
v_mfma_f32_16x16x32_bf16 v[224:227], v[104:107], v[244:247], v[224:227]
v_mfma_f32_16x16x32_bf16 v[228:231], v[84:87], v[240:243], v[228:231]
ds_read_b128 v[240:243], v12 offset:32768
v_mfma_f32_16x16x32_bf16 v[228:231], v[108:111], v[244:247], v[228:231]
ds_read_b128 v[244:247], v12 offset:35840
s_waitcnt lgkmcnt(3)
v_mfma_f32_16x16x32_bf16 v[208:211], v[112:115], v[232:235], v[208:211]
s_waitcnt lgkmcnt(2)
v_mfma_f32_16x16x32_bf16 v[208:211], v[136:139], v[236:239], v[208:211]
v_mfma_f32_16x16x32_bf16 v[212:215], v[116:119], v[232:235], v[212:215]
v_mfma_f32_16x16x32_bf16 v[212:215], v[140:143], v[236:239], v[212:215]
v_mfma_f32_16x16x32_bf16 v[216:219], v[120:123], v[232:235], v[216:219]
v_mfma_f32_16x16x32_bf16 v[216:219], v[144:147], v[236:239], v[216:219]
v_mfma_f32_16x16x32_bf16 v[220:223], v[124:127], v[232:235], v[220:223]
v_mfma_f32_16x16x32_bf16 v[220:223], v[148:151], v[236:239], v[220:223]
v_mfma_f32_16x16x32_bf16 v[224:227], v[128:131], v[232:235], v[224:227]
v_mfma_f32_16x16x32_bf16 v[224:227], v[152:155], v[236:239], v[224:227]
v_mfma_f32_16x16x32_bf16 v[228:231], v[132:135], v[232:235], v[228:231]
ds_read_b128 v[232:235], v12 offset:12288
v_mfma_f32_16x16x32_bf16 v[228:231], v[156:159], v[236:239], v[228:231]
ds_read_b128 v[236:239], v12 offset:15360
s_waitcnt lgkmcnt(3)
v_mfma_f32_16x16x32_bf16 v[208:211], v[160:163], v[240:243], v[208:211]
s_waitcnt lgkmcnt(2)
v_mfma_f32_16x16x32_bf16 v[208:211], v[184:187], v[244:247], v[208:211]
v_mfma_f32_16x16x32_bf16 v[212:215], v[164:167], v[240:243], v[212:215]
v_mfma_f32_16x16x32_bf16 v[212:215], v[188:191], v[244:247], v[212:215]
v_mfma_f32_16x16x32_bf16 v[216:219], v[168:171], v[240:243], v[216:219]
v_mfma_f32_16x16x32_bf16 v[216:219], v[192:195], v[244:247], v[216:219]
v_mfma_f32_16x16x32_bf16 v[220:223], v[172:175], v[240:243], v[220:223]
v_mfma_f32_16x16x32_bf16 v[220:223], v[196:199], v[244:247], v[220:223]
v_mfma_f32_16x16x32_bf16 v[224:227], v[176:179], v[240:243], v[224:227]
v_mfma_f32_16x16x32_bf16 v[224:227], v[200:203], v[244:247], v[224:227]
v_mfma_f32_16x16x32_bf16 v[228:231], v[180:183], v[240:243], v[228:231]
ds_read_b128 v[240:243], v12 offset:18432
v_cvt_pk_bf16_f32 v0, v208, v212
v_cvt_pk_bf16_f32 v3, v209, v213
v_mfma_f32_16x16x32_bf16 v[228:231], v[204:207], v[244:247], v[228:231]
ds_read_b128 v[244:247], v12 offset:21504
v_cvt_pk_bf16_f32 v6, v210, v214
v_cvt_pk_bf16_f32 v9, v211, v215
s_waitcnt lgkmcnt(3)
v_mfma_f32_16x16x32_bf16 v[208:211], v[16:19], v[232:235], 0
s_waitcnt lgkmcnt(2)
v_mfma_f32_16x16x32_bf16 v[208:211], v[40:43], v[236:239], v[208:211]
v_cvt_pk_bf16_f32 v1, v216, v220
v_cvt_pk_bf16_f32 v4, v217, v221
v_mfma_f32_16x16x32_bf16 v[212:215], v[20:23], v[232:235], 0
v_cvt_pk_bf16_f32 v7, v218, v222
v_cvt_pk_bf16_f32 v10, v219, v223
v_mfma_f32_16x16x32_bf16 v[212:215], v[44:47], v[236:239], v[212:215]
v_mfma_f32_16x16x32_bf16 v[216:219], v[24:27], v[232:235], 0
v_mfma_f32_16x16x32_bf16 v[216:219], v[48:51], v[236:239], v[216:219]
v_cvt_pk_bf16_f32 v2, v224, v228
v_cvt_pk_bf16_f32 v5, v225, v229
v_mfma_f32_16x16x32_bf16 v[220:223], v[28:31], v[232:235], 0
v_cvt_pk_bf16_f32 v8, v226, v230
v_cvt_pk_bf16_f32 v11, v227, v231
v_mfma_f32_16x16x32_bf16 v[220:223], v[52:55], v[236:239], v[220:223]
buffer_store_dwordx4 v[0:3], v13, s[40:43], s62 offen sc0 sc1
v_mfma_f32_16x16x32_bf16 v[224:227], v[32:35], v[232:235], 0
buffer_store_dwordx4 v[4:7], v14, s[40:43], s62 offen sc0 sc1
v_mfma_f32_16x16x32_bf16 v[224:227], v[56:59], v[236:239], v[224:227]
buffer_store_dwordx4 v[8:11], v15, s[40:43], s62 offen sc0 sc1
v_mfma_f32_16x16x32_bf16 v[228:231], v[36:39], v[232:235], 0
ds_read_b128 v[232:235], v12 offset:36864
s_add_u32 s62, s62, 2048
v_mfma_f32_16x16x32_bf16 v[228:231], v[60:63], v[236:239], v[228:231]
ds_read_b128 v[236:239], v12 offset:39936
s_waitcnt lgkmcnt(3)
v_mfma_f32_16x16x32_bf16 v[208:211], v[64:67], v[240:243], v[208:211]
s_waitcnt lgkmcnt(2)
v_mfma_f32_16x16x32_bf16 v[208:211], v[88:91], v[244:247], v[208:211]
v_mfma_f32_16x16x32_bf16 v[212:215], v[68:71], v[240:243], v[212:215]
v_mfma_f32_16x16x32_bf16 v[212:215], v[92:95], v[244:247], v[212:215]
v_mfma_f32_16x16x32_bf16 v[216:219], v[72:75], v[240:243], v[216:219]
v_mfma_f32_16x16x32_bf16 v[216:219], v[96:99], v[244:247], v[216:219]
v_mfma_f32_16x16x32_bf16 v[220:223], v[76:79], v[240:243], v[220:223]
v_mfma_f32_16x16x32_bf16 v[220:223], v[100:103], v[244:247], v[220:223]
v_mfma_f32_16x16x32_bf16 v[224:227], v[80:83], v[240:243], v[224:227]
v_mfma_f32_16x16x32_bf16 v[224:227], v[104:107], v[244:247], v[224:227]
v_mfma_f32_16x16x32_bf16 v[228:231], v[84:87], v[240:243], v[228:231]
ds_read_b128 v[240:243], v12 offset:43008
v_mfma_f32_16x16x32_bf16 v[228:231], v[108:111], v[244:247], v[228:231]
ds_read_b128 v[244:247], v12 offset:46080
s_waitcnt lgkmcnt(3)
v_mfma_f32_16x16x32_bf16 v[208:211], v[112:115], v[232:235], v[208:211]
s_waitcnt lgkmcnt(2)
v_mfma_f32_16x16x32_bf16 v[208:211], v[136:139], v[236:239], v[208:211]
v_mfma_f32_16x16x32_bf16 v[212:215], v[116:119], v[232:235], v[212:215]
v_mfma_f32_16x16x32_bf16 v[212:215], v[140:143], v[236:239], v[212:215]
v_mfma_f32_16x16x32_bf16 v[216:219], v[120:123], v[232:235], v[216:219]
v_mfma_f32_16x16x32_bf16 v[216:219], v[144:147], v[236:239], v[216:219]
v_mfma_f32_16x16x32_bf16 v[220:223], v[124:127], v[232:235], v[220:223]
v_mfma_f32_16x16x32_bf16 v[220:223], v[148:151], v[236:239], v[220:223]
v_mfma_f32_16x16x32_bf16 v[224:227], v[128:131], v[232:235], v[224:227]
v_mfma_f32_16x16x32_bf16 v[224:227], v[152:155], v[236:239], v[224:227]
v_mfma_f32_16x16x32_bf16 v[228:231], v[132:135], v[232:235], v[228:231]
ds_read_b128 v[232:235], v12 offset:13312
v_mfma_f32_16x16x32_bf16 v[228:231], v[156:159], v[236:239], v[228:231]
ds_read_b128 v[236:239], v12 offset:16384
s_waitcnt lgkmcnt(3)
v_mfma_f32_16x16x32_bf16 v[208:211], v[160:163], v[240:243], v[208:211]
s_waitcnt lgkmcnt(2)
v_mfma_f32_16x16x32_bf16 v[208:211], v[184:187], v[244:247], v[208:211]
v_mfma_f32_16x16x32_bf16 v[212:215], v[164:167], v[240:243], v[212:215]
v_mfma_f32_16x16x32_bf16 v[212:215], v[188:191], v[244:247], v[212:215]
v_mfma_f32_16x16x32_bf16 v[216:219], v[168:171], v[240:243], v[216:219]
v_mfma_f32_16x16x32_bf16 v[216:219], v[192:195], v[244:247], v[216:219]
v_mfma_f32_16x16x32_bf16 v[220:223], v[172:175], v[240:243], v[220:223]
v_mfma_f32_16x16x32_bf16 v[220:223], v[196:199], v[244:247], v[220:223]
v_mfma_f32_16x16x32_bf16 v[224:227], v[176:179], v[240:243], v[224:227]
v_mfma_f32_16x16x32_bf16 v[224:227], v[200:203], v[244:247], v[224:227]
v_mfma_f32_16x16x32_bf16 v[228:231], v[180:183], v[240:243], v[228:231]
ds_read_b128 v[240:243], v12 offset:19456
v_cvt_pk_bf16_f32 v0, v208, v212
v_cvt_pk_bf16_f32 v3, v209, v213
v_mfma_f32_16x16x32_bf16 v[228:231], v[204:207], v[244:247], v[228:231]
ds_read_b128 v[244:247], v12 offset:22528
v_cvt_pk_bf16_f32 v6, v210, v214
v_cvt_pk_bf16_f32 v9, v211, v215
s_waitcnt lgkmcnt(3)
v_mfma_f32_16x16x32_bf16 v[208:211], v[16:19], v[232:235], 0
s_waitcnt lgkmcnt(2)
v_mfma_f32_16x16x32_bf16 v[208:211], v[40:43], v[236:239], v[208:211]
v_cvt_pk_bf16_f32 v1, v216, v220
v_cvt_pk_bf16_f32 v4, v217, v221
v_mfma_f32_16x16x32_bf16 v[212:215], v[20:23], v[232:235], 0
v_cvt_pk_bf16_f32 v7, v218, v222
v_cvt_pk_bf16_f32 v10, v219, v223
v_mfma_f32_16x16x32_bf16 v[212:215], v[44:47], v[236:239], v[212:215]
v_mfma_f32_16x16x32_bf16 v[216:219], v[24:27], v[232:235], 0
v_mfma_f32_16x16x32_bf16 v[216:219], v[48:51], v[236:239], v[216:219]
v_cvt_pk_bf16_f32 v2, v224, v228
v_cvt_pk_bf16_f32 v5, v225, v229
v_mfma_f32_16x16x32_bf16 v[220:223], v[28:31], v[232:235], 0
v_cvt_pk_bf16_f32 v8, v226, v230
v_cvt_pk_bf16_f32 v11, v227, v231
v_mfma_f32_16x16x32_bf16 v[220:223], v[52:55], v[236:239], v[220:223]
buffer_store_dwordx4 v[0:3], v13, s[40:43], s62 offen sc0 sc1
v_mfma_f32_16x16x32_bf16 v[224:227], v[32:35], v[232:235], 0
buffer_store_dwordx4 v[4:7], v14, s[40:43], s62 offen sc0 sc1
v_mfma_f32_16x16x32_bf16 v[224:227], v[56:59], v[236:239], v[224:227]
buffer_store_dwordx4 v[8:11], v15, s[40:43], s62 offen sc0 sc1
v_mfma_f32_16x16x32_bf16 v[228:231], v[36:39], v[232:235], 0
ds_read_b128 v[232:235], v12 offset:37888
s_add_u32 s62, s62, 2048
v_mfma_f32_16x16x32_bf16 v[228:231], v[60:63], v[236:239], v[228:231]
ds_read_b128 v[236:239], v12 offset:40960
s_waitcnt lgkmcnt(3)
v_mfma_f32_16x16x32_bf16 v[208:211], v[64:67], v[240:243], v[208:211]
s_waitcnt lgkmcnt(2)
v_mfma_f32_16x16x32_bf16 v[208:211], v[88:91], v[244:247], v[208:211]
v_mfma_f32_16x16x32_bf16 v[212:215], v[68:71], v[240:243], v[212:215]
v_mfma_f32_16x16x32_bf16 v[212:215], v[92:95], v[244:247], v[212:215]
v_mfma_f32_16x16x32_bf16 v[216:219], v[72:75], v[240:243], v[216:219]
v_mfma_f32_16x16x32_bf16 v[216:219], v[96:99], v[244:247], v[216:219]
v_mfma_f32_16x16x32_bf16 v[220:223], v[76:79], v[240:243], v[220:223]
v_mfma_f32_16x16x32_bf16 v[220:223], v[100:103], v[244:247], v[220:223]
v_mfma_f32_16x16x32_bf16 v[224:227], v[80:83], v[240:243], v[224:227]
v_mfma_f32_16x16x32_bf16 v[224:227], v[104:107], v[244:247], v[224:227]
v_mfma_f32_16x16x32_bf16 v[228:231], v[84:87], v[240:243], v[228:231]
ds_read_b128 v[240:243], v12 offset:44032
v_mfma_f32_16x16x32_bf16 v[228:231], v[108:111], v[244:247], v[228:231]
ds_read_b128 v[244:247], v12 offset:47104
s_waitcnt lgkmcnt(3)
v_mfma_f32_16x16x32_bf16 v[208:211], v[112:115], v[232:235], v[208:211]
s_waitcnt lgkmcnt(2)
v_mfma_f32_16x16x32_bf16 v[208:211], v[136:139], v[236:239], v[208:211]
v_mfma_f32_16x16x32_bf16 v[212:215], v[116:119], v[232:235], v[212:215]
v_mfma_f32_16x16x32_bf16 v[212:215], v[140:143], v[236:239], v[212:215]
v_mfma_f32_16x16x32_bf16 v[216:219], v[120:123], v[232:235], v[216:219]
v_mfma_f32_16x16x32_bf16 v[216:219], v[144:147], v[236:239], v[216:219]
v_mfma_f32_16x16x32_bf16 v[220:223], v[124:127], v[232:235], v[220:223]
v_mfma_f32_16x16x32_bf16 v[220:223], v[148:151], v[236:239], v[220:223]
v_mfma_f32_16x16x32_bf16 v[224:227], v[128:131], v[232:235], v[224:227]
v_mfma_f32_16x16x32_bf16 v[224:227], v[152:155], v[236:239], v[224:227]
v_mfma_f32_16x16x32_bf16 v[228:231], v[132:135], v[232:235], v[228:231]
ds_read_b128 v[232:235], v12 offset:14336
v_mfma_f32_16x16x32_bf16 v[228:231], v[156:159], v[236:239], v[228:231]
ds_read_b128 v[236:239], v12 offset:17408
s_waitcnt lgkmcnt(3)
v_mfma_f32_16x16x32_bf16 v[208:211], v[160:163], v[240:243], v[208:211]
s_waitcnt lgkmcnt(2)
v_mfma_f32_16x16x32_bf16 v[208:211], v[184:187], v[244:247], v[208:211]
v_mfma_f32_16x16x32_bf16 v[212:215], v[164:167], v[240:243], v[212:215]
v_mfma_f32_16x16x32_bf16 v[212:215], v[188:191], v[244:247], v[212:215]
v_mfma_f32_16x16x32_bf16 v[216:219], v[168:171], v[240:243], v[216:219]
v_mfma_f32_16x16x32_bf16 v[216:219], v[192:195], v[244:247], v[216:219]
s_mov_b64 exec, 1
s_waitcnt vmcnt(3)
ds_add_u32 v249, v248 offset:4
s_mov_b64 exec, -1
v_mfma_f32_16x16x32_bf16 v[220:223], v[172:175], v[240:243], v[220:223]
v_mfma_f32_16x16x32_bf16 v[220:223], v[196:199], v[244:247], v[220:223]
v_mfma_f32_16x16x32_bf16 v[224:227], v[176:179], v[240:243], v[224:227]
v_mfma_f32_16x16x32_bf16 v[224:227], v[200:203], v[244:247], v[224:227]
v_mfma_f32_16x16x32_bf16 v[228:231], v[180:183], v[240:243], v[228:231]
ds_read_b128 v[240:243], v12 offset:20480
v_cvt_pk_bf16_f32 v0, v208, v212
v_cvt_pk_bf16_f32 v3, v209, v213
v_mfma_f32_16x16x32_bf16 v[228:231], v[204:207], v[244:247], v[228:231]
ds_read_b128 v[244:247], v12 offset:23552
v_cvt_pk_bf16_f32 v6, v210, v214
v_cvt_pk_bf16_f32 v9, v211, v215
s_waitcnt lgkmcnt(4)
v_mfma_f32_16x16x32_bf16 v[208:211], v[16:19], v[232:235], 0
s_waitcnt lgkmcnt(3)
v_mfma_f32_16x16x32_bf16 v[208:211], v[40:43], v[236:239], v[208:211]
v_cvt_pk_bf16_f32 v1, v216, v220
v_cvt_pk_bf16_f32 v4, v217, v221
v_mfma_f32_16x16x32_bf16 v[212:215], v[20:23], v[232:235], 0
v_cvt_pk_bf16_f32 v7, v218, v222
v_cvt_pk_bf16_f32 v10, v219, v223
v_mfma_f32_16x16x32_bf16 v[212:215], v[44:47], v[236:239], v[212:215]
v_mfma_f32_16x16x32_bf16 v[216:219], v[24:27], v[232:235], 0
v_mfma_f32_16x16x32_bf16 v[216:219], v[48:51], v[236:239], v[216:219]
v_cvt_pk_bf16_f32 v2, v224, v228
v_cvt_pk_bf16_f32 v5, v225, v229
v_mfma_f32_16x16x32_bf16 v[220:223], v[28:31], v[232:235], 0
v_cvt_pk_bf16_f32 v8, v226, v230
v_cvt_pk_bf16_f32 v11, v227, v231
v_mfma_f32_16x16x32_bf16 v[220:223], v[52:55], v[236:239], v[220:223]
buffer_store_dwordx4 v[0:3], v13, s[40:43], s62 offen sc0 sc1
v_mfma_f32_16x16x32_bf16 v[224:227], v[32:35], v[232:235], 0
buffer_store_dwordx4 v[4:7], v14, s[40:43], s62 offen sc0 sc1
v_mfma_f32_16x16x32_bf16 v[224:227], v[56:59], v[236:239], v[224:227]
buffer_store_dwordx4 v[8:11], v15, s[40:43], s62 offen sc0 sc1
v_mfma_f32_16x16x32_bf16 v[228:231], v[36:39], v[232:235], 0
ds_read_b128 v[232:235], v12 offset:38912
s_add_u32 s62, s62, 2048
v_mfma_f32_16x16x32_bf16 v[228:231], v[60:63], v[236:239], v[228:231]
ds_read_b128 v[236:239], v12 offset:41984
s_waitcnt lgkmcnt(3)
v_mfma_f32_16x16x32_bf16 v[208:211], v[64:67], v[240:243], v[208:211]
s_waitcnt lgkmcnt(2)
v_mfma_f32_16x16x32_bf16 v[208:211], v[88:91], v[244:247], v[208:211]
v_mfma_f32_16x16x32_bf16 v[212:215], v[68:71], v[240:243], v[212:215]
v_mfma_f32_16x16x32_bf16 v[212:215], v[92:95], v[244:247], v[212:215]
v_mfma_f32_16x16x32_bf16 v[216:219], v[72:75], v[240:243], v[216:219]
v_mfma_f32_16x16x32_bf16 v[216:219], v[96:99], v[244:247], v[216:219]
v_mfma_f32_16x16x32_bf16 v[220:223], v[76:79], v[240:243], v[220:223]
v_mfma_f32_16x16x32_bf16 v[220:223], v[100:103], v[244:247], v[220:223]
v_mfma_f32_16x16x32_bf16 v[224:227], v[80:83], v[240:243], v[224:227]
v_mfma_f32_16x16x32_bf16 v[224:227], v[104:107], v[244:247], v[224:227]
v_mfma_f32_16x16x32_bf16 v[228:231], v[84:87], v[240:243], v[228:231]
ds_read_b128 v[240:243], v12 offset:45056
v_mfma_f32_16x16x32_bf16 v[228:231], v[108:111], v[244:247], v[228:231]
ds_read_b128 v[244:247], v12 offset:48128
s_waitcnt lgkmcnt(3)
v_mfma_f32_16x16x32_bf16 v[208:211], v[112:115], v[232:235], v[208:211]
s_waitcnt lgkmcnt(2)
v_mfma_f32_16x16x32_bf16 v[208:211], v[136:139], v[236:239], v[208:211]
v_mfma_f32_16x16x32_bf16 v[212:215], v[116:119], v[232:235], v[212:215]
v_mfma_f32_16x16x32_bf16 v[212:215], v[140:143], v[236:239], v[212:215]
v_mfma_f32_16x16x32_bf16 v[216:219], v[120:123], v[232:235], v[216:219]
v_mfma_f32_16x16x32_bf16 v[216:219], v[144:147], v[236:239], v[216:219]
v_mfma_f32_16x16x32_bf16 v[220:223], v[124:127], v[232:235], v[220:223]
v_mfma_f32_16x16x32_bf16 v[220:223], v[148:151], v[236:239], v[220:223]
v_mfma_f32_16x16x32_bf16 v[224:227], v[128:131], v[232:235], v[224:227]
v_mfma_f32_16x16x32_bf16 v[224:227], v[152:155], v[236:239], v[224:227]
v_mfma_f32_16x16x32_bf16 v[228:231], v[132:135], v[232:235], v[228:231]
v_mfma_f32_16x16x32_bf16 v[228:231], v[156:159], v[236:239], v[228:231]
s_waitcnt lgkmcnt(1)
v_mfma_f32_16x16x32_bf16 v[208:211], v[160:163], v[240:243], v[208:211]
s_waitcnt lgkmcnt(0)
v_mfma_f32_16x16x32_bf16 v[208:211], v[184:187], v[244:247], v[208:211]
v_mfma_f32_16x16x32_bf16 v[212:215], v[164:167], v[240:243], v[212:215]
v_mfma_f32_16x16x32_bf16 v[212:215], v[188:191], v[244:247], v[212:215]
v_mfma_f32_16x16x32_bf16 v[216:219], v[168:171], v[240:243], v[216:219]
v_mfma_f32_16x16x32_bf16 v[216:219], v[192:195], v[244:247], v[216:219]
v_mfma_f32_16x16x32_bf16 v[220:223], v[172:175], v[240:243], v[220:223]
v_mfma_f32_16x16x32_bf16 v[220:223], v[196:199], v[244:247], v[220:223]
v_mfma_f32_16x16x32_bf16 v[224:227], v[176:179], v[240:243], v[224:227]
v_mfma_f32_16x16x32_bf16 v[224:227], v[200:203], v[244:247], v[224:227]
v_mfma_f32_16x16x32_bf16 v[228:231], v[180:183], v[240:243], v[228:231]
s_nop 0
v_cvt_pk_bf16_f32 v0, v208, v212
v_cvt_pk_bf16_f32 v3, v209, v213
v_mfma_f32_16x16x32_bf16 v[228:231], v[204:207], v[244:247], v[228:231]
v_cvt_pk_bf16_f32 v6, v210, v214
v_cvt_pk_bf16_f32 v9, v211, v215
v_cvt_pk_bf16_f32 v1, v216, v220
v_cvt_pk_bf16_f32 v4, v217, v221
v_cvt_pk_bf16_f32 v7, v218, v222
v_cvt_pk_bf16_f32 v10, v219, v223
s_nop 0
s_nop 0
v_cvt_pk_bf16_f32 v2, v224, v228
v_cvt_pk_bf16_f32 v5, v225, v229
v_cvt_pk_bf16_f32 v8, v226, v230
v_cvt_pk_bf16_f32 v11, v227, v231
buffer_store_dwordx4 v[0:3], v13, s[40:43], s62 offen sc0 sc1
buffer_store_dwordx4 v[4:7], v14, s[40:43], s62 offen sc0 sc1
buffer_store_dwordx4 v[8:11], v15, s[40:43], s62 offen sc0 sc1
s_add_u32 s62, s62, 2048
s_mov_b64 exec, 1
ds_add_u32 v249, v248 offset:12
s_mov_b64 exec, -1
s_branch L_red
.p2align 6
L_compute:
s_lshr_b32 s58, s50, 1
s_and_b32 s59, s50, 1
v_lshrrev_b32 v253, 4, v252
v_and_b32 v254, 3, v252
v_and_b32 v255, 1, v253
v_xor_b32 v248, v254, v255
v_lshlrev_b32 v248, 4, v248
v_lshl_add_u32 v248, v253, 12, v248
v_and_b32 v249, 1, v254
v_lshl_add_u32 v248, v249, 3, v248
v_bfe_u32 v249, v252, 2, 2
v_lshl_add_u32 v248, v249, 6, v248
L_pg3:
s_cbranch_execz L_ret
s_lshl_b32 s60, s58, 10
v_add_u32 v248, s60, v248
v_xor_b32 v249, 8, v248
v_add_u32 v214, 102400, v248
v_add_u32 v215, 102400, v249
v_bfe_u32 v250, v252, 2, 2
v_sub_u32 v250, 0, v250
v_and_b32 v250, 3, v250
v_xor_b32 v250, v250, v253
v_lshlrev_b32 v250, 4, v250
v_and_b32 v254, 7, v252
v_lshl_add_u32 v250, v254, 6, v250
v_bfe_u32 v254, v252, 3, 1
v_lshl_add_u32 v250, v254, 10, v250
s_mul_i32 s60, s59, 6144
s_add_u32 s60, s60, 65536
v_add_u32 v250, s60, v250
v_mov_b32 v216, 0
v_and_b32 v228, 3, v252
v_cmp_eq_u32 vcc, 0, v228
v_mov_b32 v229, 0x3f803f80
v_cndmask_b32 v228, 0, v229, vcc
v_mov_b32 v229, v228
v_mov_b32 v230, v228
v_mov_b32 v231, v228
s_mov_b32 s56, 0x3e0293ee
s_mov_b32 s57, 0x3e0293ee
s_waitcnt lgkmcnt(0)
s_mov_b32 s24, s6
s_and_b32 s25, s7, 0xffff
s_mov_b32 s26, 0x2000000
s_mov_b32 s27, 0x20000
s_mov_b32 s28, s8
s_and_b32 s29, s9, 0xffff
s_mov_b32 s30, 0x2000000
s_mov_b32 s31, 0x20000
s_mov_b32 s36, s12
s_and_b32 s37, s13, 0xffff
s_mov_b32 s38, 0x480000
s_mov_b32 s39, 0x20000
s_mov_b32 s40, s18
s_and_b32 s41, s19, 0xffff
s_mov_b32 s42, 0x10000000
s_mov_b32 s43, 0x20000
s_mov_b32 s44, s14
s_and_b32 s45, s15, 0xffff
s_mov_b32 s46, 0x1b0000
s_mov_b32 s47, 0x20000
s_mov_b32 s96, s16
s_and_b32 s97, s17, 0xffff
s_mov_b32 s98, 0x100
s_mov_b32 s99, 0x20000
s_lshr_b32 s54, s64, 10
s_add_u32 s54, s54, 67108864
s_cmp_lg_u32 s50, 0
s_cbranch_scc1 L_noclr
v_lshlrev_b32 v254, 4, v252
v_mov_b32 v217, 0
v_mov_b32 v218, 0
v_mov_b32 v219, 0
s_lshr_b32 s58, s64, 7
s_add_u32 s58, s58, 67108864
buffer_store_dwordx4 v[216:219], v254, s[40:43], s58 offen sc0 sc1
s_mov_b64 exec, -1
L_noclr:
s_mov_b64 exec, 0
s_cmp_eq_u32 s50, 0
s_cbranch_scc1 L_t1_0
s_cmp_eq_u32 s50, 1
s_cbranch_scc1 L_t1_1
s_cmp_eq_u32 s50, 2
s_cbranch_scc1 L_t1_2
L_t1_3:
s_call_b64 s[100:101], L_pg7
s_nop 0
s_mov_b64 exec, -1
s_branch L_te1
L_t1_0:
s_call_b64 s[100:101], L_pg6
s_nop 0
s_mov_b64 exec, -1
s_branch L_te1
L_t1_1:
s_call_b64 s[100:101], L_pg5
s_call_b64 s[100:101], L_pg9
s_mov_b64 exec, -1
s_branch L_te1
L_t1_2:
s_call_b64 s[100:101], L_pg2
s_call_b64 s[100:101], L_pg8
s_mov_b64 exec, -1
L_te1:
s_barrier
ds_read_b128 v[144:147], v250 offset:0
ds_read_b128 v[148:151], v250 offset:2048
ds_read_b128 v[152:155], v250 offset:4096
ds_read_b64_tr_b16 v[232:233], v248 offset:0
ds_read_b64_tr_b16 v[234:235], v248 offset:2048
ds_read_b64_tr_b16 v[236:237], v249 offset:0
ds_read_b64_tr_b16 v[238:239], v249 offset:2048
ds_read_b64_tr_b16 v[240:241], v248 offset:256
ds_read_b64_tr_b16 v[242:243], v248 offset:2304
ds_read_b64_tr_b16 v[244:245], v249 offset:256
ds_read_b64_tr_b16 v[246:247], v249 offset:2304
s_waitcnt lgkmcnt(6)
v_mfma_f32_16x16x32_bf16 v[0:3], v[232:235], v[144:147], 0
v_mfma_f32_16x16x32_bf16 v[4:7], v[232:235], v[148:151], 0
v_mfma_f32_16x16x32_bf16 v[8:11], v[232:235], v[152:155], 0
ds_read_b64_tr_b16 v[232:233], v248 offset:512
s_waitcnt lgkmcnt(5)
v_mfma_f32_16x16x32_bf16 v[12:15], v[236:239], v[144:147], 0
ds_read_b64_tr_b16 v[234:235], v248 offset:2560
v_mfma_f32_16x16x32_bf16 v[16:19], v[236:239], v[148:151], 0
v_mfma_f32_16x16x32_bf16 v[20:23], v[236:239], v[152:155], 0
ds_read_b64_tr_b16 v[236:237], v249 offset:512
s_waitcnt lgkmcnt(5)
v_mfma_f32_16x16x32_bf16 v[24:27], v[240:243], v[144:147], 0
ds_read_b64_tr_b16 v[238:239], v249 offset:2560
v_mfma_f32_16x16x32_bf16 v[28:31], v[240:243], v[148:151], 0
v_mfma_f32_16x16x32_bf16 v[32:35], v[240:243], v[152:155], 0
ds_read_b64_tr_b16 v[240:241], v248 offset:768
s_waitcnt lgkmcnt(5)
v_mfma_f32_16x16x32_bf16 v[36:39], v[244:247], v[144:147], 0
ds_read_b64_tr_b16 v[242:243], v248 offset:2816
v_mfma_f32_16x16x32_bf16 v[40:43], v[244:247], v[148:151], 0
s_barrier
v_mfma_f32_16x16x32_bf16 v[44:47], v[244:247], v[152:155], 0
ds_read_b64_tr_b16 v[244:245], v249 offset:768
s_waitcnt lgkmcnt(5)
v_mfma_f32_16x16x32_bf16 v[48:51], v[232:235], v[144:147], 0
ds_read_b64_tr_b16 v[246:247], v249 offset:2816
v_mfma_f32_16x16x32_bf16 v[52:55], v[232:235], v[148:151], 0
ds_read_b128 v[156:159], v250 offset:512
v_mfma_f32_16x16x32_bf16 v[56:59], v[232:235], v[152:155], 0
ds_read_b64_tr_b16 v[232:233], v248 offset:16384
s_waitcnt lgkmcnt(6)
v_mfma_f32_16x16x32_bf16 v[60:63], v[236:239], v[144:147], 0
ds_read_b64_tr_b16 v[234:235], v248 offset:18432
v_mfma_f32_16x16x32_bf16 v[64:67], v[236:239], v[148:151], 0
ds_read_b128 v[160:163], v250 offset:2560
v_mfma_f32_16x16x32_bf16 v[68:71], v[236:239], v[152:155], 0
ds_read_b64_tr_b16 v[236:237], v249 offset:16384
s_waitcnt lgkmcnt(7)
v_mfma_f32_16x16x32_bf16 v[72:75], v[240:243], v[144:147], 0
ds_read_b64_tr_b16 v[238:239], v249 offset:18432
v_mfma_f32_16x16x32_bf16 v[76:79], v[240:243], v[148:151], 0
ds_read_b128 v[164:167], v250 offset:4608
v_mfma_f32_16x16x32_bf16 v[80:83], v[240:243], v[152:155], 0
ds_read_b64_tr_b16 v[240:241], v248 offset:16640
s_waitcnt lgkmcnt(8)
v_mfma_f32_16x16x32_bf16 v[84:87], v[244:247], v[144:147], 0
ds_read_b64_tr_b16 v[242:243], v248 offset:18688
v_mfma_f32_16x16x32_bf16 v[88:91], v[244:247], v[148:151], 0
v_mfma_f32_16x16x32_bf16 v[92:95], v[244:247], v[152:155], 0
ds_read_b64_tr_b16 v[244:245], v249 offset:16640
ds_read_b64_tr_b16 v[246:247], v249 offset:18688
s_waitcnt lgkmcnt(8)
v_mfma_f32_16x16x32_bf16 v[0:3], v[232:235], v[156:159], v[0:3]
s_waitcnt lgkmcnt(7)
v_mfma_f32_16x16x32_bf16 v[4:7], v[232:235], v[160:163], v[4:7]
s_waitcnt lgkmcnt(4)
v_mfma_f32_16x16x32_bf16 v[8:11], v[232:235], v[164:167], v[8:11]
ds_read_b64_tr_b16 v[232:233], v248 offset:16896
v_mfma_f32_16x16x32_bf16 v[12:15], v[236:239], v[156:159], v[12:15]
ds_read_b64_tr_b16 v[234:235], v248 offset:18944
v_mfma_f32_16x16x32_bf16 v[16:19], v[236:239], v[160:163], v[16:19]
v_mfma_f32_16x16x32_bf16 v[20:23], v[236:239], v[164:167], v[20:23]
ds_read_b64_tr_b16 v[236:237], v249 offset:16896
s_waitcnt lgkmcnt(5)
v_mfma_f32_16x16x32_bf16 v[24:27], v[240:243], v[156:159], v[24:27]
ds_read_b64_tr_b16 v[238:239], v249 offset:18944
v_mfma_f32_16x16x32_bf16 v[28:31], v[240:243], v[160:163], v[28:31]
v_mfma_f32_16x16x32_bf16 v[32:35], v[240:243], v[164:167], v[32:35]
ds_read_b64_tr_b16 v[240:241], v248 offset:17152
s_waitcnt lgkmcnt(5)
v_mfma_f32_16x16x32_bf16 v[36:39], v[244:247], v[156:159], v[36:39]
ds_read_b64_tr_b16 v[242:243], v248 offset:19200
v_mfma_f32_16x16x32_bf16 v[40:43], v[244:247], v[160:163], v[40:43]
s_barrier
v_mfma_f32_16x16x32_bf16 v[44:47], v[244:247], v[164:167], v[44:47]
ds_read_b64_tr_b16 v[244:245], v249 offset:17152
s_waitcnt lgkmcnt(5)
v_mfma_f32_16x16x32_bf16 v[48:51], v[232:235], v[156:159], v[48:51]
ds_read_b64_tr_b16 v[246:247], v249 offset:19200
v_mfma_f32_16x16x32_bf16 v[52:55], v[232:235], v[160:163], v[52:55]
ds_read_b128 v[144:147], v250 offset:12288
v_mfma_f32_16x16x32_bf16 v[56:59], v[232:235], v[164:167], v[56:59]
ds_read_b64_tr_b16 v[232:233], v248 offset:32768
s_waitcnt lgkmcnt(6)
v_mfma_f32_16x16x32_bf16 v[60:63], v[236:239], v[156:159], v[60:63]
ds_read_b64_tr_b16 v[234:235], v248 offset:34816
v_mfma_f32_16x16x32_bf16 v[64:67], v[236:239], v[160:163], v[64:67]
ds_read_b128 v[148:151], v250 offset:14336
v_mfma_f32_16x16x32_bf16 v[68:71], v[236:239], v[164:167], v[68:71]
ds_read_b64_tr_b16 v[236:237], v249 offset:32768
s_waitcnt lgkmcnt(7)
v_mfma_f32_16x16x32_bf16 v[72:75], v[240:243], v[156:159], v[72:75]
ds_read_b64_tr_b16 v[238:239], v249 offset:34816
v_mfma_f32_16x16x32_bf16 v[76:79], v[240:243], v[160:163], v[76:79]
ds_read_b128 v[152:155], v250 offset:16384
v_mfma_f32_16x16x32_bf16 v[80:83], v[240:243], v[164:167], v[80:83]
ds_read_b64_tr_b16 v[240:241], v248 offset:33024
s_waitcnt lgkmcnt(8)
v_mfma_f32_16x16x32_bf16 v[84:87], v[244:247], v[156:159], v[84:87]
ds_read_b64_tr_b16 v[242:243], v248 offset:35072
v_mfma_f32_16x16x32_bf16 v[88:91], v[244:247], v[160:163], v[88:91]
v_mfma_f32_16x16x32_bf16 v[92:95], v[244:247], v[164:167], v[92:95]
ds_read_b64_tr_b16 v[244:245], v249 offset:33024
ds_read_b64_tr_b16 v[246:247], v249 offset:35072
s_waitcnt lgkmcnt(8)
v_mfma_f32_16x16x32_bf16 v[0:3], v[232:235], v[144:147], v[0:3]
s_waitcnt lgkmcnt(7)
v_mfma_f32_16x16x32_bf16 v[4:7], v[232:235], v[148:151], v[4:7]
s_waitcnt lgkmcnt(4)
v_mfma_f32_16x16x32_bf16 v[8:11], v[232:235], v[152:155], v[8:11]
ds_read_b64_tr_b16 v[232:233], v248 offset:33280
v_mfma_f32_16x16x32_bf16 v[12:15], v[236:239], v[144:147], v[12:15]
ds_read_b64_tr_b16 v[234:235], v248 offset:35328
v_mfma_f32_16x16x32_bf16 v[16:19], v[236:239], v[148:151], v[16:19]
v_mfma_f32_16x16x32_bf16 v[20:23], v[236:239], v[152:155], v[20:23]
ds_read_b64_tr_b16 v[236:237], v249 offset:33280
s_waitcnt lgkmcnt(5)
v_mfma_f32_16x16x32_bf16 v[24:27], v[240:243], v[144:147], v[24:27]
ds_read_b64_tr_b16 v[238:239], v249 offset:35328
v_mfma_f32_16x16x32_bf16 v[28:31], v[240:243], v[148:151], v[28:31]
v_mfma_f32_16x16x32_bf16 v[32:35], v[240:243], v[152:155], v[32:35]
ds_read_b64_tr_b16 v[240:241], v248 offset:33536
s_waitcnt lgkmcnt(5)
v_mfma_f32_16x16x32_bf16 v[36:39], v[244:247], v[144:147], v[36:39]
ds_read_b64_tr_b16 v[242:243], v248 offset:35584
v_mfma_f32_16x16x32_bf16 v[40:43], v[244:247], v[148:151], v[40:43]
s_barrier
v_mfma_f32_16x16x32_bf16 v[44:47], v[244:247], v[152:155], v[44:47]
ds_read_b64_tr_b16 v[244:245], v249 offset:33536
s_waitcnt lgkmcnt(5)
v_mfma_f32_16x16x32_bf16 v[48:51], v[232:235], v[144:147], v[48:51]
ds_read_b64_tr_b16 v[246:247], v249 offset:35584
v_mfma_f32_16x16x32_bf16 v[52:55], v[232:235], v[148:151], v[52:55]
ds_read_b128 v[156:159], v250 offset:12800
v_mfma_f32_16x16x32_bf16 v[56:59], v[232:235], v[152:155], v[56:59]
ds_read_b64_tr_b16 v[232:233], v248 offset:49152
s_waitcnt lgkmcnt(6)
v_mfma_f32_16x16x32_bf16 v[60:63], v[236:239], v[144:147], v[60:63]
ds_read_b64_tr_b16 v[234:235], v248 offset:51200
v_mfma_f32_16x16x32_bf16 v[64:67], v[236:239], v[148:151], v[64:67]
ds_read_b128 v[160:163], v250 offset:14848
v_mfma_f32_16x16x32_bf16 v[68:71], v[236:239], v[152:155], v[68:71]
ds_read_b64_tr_b16 v[236:237], v249 offset:49152
s_waitcnt lgkmcnt(7)
v_mfma_f32_16x16x32_bf16 v[72:75], v[240:243], v[144:147], v[72:75]
ds_read_b64_tr_b16 v[238:239], v249 offset:51200
v_mfma_f32_16x16x32_bf16 v[76:79], v[240:243], v[148:151], v[76:79]
ds_read_b128 v[164:167], v250 offset:16896
v_mfma_f32_16x16x32_bf16 v[80:83], v[240:243], v[152:155], v[80:83]
ds_read_b64_tr_b16 v[240:241], v248 offset:49408
s_waitcnt lgkmcnt(8)
v_mfma_f32_16x16x32_bf16 v[84:87], v[244:247], v[144:147], v[84:87]
ds_read_b64_tr_b16 v[242:243], v248 offset:51456
v_mfma_f32_16x16x32_bf16 v[88:91], v[244:247], v[148:151], v[88:91]
v_mfma_f32_16x16x32_bf16 v[92:95], v[244:247], v[152:155], v[92:95]
ds_read_b64_tr_b16 v[244:245], v249 offset:49408
ds_read_b64_tr_b16 v[246:247], v249 offset:51456
s_waitcnt lgkmcnt(8)
v_mfma_f32_16x16x32_bf16 v[0:3], v[232:235], v[156:159], v[0:3]
s_waitcnt lgkmcnt(7)
v_mfma_f32_16x16x32_bf16 v[4:7], v[232:235], v[160:163], v[4:7]
s_waitcnt lgkmcnt(4)
v_mfma_f32_16x16x32_bf16 v[8:11], v[232:235], v[164:167], v[8:11]
ds_read_b64_tr_b16 v[232:233], v248 offset:49664
v_mfma_f32_16x16x32_bf16 v[12:15], v[236:239], v[156:159], v[12:15]
ds_read_b64_tr_b16 v[234:235], v248 offset:51712
v_mfma_f32_16x16x32_bf16 v[16:19], v[236:239], v[160:163], v[16:19]
v_mfma_f32_16x16x32_bf16 v[20:23], v[236:239], v[164:167], v[20:23]
ds_read_b64_tr_b16 v[236:237], v249 offset:49664
s_waitcnt lgkmcnt(5)
v_mfma_f32_16x16x32_bf16 v[24:27], v[240:243], v[156:159], v[24:27]
ds_read_b64_tr_b16 v[238:239], v249 offset:51712
v_mfma_f32_16x16x32_bf16 v[28:31], v[240:243], v[160:163], v[28:31]
v_mfma_f32_16x16x32_bf16 v[32:35], v[240:243], v[164:167], v[32:35]
ds_read_b64_tr_b16 v[240:241], v248 offset:49920
s_waitcnt lgkmcnt(5)
v_mfma_f32_16x16x32_bf16 v[36:39], v[244:247], v[156:159], v[36:39]
ds_read_b64_tr_b16 v[242:243], v248 offset:51968
v_mfma_f32_16x16x32_bf16 v[40:43], v[244:247], v[160:163], v[40:43]
s_barrier
v_mfma_f32_16x16x32_bf16 v[44:47], v[244:247], v[164:167], v[44:47]
ds_read_b64_tr_b16 v[244:245], v249 offset:49920
s_waitcnt lgkmcnt(5)
v_mfma_f32_16x16x32_bf16 v[48:51], v[232:235], v[156:159], v[48:51]
ds_read_b64_tr_b16 v[246:247], v249 offset:51968
v_mfma_f32_16x16x32_bf16 v[52:55], v[232:235], v[160:163], v[52:55]
ds_read_b128 v[144:147], v250 offset:24576
v_mfma_f32_16x16x32_bf16 v[56:59], v[232:235], v[164:167], v[56:59]
ds_read_b64_tr_b16 v[232:233], v214 offset:4096
s_waitcnt lgkmcnt(6)
v_mfma_f32_16x16x32_bf16 v[60:63], v[236:239], v[156:159], v[60:63]
ds_read_b64_tr_b16 v[234:235], v214 offset:6144
v_mfma_f32_16x16x32_bf16 v[64:67], v[236:239], v[160:163], v[64:67]
ds_read_b128 v[148:151], v250 offset:26624
v_mfma_f32_16x16x32_bf16 v[68:71], v[236:239], v[164:167], v[68:71]
ds_read_b64_tr_b16 v[236:237], v215 offset:4096
s_waitcnt lgkmcnt(7)
v_mfma_f32_16x16x32_bf16 v[72:75], v[240:243], v[156:159], v[72:75]
ds_read_b64_tr_b16 v[238:239], v215 offset:6144
v_mfma_f32_16x16x32_bf16 v[76:79], v[240:243], v[160:163], v[76:79]
ds_read_b128 v[152:155], v250 offset:28672
v_mfma_f32_16x16x32_bf16 v[80:83], v[240:243], v[164:167], v[80:83]
ds_read_b64_tr_b16 v[240:241], v214 offset:4352
s_waitcnt lgkmcnt(8)
v_mfma_f32_16x16x32_bf16 v[84:87], v[244:247], v[156:159], v[84:87]
ds_read_b64_tr_b16 v[242:243], v214 offset:6400
v_mfma_f32_16x16x32_bf16 v[88:91], v[244:247], v[160:163], v[88:91]
v_mfma_f32_16x16x32_bf16 v[92:95], v[244:247], v[164:167], v[92:95]
ds_read_b64_tr_b16 v[244:245], v215 offset:4352
ds_read_b64_tr_b16 v[246:247], v215 offset:6400
s_waitcnt lgkmcnt(8)
v_mfma_f32_16x16x32_bf16 v[0:3], v[232:235], v[144:147], v[0:3]
s_waitcnt lgkmcnt(7)
v_mfma_f32_16x16x32_bf16 v[4:7], v[232:235], v[148:151], v[4:7]
s_waitcnt lgkmcnt(4)
v_mfma_f32_16x16x32_bf16 v[8:11], v[232:235], v[152:155], v[8:11]
ds_read_b64_tr_b16 v[232:233], v214 offset:4608
v_mfma_f32_16x16x32_bf16 v[12:15], v[236:239], v[144:147], v[12:15]
ds_read_b64_tr_b16 v[234:235], v214 offset:6656
v_mfma_f32_16x16x32_bf16 v[16:19], v[236:239], v[148:151], v[16:19]
v_mfma_f32_16x16x32_bf16 v[20:23], v[236:239], v[152:155], v[20:23]
ds_read_b64_tr_b16 v[236:237], v215 offset:4608
s_waitcnt lgkmcnt(5)
v_mfma_f32_16x16x32_bf16 v[24:27], v[240:243], v[144:147], v[24:27]
ds_read_b64_tr_b16 v[238:239], v215 offset:6656
v_mfma_f32_16x16x32_bf16 v[28:31], v[240:243], v[148:151], v[28:31]
v_mfma_f32_16x16x32_bf16 v[32:35], v[240:243], v[152:155], v[32:35]
ds_read_b64_tr_b16 v[240:241], v214 offset:4864
s_waitcnt lgkmcnt(5)
v_mfma_f32_16x16x32_bf16 v[36:39], v[244:247], v[144:147], v[36:39]
ds_read_b64_tr_b16 v[242:243], v214 offset:6912
v_mfma_f32_16x16x32_bf16 v[40:43], v[244:247], v[148:151], v[40:43]
s_barrier
v_mfma_f32_16x16x32_bf16 v[44:47], v[244:247], v[152:155], v[44:47]
ds_read_b64_tr_b16 v[244:245], v215 offset:4864
s_waitcnt lgkmcnt(5)
v_mfma_f32_16x16x32_bf16 v[48:51], v[232:235], v[144:147], v[48:51]
ds_read_b64_tr_b16 v[246:247], v215 offset:6912
v_mfma_f32_16x16x32_bf16 v[52:55], v[232:235], v[148:151], v[52:55]
ds_read_b128 v[156:159], v250 offset:25088
v_mfma_f32_16x16x32_bf16 v[56:59], v[232:235], v[152:155], v[56:59]
ds_read_b64_tr_b16 v[232:233], v214 offset:28672
s_waitcnt lgkmcnt(6)
v_mfma_f32_16x16x32_bf16 v[60:63], v[236:239], v[144:147], v[60:63]
ds_read_b64_tr_b16 v[234:235], v214 offset:30720
v_mfma_f32_16x16x32_bf16 v[64:67], v[236:239], v[148:151], v[64:67]
ds_read_b128 v[160:163], v250 offset:27136
v_mfma_f32_16x16x32_bf16 v[68:71], v[236:239], v[152:155], v[68:71]
ds_read_b64_tr_b16 v[236:237], v215 offset:28672
s_waitcnt lgkmcnt(7)
v_mfma_f32_16x16x32_bf16 v[72:75], v[240:243], v[144:147], v[72:75]
ds_read_b64_tr_b16 v[238:239], v215 offset:30720
v_mfma_f32_16x16x32_bf16 v[76:79], v[240:243], v[148:151], v[76:79]
ds_read_b128 v[164:167], v250 offset:29184
v_mfma_f32_16x16x32_bf16 v[80:83], v[240:243], v[152:155], v[80:83]
ds_read_b64_tr_b16 v[240:241], v214 offset:28928
s_waitcnt lgkmcnt(8)
v_mfma_f32_16x16x32_bf16 v[84:87], v[244:247], v[144:147], v[84:87]
ds_read_b64_tr_b16 v[242:243], v214 offset:30976
v_mfma_f32_16x16x32_bf16 v[88:91], v[244:247], v[148:151], v[88:91]
v_mfma_f32_16x16x32_bf16 v[92:95], v[244:247], v[152:155], v[92:95]
ds_read_b64_tr_b16 v[244:245], v215 offset:28928
ds_read_b64_tr_b16 v[246:247], v215 offset:30976
s_waitcnt lgkmcnt(8)
v_mfma_f32_16x16x32_bf16 v[0:3], v[232:235], v[156:159], v[0:3]
s_waitcnt lgkmcnt(7)
v_mfma_f32_16x16x32_bf16 v[4:7], v[232:235], v[160:163], v[4:7]
s_waitcnt lgkmcnt(4)
v_mfma_f32_16x16x32_bf16 v[8:11], v[232:235], v[164:167], v[8:11]
ds_read_b64_tr_b16 v[232:233], v214 offset:29184
v_mfma_f32_16x16x32_bf16 v[12:15], v[236:239], v[156:159], v[12:15]
ds_read_b64_tr_b16 v[234:235], v214 offset:31232
v_mfma_f32_16x16x32_bf16 v[16:19], v[236:239], v[160:163], v[16:19]
v_mfma_f32_16x16x32_bf16 v[20:23], v[236:239], v[164:167], v[20:23]
ds_read_b64_tr_b16 v[236:237], v215 offset:29184
s_waitcnt lgkmcnt(5)
v_mfma_f32_16x16x32_bf16 v[24:27], v[240:243], v[156:159], v[24:27]
ds_read_b64_tr_b16 v[238:239], v215 offset:31232
v_mfma_f32_16x16x32_bf16 v[28:31], v[240:243], v[160:163], v[28:31]
v_mfma_f32_16x16x32_bf16 v[32:35], v[240:243], v[164:167], v[32:35]
ds_read_b64_tr_b16 v[240:241], v214 offset:29440
s_waitcnt lgkmcnt(5)
v_mfma_f32_16x16x32_bf16 v[36:39], v[244:247], v[156:159], v[36:39]
ds_read_b64_tr_b16 v[242:243], v214 offset:31488
v_mfma_f32_16x16x32_bf16 v[40:43], v[244:247], v[160:163], v[40:43]
s_barrier
v_mfma_f32_16x16x32_bf16 v[44:47], v[244:247], v[164:167], v[44:47]
ds_read_b64_tr_b16 v[244:245], v215 offset:29440
s_waitcnt lgkmcnt(5)
v_mfma_f32_16x16x32_bf16 v[48:51], v[232:235], v[156:159], v[48:51]
ds_read_b64_tr_b16 v[246:247], v215 offset:31488
v_mfma_f32_16x16x32_bf16 v[52:55], v[232:235], v[160:163], v[52:55]
ds_read_b128 v[144:147], v250 offset:0
v_mfma_f32_16x16x32_bf16 v[56:59], v[232:235], v[164:167], v[56:59]
ds_read_b64_tr_b16 v[232:233], v214 offset:45056
s_waitcnt lgkmcnt(6)
v_mfma_f32_16x16x32_bf16 v[60:63], v[236:239], v[156:159], v[60:63]
ds_read_b64_tr_b16 v[234:235], v214 offset:47104
v_mfma_f32_16x16x32_bf16 v[64:67], v[236:239], v[160:163], v[64:67]
ds_read_b128 v[148:151], v250 offset:2048
v_mfma_f32_16x16x32_bf16 v[68:71], v[236:239], v[164:167], v[68:71]
ds_read_b64_tr_b16 v[236:237], v215 offset:45056
s_waitcnt lgkmcnt(7)
v_mfma_f32_16x16x32_bf16 v[72:75], v[240:243], v[156:159], v[72:75]
ds_read_b64_tr_b16 v[238:239], v215 offset:47104
v_mfma_f32_16x16x32_bf16 v[76:79], v[240:243], v[160:163], v[76:79]
ds_read_b128 v[152:155], v250 offset:4096
v_mfma_f32_16x16x32_bf16 v[80:83], v[240:243], v[164:167], v[80:83]
ds_read_b64_tr_b16 v[240:241], v214 offset:45312
s_waitcnt lgkmcnt(8)
v_mfma_f32_16x16x32_bf16 v[84:87], v[244:247], v[156:159], v[84:87]
ds_read_b64_tr_b16 v[242:243], v214 offset:47360
v_mfma_f32_16x16x32_bf16 v[88:91], v[244:247], v[160:163], v[88:91]
v_mfma_f32_16x16x32_bf16 v[92:95], v[244:247], v[164:167], v[92:95]
ds_read_b64_tr_b16 v[244:245], v215 offset:45312
ds_read_b64_tr_b16 v[246:247], v215 offset:47360
s_waitcnt lgkmcnt(8)
v_mfma_f32_16x16x32_bf16 v[0:3], v[232:235], v[144:147], v[0:3]
s_waitcnt lgkmcnt(7)
v_mfma_f32_16x16x32_bf16 v[4:7], v[232:235], v[148:151], v[4:7]
s_waitcnt lgkmcnt(4)
v_mfma_f32_16x16x32_bf16 v[8:11], v[232:235], v[152:155], v[8:11]
ds_read_b64_tr_b16 v[232:233], v214 offset:45568
v_mfma_f32_16x16x32_bf16 v[12:15], v[236:239], v[144:147], v[12:15]
ds_read_b64_tr_b16 v[234:235], v214 offset:47616
v_mfma_f32_16x16x32_bf16 v[16:19], v[236:239], v[148:151], v[16:19]
v_mfma_f32_16x16x32_bf16 v[20:23], v[236:239], v[152:155], v[20:23]
ds_read_b64_tr_b16 v[236:237], v215 offset:45568
s_waitcnt lgkmcnt(5)
v_mfma_f32_16x16x32_bf16 v[24:27], v[240:243], v[144:147], v[24:27]
ds_read_b64_tr_b16 v[238:239], v215 offset:47616
v_mfma_f32_16x16x32_bf16 v[28:31], v[240:243], v[148:151], v[28:31]
v_mfma_f32_16x16x32_bf16 v[32:35], v[240:243], v[152:155], v[32:35]
ds_read_b64_tr_b16 v[240:241], v214 offset:45824
s_waitcnt lgkmcnt(5)
v_mfma_f32_16x16x32_bf16 v[36:39], v[244:247], v[144:147], v[36:39]
ds_read_b64_tr_b16 v[242:243], v214 offset:47872
v_mfma_f32_16x16x32_bf16 v[40:43], v[244:247], v[148:151], v[40:43]
s_barrier
v_mfma_f32_16x16x32_bf16 v[44:47], v[244:247], v[152:155], v[44:47]
ds_read_b64_tr_b16 v[244:245], v215 offset:45824
s_waitcnt lgkmcnt(5)
v_mfma_f32_16x16x32_bf16 v[48:51], v[232:235], v[144:147], v[48:51]
ds_read_b64_tr_b16 v[246:247], v215 offset:47872
v_mfma_f32_16x16x32_bf16 v[52:55], v[232:235], v[148:151], v[52:55]
ds_read_b128 v[156:159], v250 offset:512
v_mfma_f32_16x16x32_bf16 v[56:59], v[232:235], v[152:155], v[56:59]
ds_read_b64_tr_b16 v[232:233], v248 offset:0
s_waitcnt lgkmcnt(6)
v_mfma_f32_16x16x32_bf16 v[60:63], v[236:239], v[144:147], v[60:63]
ds_read_b64_tr_b16 v[234:235], v248 offset:2048
v_mfma_f32_16x16x32_bf16 v[64:67], v[236:239], v[148:151], v[64:67]
ds_read_b128 v[160:163], v250 offset:2560
v_mfma_f32_16x16x32_bf16 v[68:71], v[236:239], v[152:155], v[68:71]
ds_read_b64_tr_b16 v[236:237], v249 offset:0
s_waitcnt lgkmcnt(7)
v_mfma_f32_16x16x32_bf16 v[72:75], v[240:243], v[144:147], v[72:75]
ds_read_b64_tr_b16 v[238:239], v249 offset:2048
v_mfma_f32_16x16x32_bf16 v[76:79], v[240:243], v[148:151], v[76:79]
ds_read_b128 v[164:167], v250 offset:4608
v_mfma_f32_16x16x32_bf16 v[80:83], v[240:243], v[152:155], v[80:83]
ds_read_b64_tr_b16 v[240:241], v248 offset:256
s_waitcnt lgkmcnt(8)
v_mfma_f32_16x16x32_bf16 v[84:87], v[244:247], v[144:147], v[84:87]
ds_read_b64_tr_b16 v[242:243], v248 offset:2304
v_mfma_f32_16x16x32_bf16 v[88:91], v[244:247], v[148:151], v[88:91]
v_mfma_f32_16x16x32_bf16 v[92:95], v[244:247], v[152:155], v[92:95]
ds_read_b64_tr_b16 v[244:245], v249 offset:256
ds_read_b64_tr_b16 v[246:247], v249 offset:2304
s_waitcnt lgkmcnt(8)
v_mfma_f32_16x16x32_bf16 v[0:3], v[232:235], v[156:159], v[0:3]
s_waitcnt lgkmcnt(7)
v_mfma_f32_16x16x32_bf16 v[4:7], v[232:235], v[160:163], v[4:7]
s_waitcnt lgkmcnt(4)
v_mfma_f32_16x16x32_bf16 v[8:11], v[232:235], v[164:167], v[8:11]
ds_read_b64_tr_b16 v[232:233], v248 offset:512
v_mfma_f32_16x16x32_bf16 v[12:15], v[236:239], v[156:159], v[12:15]
ds_read_b64_tr_b16 v[234:235], v248 offset:2560
v_mfma_f32_16x16x32_bf16 v[16:19], v[236:239], v[160:163], v[16:19]
v_mfma_f32_16x16x32_bf16 v[20:23], v[236:239], v[164:167], v[20:23]
ds_read_b64_tr_b16 v[236:237], v249 offset:512
s_waitcnt lgkmcnt(5)
v_mfma_f32_16x16x32_bf16 v[24:27], v[240:243], v[156:159], v[24:27]
ds_read_b64_tr_b16 v[238:239], v249 offset:2560
v_mfma_f32_16x16x32_bf16 v[28:31], v[240:243], v[160:163], v[28:31]
v_mfma_f32_16x16x32_bf16 v[32:35], v[240:243], v[164:167], v[32:35]
ds_read_b64_tr_b16 v[240:241], v248 offset:768
s_waitcnt lgkmcnt(5)
v_mfma_f32_16x16x32_bf16 v[36:39], v[244:247], v[156:159], v[36:39]
ds_read_b64_tr_b16 v[242:243], v248 offset:2816
v_mfma_f32_16x16x32_bf16 v[40:43], v[244:247], v[160:163], v[40:43]
s_barrier
v_mfma_f32_16x16x32_bf16 v[44:47], v[244:247], v[164:167], v[44:47]
ds_read_b64_tr_b16 v[244:245], v249 offset:768
s_waitcnt lgkmcnt(5)
v_mfma_f32_16x16x32_bf16 v[48:51], v[232:235], v[156:159], v[48:51]
ds_read_b64_tr_b16 v[246:247], v249 offset:2816
v_mfma_f32_16x16x32_bf16 v[52:55], v[232:235], v[160:163], v[52:55]
ds_read_b128 v[144:147], v250 offset:12288
v_mfma_f32_16x16x32_bf16 v[56:59], v[232:235], v[164:167], v[56:59]
ds_read_b64_tr_b16 v[232:233], v248 offset:16384
s_waitcnt lgkmcnt(6)
v_mfma_f32_16x16x32_bf16 v[60:63], v[236:239], v[156:159], v[60:63]
ds_read_b64_tr_b16 v[234:235], v248 offset:18432
v_mfma_f32_16x16x32_bf16 v[64:67], v[236:239], v[160:163], v[64:67]
ds_read_b128 v[148:151], v250 offset:14336
v_mfma_f32_16x16x32_bf16 v[68:71], v[236:239], v[164:167], v[68:71]
ds_read_b64_tr_b16 v[236:237], v249 offset:16384
s_waitcnt lgkmcnt(7)
v_mfma_f32_16x16x32_bf16 v[72:75], v[240:243], v[156:159], v[72:75]
ds_read_b64_tr_b16 v[238:239], v249 offset:18432
v_mfma_f32_16x16x32_bf16 v[76:79], v[240:243], v[160:163], v[76:79]
ds_read_b128 v[152:155], v250 offset:16384
v_mfma_f32_16x16x32_bf16 v[80:83], v[240:243], v[164:167], v[80:83]
ds_read_b64_tr_b16 v[240:241], v248 offset:16640
s_waitcnt lgkmcnt(8)
v_mfma_f32_16x16x32_bf16 v[84:87], v[244:247], v[156:159], v[84:87]
ds_read_b64_tr_b16 v[242:243], v248 offset:18688
v_mfma_f32_16x16x32_bf16 v[88:91], v[244:247], v[160:163], v[88:91]
v_mfma_f32_16x16x32_bf16 v[92:95], v[244:247], v[164:167], v[92:95]
ds_read_b64_tr_b16 v[244:245], v249 offset:16640
ds_read_b64_tr_b16 v[246:247], v249 offset:18688
s_waitcnt lgkmcnt(8)
v_mfma_f32_16x16x32_bf16 v[0:3], v[232:235], v[144:147], v[0:3]
s_waitcnt lgkmcnt(7)
v_mfma_f32_16x16x32_bf16 v[4:7], v[232:235], v[148:151], v[4:7]
s_waitcnt lgkmcnt(4)
v_mfma_f32_16x16x32_bf16 v[8:11], v[232:235], v[152:155], v[8:11]
ds_read_b64_tr_b16 v[232:233], v248 offset:16896
v_mfma_f32_16x16x32_bf16 v[12:15], v[236:239], v[144:147], v[12:15]
ds_read_b64_tr_b16 v[234:235], v248 offset:18944
v_mfma_f32_16x16x32_bf16 v[16:19], v[236:239], v[148:151], v[16:19]
v_mfma_f32_16x16x32_bf16 v[20:23], v[236:239], v[152:155], v[20:23]
ds_read_b64_tr_b16 v[236:237], v249 offset:16896
s_waitcnt lgkmcnt(5)
v_mfma_f32_16x16x32_bf16 v[24:27], v[240:243], v[144:147], v[24:27]
ds_read_b64_tr_b16 v[238:239], v249 offset:18944
v_mfma_f32_16x16x32_bf16 v[28:31], v[240:243], v[148:151], v[28:31]
v_mfma_f32_16x16x32_bf16 v[32:35], v[240:243], v[152:155], v[32:35]
ds_read_b64_tr_b16 v[240:241], v248 offset:17152
s_waitcnt lgkmcnt(5)
v_mfma_f32_16x16x32_bf16 v[36:39], v[244:247], v[144:147], v[36:39]
ds_read_b64_tr_b16 v[242:243], v248 offset:19200
v_mfma_f32_16x16x32_bf16 v[40:43], v[244:247], v[148:151], v[40:43]
s_barrier
v_mfma_f32_16x16x32_bf16 v[44:47], v[244:247], v[152:155], v[44:47]
ds_read_b64_tr_b16 v[244:245], v249 offset:17152
s_waitcnt lgkmcnt(5)
v_mfma_f32_16x16x32_bf16 v[48:51], v[232:235], v[144:147], v[48:51]
ds_read_b64_tr_b16 v[246:247], v249 offset:19200
v_mfma_f32_16x16x32_bf16 v[52:55], v[232:235], v[148:151], v[52:55]
ds_read_b128 v[156:159], v250 offset:12800
v_mfma_f32_16x16x32_bf16 v[56:59], v[232:235], v[152:155], v[56:59]
ds_read_b64_tr_b16 v[232:233], v248 offset:32768
s_waitcnt lgkmcnt(6)
v_mfma_f32_16x16x32_bf16 v[60:63], v[236:239], v[144:147], v[60:63]
ds_read_b64_tr_b16 v[234:235], v248 offset:34816
v_mfma_f32_16x16x32_bf16 v[64:67], v[236:239], v[148:151], v[64:67]
ds_read_b128 v[160:163], v250 offset:14848
v_mfma_f32_16x16x32_bf16 v[68:71], v[236:239], v[152:155], v[68:71]
ds_read_b64_tr_b16 v[236:237], v249 offset:32768
s_waitcnt lgkmcnt(7)
v_mfma_f32_16x16x32_bf16 v[72:75], v[240:243], v[144:147], v[72:75]
ds_read_b64_tr_b16 v[238:239], v249 offset:34816
v_mfma_f32_16x16x32_bf16 v[76:79], v[240:243], v[148:151], v[76:79]
ds_read_b128 v[164:167], v250 offset:16896
v_mfma_f32_16x16x32_bf16 v[80:83], v[240:243], v[152:155], v[80:83]
ds_read_b64_tr_b16 v[240:241], v248 offset:33024
s_waitcnt lgkmcnt(8)
v_mfma_f32_16x16x32_bf16 v[84:87], v[244:247], v[144:147], v[84:87]
ds_read_b64_tr_b16 v[242:243], v248 offset:35072
v_mfma_f32_16x16x32_bf16 v[88:91], v[244:247], v[148:151], v[88:91]
v_mfma_f32_16x16x32_bf16 v[92:95], v[244:247], v[152:155], v[92:95]
ds_read_b64_tr_b16 v[244:245], v249 offset:33024
ds_read_b64_tr_b16 v[246:247], v249 offset:35072
s_waitcnt lgkmcnt(8)
v_mfma_f32_16x16x32_bf16 v[0:3], v[232:235], v[156:159], v[0:3]
s_waitcnt lgkmcnt(7)
v_mfma_f32_16x16x32_bf16 v[4:7], v[232:235], v[160:163], v[4:7]
s_waitcnt lgkmcnt(4)
v_mfma_f32_16x16x32_bf16 v[8:11], v[232:235], v[164:167], v[8:11]
ds_read_b64_tr_b16 v[232:233], v248 offset:33280
v_mfma_f32_16x16x32_bf16 v[12:15], v[236:239], v[156:159], v[12:15]
ds_read_b64_tr_b16 v[234:235], v248 offset:35328
v_mfma_f32_16x16x32_bf16 v[16:19], v[236:239], v[160:163], v[16:19]
v_mfma_f32_16x16x32_bf16 v[20:23], v[236:239], v[164:167], v[20:23]
L_pg4:
s_cbranch_execz L_ret
ds_read_b64_tr_b16 v[236:237], v249 offset:33280
s_waitcnt lgkmcnt(5)
v_mfma_f32_16x16x32_bf16 v[24:27], v[240:243], v[156:159], v[24:27]
ds_read_b64_tr_b16 v[238:239], v249 offset:35328
v_mfma_f32_16x16x32_bf16 v[28:31], v[240:243], v[160:163], v[28:31]
v_mfma_f32_16x16x32_bf16 v[32:35], v[240:243], v[164:167], v[32:35]
ds_read_b64_tr_b16 v[240:241], v248 offset:33536
s_waitcnt lgkmcnt(5)
v_mfma_f32_16x16x32_bf16 v[36:39], v[244:247], v[156:159], v[36:39]
ds_read_b64_tr_b16 v[242:243], v248 offset:35584
v_mfma_f32_16x16x32_bf16 v[40:43], v[244:247], v[160:163], v[40:43]
s_barrier
v_mfma_f32_16x16x32_bf16 v[44:47], v[244:247], v[164:167], v[44:47]
ds_read_b64_tr_b16 v[244:245], v249 offset:33536
s_waitcnt lgkmcnt(5)
v_mfma_f32_16x16x32_bf16 v[48:51], v[232:235], v[156:159], v[48:51]
ds_read_b64_tr_b16 v[246:247], v249 offset:35584
v_mfma_f32_16x16x32_bf16 v[52:55], v[232:235], v[160:163], v[52:55]
ds_read_b128 v[144:147], v250 offset:24576
v_mfma_f32_16x16x32_bf16 v[56:59], v[232:235], v[164:167], v[56:59]
ds_read_b64_tr_b16 v[232:233], v248 offset:49152
s_waitcnt lgkmcnt(6)
v_mfma_f32_16x16x32_bf16 v[60:63], v[236:239], v[156:159], v[60:63]
ds_read_b64_tr_b16 v[234:235], v248 offset:51200
v_mfma_f32_16x16x32_bf16 v[64:67], v[236:239], v[160:163], v[64:67]
ds_read_b128 v[148:151], v250 offset:26624
v_mfma_f32_16x16x32_bf16 v[68:71], v[236:239], v[164:167], v[68:71]
ds_read_b64_tr_b16 v[236:237], v249 offset:49152
s_waitcnt lgkmcnt(7)
v_mfma_f32_16x16x32_bf16 v[72:75], v[240:243], v[156:159], v[72:75]
ds_read_b64_tr_b16 v[238:239], v249 offset:51200
v_mfma_f32_16x16x32_bf16 v[76:79], v[240:243], v[160:163], v[76:79]
ds_read_b128 v[152:155], v250 offset:28672
v_mfma_f32_16x16x32_bf16 v[80:83], v[240:243], v[164:167], v[80:83]
ds_read_b64_tr_b16 v[240:241], v248 offset:49408
s_waitcnt lgkmcnt(8)
v_mfma_f32_16x16x32_bf16 v[84:87], v[244:247], v[156:159], v[84:87]
ds_read_b64_tr_b16 v[242:243], v248 offset:51456
v_mfma_f32_16x16x32_bf16 v[88:91], v[244:247], v[160:163], v[88:91]
v_mfma_f32_16x16x32_bf16 v[92:95], v[244:247], v[164:167], v[92:95]
ds_read_b64_tr_b16 v[244:245], v249 offset:49408
ds_read_b64_tr_b16 v[246:247], v249 offset:51456
s_waitcnt lgkmcnt(8)
v_mfma_f32_16x16x32_bf16 v[0:3], v[232:235], v[144:147], v[0:3]
s_waitcnt lgkmcnt(7)
v_mfma_f32_16x16x32_bf16 v[4:7], v[232:235], v[148:151], v[4:7]
s_waitcnt lgkmcnt(4)
v_mfma_f32_16x16x32_bf16 v[8:11], v[232:235], v[152:155], v[8:11]
ds_read_b64_tr_b16 v[232:233], v248 offset:49664
v_mfma_f32_16x16x32_bf16 v[12:15], v[236:239], v[144:147], v[12:15]
ds_read_b64_tr_b16 v[234:235], v248 offset:51712
v_mfma_f32_16x16x32_bf16 v[16:19], v[236:239], v[148:151], v[16:19]
v_mfma_f32_16x16x32_bf16 v[20:23], v[236:239], v[152:155], v[20:23]
ds_read_b64_tr_b16 v[236:237], v249 offset:49664
s_waitcnt lgkmcnt(5)
v_mfma_f32_16x16x32_bf16 v[24:27], v[240:243], v[144:147], v[24:27]
ds_read_b64_tr_b16 v[238:239], v249 offset:51712
v_mfma_f32_16x16x32_bf16 v[28:31], v[240:243], v[148:151], v[28:31]
v_mfma_f32_16x16x32_bf16 v[32:35], v[240:243], v[152:155], v[32:35]
ds_read_b64_tr_b16 v[240:241], v248 offset:49920
s_waitcnt lgkmcnt(5)
v_mfma_f32_16x16x32_bf16 v[36:39], v[244:247], v[144:147], v[36:39]
ds_read_b64_tr_b16 v[242:243], v248 offset:51968
v_mfma_f32_16x16x32_bf16 v[40:43], v[244:247], v[148:151], v[40:43]
s_barrier
v_mfma_f32_16x16x32_bf16 v[44:47], v[244:247], v[152:155], v[44:47]
ds_read_b64_tr_b16 v[244:245], v249 offset:49920
s_waitcnt lgkmcnt(5)
v_mfma_f32_16x16x32_bf16 v[48:51], v[232:235], v[144:147], v[48:51]
ds_read_b64_tr_b16 v[246:247], v249 offset:51968
v_mfma_f32_16x16x32_bf16 v[52:55], v[232:235], v[148:151], v[52:55]
ds_read_b128 v[156:159], v250 offset:25088
v_mfma_f32_16x16x32_bf16 v[56:59], v[232:235], v[152:155], v[56:59]
ds_read_b64_tr_b16 v[232:233], v214 offset:4096
s_waitcnt lgkmcnt(6)
v_mfma_f32_16x16x32_bf16 v[60:63], v[236:239], v[144:147], v[60:63]
ds_read_b64_tr_b16 v[234:235], v214 offset:6144
v_mfma_f32_16x16x32_bf16 v[64:67], v[236:239], v[148:151], v[64:67]
ds_read_b128 v[160:163], v250 offset:27136
v_mfma_f32_16x16x32_bf16 v[68:71], v[236:239], v[152:155], v[68:71]
ds_read_b64_tr_b16 v[236:237], v215 offset:4096
s_waitcnt lgkmcnt(7)
v_mfma_f32_16x16x32_bf16 v[72:75], v[240:243], v[144:147], v[72:75]
ds_read_b64_tr_b16 v[238:239], v215 offset:6144
v_mfma_f32_16x16x32_bf16 v[76:79], v[240:243], v[148:151], v[76:79]
ds_read_b128 v[164:167], v250 offset:29184
v_mfma_f32_16x16x32_bf16 v[80:83], v[240:243], v[152:155], v[80:83]
ds_read_b64_tr_b16 v[240:241], v214 offset:4352
s_waitcnt lgkmcnt(8)
v_mfma_f32_16x16x32_bf16 v[84:87], v[244:247], v[144:147], v[84:87]
ds_read_b64_tr_b16 v[242:243], v214 offset:6400
v_mfma_f32_16x16x32_bf16 v[88:91], v[244:247], v[148:151], v[88:91]
v_mfma_f32_16x16x32_bf16 v[92:95], v[244:247], v[152:155], v[92:95]
ds_read_b64_tr_b16 v[244:245], v215 offset:4352
ds_read_b64_tr_b16 v[246:247], v215 offset:6400
s_waitcnt lgkmcnt(8)
v_mfma_f32_16x16x32_bf16 v[0:3], v[232:235], v[156:159], v[0:3]
s_waitcnt lgkmcnt(7)
v_mfma_f32_16x16x32_bf16 v[4:7], v[232:235], v[160:163], v[4:7]
s_waitcnt lgkmcnt(4)
v_mfma_f32_16x16x32_bf16 v[8:11], v[232:235], v[164:167], v[8:11]
ds_read_b64_tr_b16 v[232:233], v214 offset:4608
v_mfma_f32_16x16x32_bf16 v[12:15], v[236:239], v[156:159], v[12:15]
ds_read_b64_tr_b16 v[234:235], v214 offset:6656
v_mfma_f32_16x16x32_bf16 v[16:19], v[236:239], v[160:163], v[16:19]
v_mfma_f32_16x16x32_bf16 v[20:23], v[236:239], v[164:167], v[20:23]
ds_read_b64_tr_b16 v[236:237], v215 offset:4608
s_waitcnt lgkmcnt(5)
v_mfma_f32_16x16x32_bf16 v[24:27], v[240:243], v[156:159], v[24:27]
ds_read_b64_tr_b16 v[238:239], v215 offset:6656
v_mfma_f32_16x16x32_bf16 v[28:31], v[240:243], v[160:163], v[28:31]
v_mfma_f32_16x16x32_bf16 v[32:35], v[240:243], v[164:167], v[32:35]
ds_read_b64_tr_b16 v[240:241], v214 offset:4864
s_waitcnt lgkmcnt(5)
v_mfma_f32_16x16x32_bf16 v[36:39], v[244:247], v[156:159], v[36:39]
ds_read_b64_tr_b16 v[242:243], v214 offset:6912
v_mfma_f32_16x16x32_bf16 v[40:43], v[244:247], v[160:163], v[40:43]
s_barrier
v_mfma_f32_16x16x32_bf16 v[44:47], v[244:247], v[164:167], v[44:47]
ds_read_b64_tr_b16 v[244:245], v215 offset:4864
s_waitcnt lgkmcnt(5)
v_mfma_f32_16x16x32_bf16 v[48:51], v[232:235], v[156:159], v[48:51]
ds_read_b64_tr_b16 v[246:247], v215 offset:6912
v_mfma_f32_16x16x32_bf16 v[52:55], v[232:235], v[160:163], v[52:55]
ds_read_b128 v[144:147], v250 offset:0
v_mfma_f32_16x16x32_bf16 v[56:59], v[232:235], v[164:167], v[56:59]
ds_read_b64_tr_b16 v[232:233], v214 offset:28672
s_waitcnt lgkmcnt(6)
v_mfma_f32_16x16x32_bf16 v[60:63], v[236:239], v[156:159], v[60:63]
ds_read_b64_tr_b16 v[234:235], v214 offset:30720
v_mfma_f32_16x16x32_bf16 v[64:67], v[236:239], v[160:163], v[64:67]
ds_read_b128 v[148:151], v250 offset:2048
v_mfma_f32_16x16x32_bf16 v[68:71], v[236:239], v[164:167], v[68:71]
ds_read_b64_tr_b16 v[236:237], v215 offset:28672
s_waitcnt lgkmcnt(7)
v_mfma_f32_16x16x32_bf16 v[72:75], v[240:243], v[156:159], v[72:75]
ds_read_b64_tr_b16 v[238:239], v215 offset:30720
v_mfma_f32_16x16x32_bf16 v[76:79], v[240:243], v[160:163], v[76:79]
ds_read_b128 v[152:155], v250 offset:4096
v_mfma_f32_16x16x32_bf16 v[80:83], v[240:243], v[164:167], v[80:83]
ds_read_b64_tr_b16 v[240:241], v214 offset:28928
s_waitcnt lgkmcnt(8)
v_mfma_f32_16x16x32_bf16 v[84:87], v[244:247], v[156:159], v[84:87]
ds_read_b64_tr_b16 v[242:243], v214 offset:30976
v_mfma_f32_16x16x32_bf16 v[88:91], v[244:247], v[160:163], v[88:91]
v_mfma_f32_16x16x32_bf16 v[92:95], v[244:247], v[164:167], v[92:95]
ds_read_b64_tr_b16 v[244:245], v215 offset:28928
ds_read_b64_tr_b16 v[246:247], v215 offset:30976
s_waitcnt lgkmcnt(8)
v_mfma_f32_16x16x32_bf16 v[0:3], v[232:235], v[144:147], v[0:3]
s_waitcnt lgkmcnt(7)
v_mfma_f32_16x16x32_bf16 v[4:7], v[232:235], v[148:151], v[4:7]
s_waitcnt lgkmcnt(4)
v_mfma_f32_16x16x32_bf16 v[8:11], v[232:235], v[152:155], v[8:11]
ds_read_b64_tr_b16 v[232:233], v214 offset:29184
v_mfma_f32_16x16x32_bf16 v[12:15], v[236:239], v[144:147], v[12:15]
ds_read_b64_tr_b16 v[234:235], v214 offset:31232
v_mfma_f32_16x16x32_bf16 v[16:19], v[236:239], v[148:151], v[16:19]
v_mfma_f32_16x16x32_bf16 v[20:23], v[236:239], v[152:155], v[20:23]
ds_read_b64_tr_b16 v[236:237], v215 offset:29184
s_waitcnt lgkmcnt(5)
v_mfma_f32_16x16x32_bf16 v[24:27], v[240:243], v[144:147], v[24:27]
ds_read_b64_tr_b16 v[238:239], v215 offset:31232
v_mfma_f32_16x16x32_bf16 v[28:31], v[240:243], v[148:151], v[28:31]
v_mfma_f32_16x16x32_bf16 v[32:35], v[240:243], v[152:155], v[32:35]
ds_read_b64_tr_b16 v[240:241], v214 offset:29440
s_waitcnt lgkmcnt(5)
v_mfma_f32_16x16x32_bf16 v[36:39], v[244:247], v[144:147], v[36:39]
ds_read_b64_tr_b16 v[242:243], v214 offset:31488
v_mfma_f32_16x16x32_bf16 v[40:43], v[244:247], v[148:151], v[40:43]
s_barrier
v_mfma_f32_16x16x32_bf16 v[44:47], v[244:247], v[152:155], v[44:47]
ds_read_b64_tr_b16 v[244:245], v215 offset:29440
s_waitcnt lgkmcnt(5)
v_mfma_f32_16x16x32_bf16 v[48:51], v[232:235], v[144:147], v[48:51]
ds_read_b64_tr_b16 v[246:247], v215 offset:31488
v_mfma_f32_16x16x32_bf16 v[52:55], v[232:235], v[148:151], v[52:55]
ds_read_b128 v[156:159], v250 offset:512
v_mfma_f32_16x16x32_bf16 v[56:59], v[232:235], v[152:155], v[56:59]
ds_read_b64_tr_b16 v[232:233], v214 offset:45056
s_waitcnt lgkmcnt(6)
v_mfma_f32_16x16x32_bf16 v[60:63], v[236:239], v[144:147], v[60:63]
ds_read_b64_tr_b16 v[234:235], v214 offset:47104
v_mfma_f32_16x16x32_bf16 v[64:67], v[236:239], v[148:151], v[64:67]
ds_read_b128 v[160:163], v250 offset:2560
v_mfma_f32_16x16x32_bf16 v[68:71], v[236:239], v[152:155], v[68:71]
ds_read_b64_tr_b16 v[236:237], v215 offset:45056
s_waitcnt lgkmcnt(7)
v_mfma_f32_16x16x32_bf16 v[72:75], v[240:243], v[144:147], v[72:75]
ds_read_b64_tr_b16 v[238:239], v215 offset:47104
v_mfma_f32_16x16x32_bf16 v[76:79], v[240:243], v[148:151], v[76:79]
ds_read_b128 v[164:167], v250 offset:4608
v_mfma_f32_16x16x32_bf16 v[80:83], v[240:243], v[152:155], v[80:83]
ds_read_b64_tr_b16 v[240:241], v214 offset:45312
s_waitcnt lgkmcnt(8)
v_mfma_f32_16x16x32_bf16 v[84:87], v[244:247], v[144:147], v[84:87]
ds_read_b64_tr_b16 v[242:243], v214 offset:47360
v_mfma_f32_16x16x32_bf16 v[88:91], v[244:247], v[148:151], v[88:91]
v_mfma_f32_16x16x32_bf16 v[92:95], v[244:247], v[152:155], v[92:95]
ds_read_b64_tr_b16 v[244:245], v215 offset:45312
ds_read_b64_tr_b16 v[246:247], v215 offset:47360
s_waitcnt lgkmcnt(8)
v_mfma_f32_16x16x32_bf16 v[0:3], v[232:235], v[156:159], v[0:3]
s_waitcnt lgkmcnt(7)
v_mfma_f32_16x16x32_bf16 v[4:7], v[232:235], v[160:163], v[4:7]
s_waitcnt lgkmcnt(4)
v_mfma_f32_16x16x32_bf16 v[8:11], v[232:235], v[164:167], v[8:11]
ds_read_b64_tr_b16 v[232:233], v214 offset:45568
v_mfma_f32_16x16x32_bf16 v[12:15], v[236:239], v[156:159], v[12:15]
ds_read_b64_tr_b16 v[234:235], v214 offset:47616
v_mfma_f32_16x16x32_bf16 v[16:19], v[236:239], v[160:163], v[16:19]
v_mfma_f32_16x16x32_bf16 v[20:23], v[236:239], v[164:167], v[20:23]
ds_read_b64_tr_b16 v[236:237], v215 offset:45568
s_waitcnt lgkmcnt(5)
v_mfma_f32_16x16x32_bf16 v[24:27], v[240:243], v[156:159], v[24:27]
ds_read_b64_tr_b16 v[238:239], v215 offset:47616
v_mfma_f32_16x16x32_bf16 v[28:31], v[240:243], v[160:163], v[28:31]
v_mfma_f32_16x16x32_bf16 v[32:35], v[240:243], v[164:167], v[32:35]
ds_read_b64_tr_b16 v[240:241], v214 offset:45824
s_waitcnt lgkmcnt(5)
v_mfma_f32_16x16x32_bf16 v[36:39], v[244:247], v[156:159], v[36:39]
ds_read_b64_tr_b16 v[242:243], v214 offset:47872
v_mfma_f32_16x16x32_bf16 v[40:43], v[244:247], v[160:163], v[40:43]
s_barrier
v_mfma_f32_16x16x32_bf16 v[44:47], v[244:247], v[164:167], v[44:47]
ds_read_b64_tr_b16 v[244:245], v215 offset:45824
s_waitcnt lgkmcnt(5)
v_mfma_f32_16x16x32_bf16 v[48:51], v[232:235], v[156:159], v[48:51]
ds_read_b64_tr_b16 v[246:247], v215 offset:47872
v_mfma_f32_16x16x32_bf16 v[52:55], v[232:235], v[160:163], v[52:55]
ds_read_b128 v[144:147], v250 offset:12288
v_mfma_f32_16x16x32_bf16 v[56:59], v[232:235], v[164:167], v[56:59]
ds_read_b64_tr_b16 v[232:233], v248 offset:0
s_waitcnt lgkmcnt(6)
v_mfma_f32_16x16x32_bf16 v[60:63], v[236:239], v[156:159], v[60:63]
ds_read_b64_tr_b16 v[234:235], v248 offset:2048
v_mfma_f32_16x16x32_bf16 v[64:67], v[236:239], v[160:163], v[64:67]
ds_read_b128 v[148:151], v250 offset:14336
v_mfma_f32_16x16x32_bf16 v[68:71], v[236:239], v[164:167], v[68:71]
ds_read_b64_tr_b16 v[236:237], v249 offset:0
s_waitcnt lgkmcnt(7)
v_mfma_f32_16x16x32_bf16 v[72:75], v[240:243], v[156:159], v[72:75]
ds_read_b64_tr_b16 v[238:239], v249 offset:2048
v_mfma_f32_16x16x32_bf16 v[76:79], v[240:243], v[160:163], v[76:79]
ds_read_b128 v[152:155], v250 offset:16384
v_mfma_f32_16x16x32_bf16 v[80:83], v[240:243], v[164:167], v[80:83]
ds_read_b64_tr_b16 v[240:241], v248 offset:256
s_waitcnt lgkmcnt(8)
v_mfma_f32_16x16x32_bf16 v[84:87], v[244:247], v[156:159], v[84:87]
ds_read_b64_tr_b16 v[242:243], v248 offset:2304
v_mfma_f32_16x16x32_bf16 v[88:91], v[244:247], v[160:163], v[88:91]
v_mfma_f32_16x16x32_bf16 v[92:95], v[244:247], v[164:167], v[92:95]
ds_read_b64_tr_b16 v[244:245], v249 offset:256
ds_read_b64_tr_b16 v[246:247], v249 offset:2304
s_waitcnt lgkmcnt(8)
v_mfma_f32_16x16x32_bf16 v[0:3], v[232:235], v[144:147], v[0:3]
s_waitcnt lgkmcnt(7)
v_mfma_f32_16x16x32_bf16 v[4:7], v[232:235], v[148:151], v[4:7]
s_waitcnt lgkmcnt(4)
v_mfma_f32_16x16x32_bf16 v[8:11], v[232:235], v[152:155], v[8:11]
ds_read_b64_tr_b16 v[232:233], v248 offset:512
v_mfma_f32_16x16x32_bf16 v[12:15], v[236:239], v[144:147], v[12:15]
ds_read_b64_tr_b16 v[234:235], v248 offset:2560
v_mfma_f32_16x16x32_bf16 v[16:19], v[236:239], v[148:151], v[16:19]
v_mfma_f32_16x16x32_bf16 v[20:23], v[236:239], v[152:155], v[20:23]
ds_read_b64_tr_b16 v[236:237], v249 offset:512
s_waitcnt lgkmcnt(5)
v_mfma_f32_16x16x32_bf16 v[24:27], v[240:243], v[144:147], v[24:27]
ds_read_b64_tr_b16 v[238:239], v249 offset:2560
v_mfma_f32_16x16x32_bf16 v[28:31], v[240:243], v[148:151], v[28:31]
v_mfma_f32_16x16x32_bf16 v[32:35], v[240:243], v[152:155], v[32:35]
ds_read_b64_tr_b16 v[240:241], v248 offset:768
s_waitcnt lgkmcnt(5)
v_mfma_f32_16x16x32_bf16 v[36:39], v[244:247], v[144:147], v[36:39]
ds_read_b64_tr_b16 v[242:243], v248 offset:2816
v_mfma_f32_16x16x32_bf16 v[40:43], v[244:247], v[148:151], v[40:43]
s_barrier
v_mfma_f32_16x16x32_bf16 v[44:47], v[244:247], v[152:155], v[44:47]
ds_read_b64_tr_b16 v[244:245], v249 offset:768
s_waitcnt lgkmcnt(5)
v_mfma_f32_16x16x32_bf16 v[48:51], v[232:235], v[144:147], v[48:51]
ds_read_b64_tr_b16 v[246:247], v249 offset:2816
v_mfma_f32_16x16x32_bf16 v[52:55], v[232:235], v[148:151], v[52:55]
ds_read_b128 v[156:159], v250 offset:12800
v_mfma_f32_16x16x32_bf16 v[56:59], v[232:235], v[152:155], v[56:59]
ds_read_b64_tr_b16 v[232:233], v248 offset:16384
s_waitcnt lgkmcnt(6)
v_mfma_f32_16x16x32_bf16 v[60:63], v[236:239], v[144:147], v[60:63]
ds_read_b64_tr_b16 v[234:235], v248 offset:18432
v_mfma_f32_16x16x32_bf16 v[64:67], v[236:239], v[148:151], v[64:67]
ds_read_b128 v[160:163], v250 offset:14848
v_mfma_f32_16x16x32_bf16 v[68:71], v[236:239], v[152:155], v[68:71]
ds_read_b64_tr_b16 v[236:237], v249 offset:16384
s_waitcnt lgkmcnt(7)
v_mfma_f32_16x16x32_bf16 v[72:75], v[240:243], v[144:147], v[72:75]
ds_read_b64_tr_b16 v[238:239], v249 offset:18432
v_mfma_f32_16x16x32_bf16 v[76:79], v[240:243], v[148:151], v[76:79]
ds_read_b128 v[164:167], v250 offset:16896
v_mfma_f32_16x16x32_bf16 v[80:83], v[240:243], v[152:155], v[80:83]
ds_read_b64_tr_b16 v[240:241], v248 offset:16640
s_waitcnt lgkmcnt(8)
v_mfma_f32_16x16x32_bf16 v[84:87], v[244:247], v[144:147], v[84:87]
ds_read_b64_tr_b16 v[242:243], v248 offset:18688
v_mfma_f32_16x16x32_bf16 v[88:91], v[244:247], v[148:151], v[88:91]
v_mfma_f32_16x16x32_bf16 v[92:95], v[244:247], v[152:155], v[92:95]
ds_read_b64_tr_b16 v[244:245], v249 offset:16640
ds_read_b64_tr_b16 v[246:247], v249 offset:18688
s_waitcnt lgkmcnt(8)
v_mfma_f32_16x16x32_bf16 v[0:3], v[232:235], v[156:159], v[0:3]
s_waitcnt lgkmcnt(7)
v_mfma_f32_16x16x32_bf16 v[4:7], v[232:235], v[160:163], v[4:7]
s_waitcnt lgkmcnt(4)
v_mfma_f32_16x16x32_bf16 v[8:11], v[232:235], v[164:167], v[8:11]
ds_read_b64_tr_b16 v[232:233], v248 offset:16896
v_mfma_f32_16x16x32_bf16 v[12:15], v[236:239], v[156:159], v[12:15]
ds_read_b64_tr_b16 v[234:235], v248 offset:18944
v_mfma_f32_16x16x32_bf16 v[16:19], v[236:239], v[160:163], v[16:19]
v_mfma_f32_16x16x32_bf16 v[20:23], v[236:239], v[164:167], v[20:23]
ds_read_b64_tr_b16 v[236:237], v249 offset:16896
s_waitcnt lgkmcnt(5)
v_mfma_f32_16x16x32_bf16 v[24:27], v[240:243], v[156:159], v[24:27]
ds_read_b64_tr_b16 v[238:239], v249 offset:18944
v_mfma_f32_16x16x32_bf16 v[28:31], v[240:243], v[160:163], v[28:31]
v_mfma_f32_16x16x32_bf16 v[32:35], v[240:243], v[164:167], v[32:35]
ds_read_b64_tr_b16 v[240:241], v248 offset:17152
s_waitcnt lgkmcnt(5)
v_mfma_f32_16x16x32_bf16 v[36:39], v[244:247], v[156:159], v[36:39]
ds_read_b64_tr_b16 v[242:243], v248 offset:19200
v_mfma_f32_16x16x32_bf16 v[40:43], v[244:247], v[160:163], v[40:43]
s_barrier
v_mfma_f32_16x16x32_bf16 v[44:47], v[244:247], v[164:167], v[44:47]
ds_read_b64_tr_b16 v[244:245], v249 offset:17152
s_waitcnt lgkmcnt(5)
v_mfma_f32_16x16x32_bf16 v[48:51], v[232:235], v[156:159], v[48:51]
ds_read_b64_tr_b16 v[246:247], v249 offset:19200
v_mfma_f32_16x16x32_bf16 v[52:55], v[232:235], v[160:163], v[52:55]
ds_read_b128 v[144:147], v250 offset:24576
v_mfma_f32_16x16x32_bf16 v[56:59], v[232:235], v[164:167], v[56:59]
ds_read_b64_tr_b16 v[232:233], v248 offset:32768
s_waitcnt lgkmcnt(6)
v_mfma_f32_16x16x32_bf16 v[60:63], v[236:239], v[156:159], v[60:63]
ds_read_b64_tr_b16 v[234:235], v248 offset:34816
v_mfma_f32_16x16x32_bf16 v[64:67], v[236:239], v[160:163], v[64:67]
ds_read_b128 v[148:151], v250 offset:26624
v_mfma_f32_16x16x32_bf16 v[68:71], v[236:239], v[164:167], v[68:71]
ds_read_b64_tr_b16 v[236:237], v249 offset:32768
s_waitcnt lgkmcnt(7)
v_mfma_f32_16x16x32_bf16 v[72:75], v[240:243], v[156:159], v[72:75]
ds_read_b64_tr_b16 v[238:239], v249 offset:34816
v_mfma_f32_16x16x32_bf16 v[76:79], v[240:243], v[160:163], v[76:79]
ds_read_b128 v[152:155], v250 offset:28672
v_mfma_f32_16x16x32_bf16 v[80:83], v[240:243], v[164:167], v[80:83]
ds_read_b64_tr_b16 v[240:241], v248 offset:33024
s_waitcnt lgkmcnt(8)
v_mfma_f32_16x16x32_bf16 v[84:87], v[244:247], v[156:159], v[84:87]
ds_read_b64_tr_b16 v[242:243], v248 offset:35072
v_mfma_f32_16x16x32_bf16 v[88:91], v[244:247], v[160:163], v[88:91]
v_mfma_f32_16x16x32_bf16 v[92:95], v[244:247], v[164:167], v[92:95]
ds_read_b64_tr_b16 v[244:245], v249 offset:33024
ds_read_b64_tr_b16 v[246:247], v249 offset:35072
s_waitcnt lgkmcnt(8)
v_mfma_f32_16x16x32_bf16 v[0:3], v[232:235], v[144:147], v[0:3]
s_waitcnt lgkmcnt(7)
v_mfma_f32_16x16x32_bf16 v[4:7], v[232:235], v[148:151], v[4:7]
s_waitcnt lgkmcnt(4)
v_mfma_f32_16x16x32_bf16 v[8:11], v[232:235], v[152:155], v[8:11]
ds_read_b64_tr_b16 v[232:233], v248 offset:33280
v_mfma_f32_16x16x32_bf16 v[12:15], v[236:239], v[144:147], v[12:15]
ds_read_b64_tr_b16 v[234:235], v248 offset:35328
v_mfma_f32_16x16x32_bf16 v[16:19], v[236:239], v[148:151], v[16:19]
v_mfma_f32_16x16x32_bf16 v[20:23], v[236:239], v[152:155], v[20:23]
ds_read_b64_tr_b16 v[236:237], v249 offset:33280
s_waitcnt lgkmcnt(5)
v_mfma_f32_16x16x32_bf16 v[24:27], v[240:243], v[144:147], v[24:27]
ds_read_b64_tr_b16 v[238:239], v249 offset:35328
v_mfma_f32_16x16x32_bf16 v[28:31], v[240:243], v[148:151], v[28:31]
v_mfma_f32_16x16x32_bf16 v[32:35], v[240:243], v[152:155], v[32:35]
ds_read_b64_tr_b16 v[240:241], v248 offset:33536
s_waitcnt lgkmcnt(5)
v_mfma_f32_16x16x32_bf16 v[36:39], v[244:247], v[144:147], v[36:39]
ds_read_b64_tr_b16 v[242:243], v248 offset:35584
v_mfma_f32_16x16x32_bf16 v[40:43], v[244:247], v[148:151], v[40:43]
s_barrier
v_mfma_f32_16x16x32_bf16 v[44:47], v[244:247], v[152:155], v[44:47]
ds_read_b64_tr_b16 v[244:245], v249 offset:33536
s_waitcnt lgkmcnt(5)
v_mfma_f32_16x16x32_bf16 v[48:51], v[232:235], v[144:147], v[48:51]
ds_read_b64_tr_b16 v[246:247], v249 offset:35584
v_mfma_f32_16x16x32_bf16 v[52:55], v[232:235], v[148:151], v[52:55]
ds_read_b128 v[156:159], v250 offset:25088
v_mfma_f32_16x16x32_bf16 v[56:59], v[232:235], v[152:155], v[56:59]
ds_read_b64_tr_b16 v[232:233], v248 offset:49152
s_waitcnt lgkmcnt(6)
v_mfma_f32_16x16x32_bf16 v[60:63], v[236:239], v[144:147], v[60:63]
ds_read_b64_tr_b16 v[234:235], v248 offset:51200
v_mfma_f32_16x16x32_bf16 v[64:67], v[236:239], v[148:151], v[64:67]
ds_read_b128 v[160:163], v250 offset:27136
v_mfma_f32_16x16x32_bf16 v[68:71], v[236:239], v[152:155], v[68:71]
ds_read_b64_tr_b16 v[236:237], v249 offset:49152
s_waitcnt lgkmcnt(7)
v_mfma_f32_16x16x32_bf16 v[72:75], v[240:243], v[144:147], v[72:75]
ds_read_b64_tr_b16 v[238:239], v249 offset:51200
v_mfma_f32_16x16x32_bf16 v[76:79], v[240:243], v[148:151], v[76:79]
ds_read_b128 v[164:167], v250 offset:29184
v_mfma_f32_16x16x32_bf16 v[80:83], v[240:243], v[152:155], v[80:83]
ds_read_b64_tr_b16 v[240:241], v248 offset:49408
s_waitcnt lgkmcnt(8)
v_mfma_f32_16x16x32_bf16 v[84:87], v[244:247], v[144:147], v[84:87]
ds_read_b64_tr_b16 v[242:243], v248 offset:51456
v_mfma_f32_16x16x32_bf16 v[88:91], v[244:247], v[148:151], v[88:91]
v_mfma_f32_16x16x32_bf16 v[92:95], v[244:247], v[152:155], v[92:95]
ds_read_b64_tr_b16 v[244:245], v249 offset:49408
ds_read_b64_tr_b16 v[246:247], v249 offset:51456
s_waitcnt lgkmcnt(8)
v_mfma_f32_16x16x32_bf16 v[0:3], v[232:235], v[156:159], v[0:3]
s_waitcnt lgkmcnt(7)
v_mfma_f32_16x16x32_bf16 v[4:7], v[232:235], v[160:163], v[4:7]
s_waitcnt lgkmcnt(4)
v_mfma_f32_16x16x32_bf16 v[8:11], v[232:235], v[164:167], v[8:11]
ds_read_b64_tr_b16 v[232:233], v248 offset:49664
v_mfma_f32_16x16x32_bf16 v[12:15], v[236:239], v[156:159], v[12:15]
ds_read_b64_tr_b16 v[234:235], v248 offset:51712
v_mfma_f32_16x16x32_bf16 v[16:19], v[236:239], v[160:163], v[16:19]
v_mfma_f32_16x16x32_bf16 v[20:23], v[236:239], v[164:167], v[20:23]
ds_read_b64_tr_b16 v[236:237], v249 offset:49664
s_waitcnt lgkmcnt(5)
v_mfma_f32_16x16x32_bf16 v[24:27], v[240:243], v[156:159], v[24:27]
ds_read_b64_tr_b16 v[238:239], v249 offset:51712
v_mfma_f32_16x16x32_bf16 v[28:31], v[240:243], v[160:163], v[28:31]
v_mfma_f32_16x16x32_bf16 v[32:35], v[240:243], v[164:167], v[32:35]
ds_read_b64_tr_b16 v[240:241], v248 offset:49920
s_waitcnt lgkmcnt(5)
v_mfma_f32_16x16x32_bf16 v[36:39], v[244:247], v[156:159], v[36:39]
ds_read_b64_tr_b16 v[242:243], v248 offset:51968
v_mfma_f32_16x16x32_bf16 v[40:43], v[244:247], v[160:163], v[40:43]
s_barrier
v_mfma_f32_16x16x32_bf16 v[44:47], v[244:247], v[164:167], v[44:47]
ds_read_b64_tr_b16 v[244:245], v249 offset:49920
s_waitcnt lgkmcnt(5)
v_mfma_f32_16x16x32_bf16 v[48:51], v[232:235], v[156:159], v[48:51]
ds_read_b64_tr_b16 v[246:247], v249 offset:51968
v_mfma_f32_16x16x32_bf16 v[52:55], v[232:235], v[160:163], v[52:55]
v_mfma_f32_16x16x32_bf16 v[56:59], v[232:235], v[164:167], v[56:59]
s_waitcnt lgkmcnt(4)
v_mfma_f32_16x16x32_bf16 v[60:63], v[236:239], v[156:159], v[60:63]
v_mfma_f32_16x16x32_bf16 v[64:67], v[236:239], v[160:163], v[64:67]
v_mfma_f32_16x16x32_bf16 v[68:71], v[236:239], v[164:167], v[68:71]
s_waitcnt lgkmcnt(2)
v_mfma_f32_16x16x32_bf16 v[72:75], v[240:243], v[156:159], v[72:75]
v_mfma_f32_16x16x32_bf16 v[76:79], v[240:243], v[160:163], v[76:79]
v_mfma_f32_16x16x32_bf16 v[80:83], v[240:243], v[164:167], v[80:83]
s_waitcnt lgkmcnt(0)
v_mfma_f32_16x16x32_bf16 v[84:87], v[244:247], v[156:159], v[84:87]
v_mfma_f32_16x16x32_bf16 v[88:91], v[244:247], v[160:163], v[88:91]
v_mfma_f32_16x16x32_bf16 v[92:95], v[244:247], v[164:167], v[92:95]
v_lshrrev_b32_e64 v253, 4, v252
v_bfe_u32 v254, v252, 2, 2
v_and_b32 v250, 3, v252
v_sub_u32 v251, 0, v254
v_and_b32 v251, 3, v251
v_xor_b32 v251, v251, v253
v_lshlrev_b32_e64 v251, 4, v251
v_lshl_add_u32 v251, v254, 10, v251
v_lshl_add_u32 v251, v250, 6, v251
v_lshlrev_b32_e64 v248, 3, v250
v_lshl_add_u32 v248, v254, 6, v248
v_lshl_add_u32 v248, v253, 10, v248
v_and_b32_e64 v253, 1, v253
v_lshl_add_u32 v248, v253, 5, v248
v_add_u32 v250, 0x20000, v251
v_add_u32 v251, 0x10000, v251
v_add_u32 v253, 0x20000, v248
v_add_u32 v248, 0x10000, v248
v_xor_b32 v254, 32, v253
v_xor_b32_e64 v249, 32, v248
s_waitcnt vmcnt(0)
s_mov_b32 vcc_lo, 0xffff0000
s_mov_b32 vcc_hi, 0xffff0000
v_pk_mul_f32 v[0:1], v[0:1], s[56:57]
v_pk_mul_f32 v[2:3], v[2:3], s[56:57]
v_pk_mul_f32 v[12:13], v[12:13], s[56:57]
v_pk_mul_f32 v[14:15], v[14:15], s[56:57]
v_cvt_pk_bf16_f32 v192, v0, v1
v_cvt_pk_bf16_f32 v193, v2, v3
v_cvt_pk_bf16_f32 v194, v12, v13
v_cvt_pk_bf16_f32 v195, v14, v15
v_cndmask_b32 v96, v192, v194, vcc
v_cndmask_b32 v97, v193, v195, vcc
v_cndmask_b32 v98, v194, v192, vcc
v_cndmask_b32 v99, v195, v193, vcc
v_pk_mul_f32 v[4:5], v[4:5], s[56:57]
v_pk_mul_f32 v[6:7], v[6:7], s[56:57]
v_pk_mul_f32 v[16:17], v[16:17], s[56:57]
v_pk_mul_f32 v[18:19], v[18:19], s[56:57]
v_cvt_pk_bf16_f32 v196, v4, v5
v_cvt_pk_bf16_f32 v197, v6, v7
v_cvt_pk_bf16_f32 v198, v16, v17
v_cvt_pk_bf16_f32 v199, v18, v19
v_cndmask_b32 v112, v196, v198, vcc
v_cndmask_b32 v113, v197, v199, vcc
v_cndmask_b32 v114, v198, v196, vcc
v_cndmask_b32 v115, v199, v197, vcc
v_pk_mul_f32 v[8:9], v[8:9], s[56:57]
v_pk_mul_f32 v[10:11], v[10:11], s[56:57]
v_pk_mul_f32 v[20:21], v[20:21], s[56:57]
v_pk_mul_f32 v[22:23], v[22:23], s[56:57]
v_cvt_pk_bf16_f32 v200, v8, v9
v_cvt_pk_bf16_f32 v201, v10, v11
v_cvt_pk_bf16_f32 v202, v20, v21
v_cvt_pk_bf16_f32 v203, v22, v23
v_cndmask_b32 v128, v200, v202, vcc
v_cndmask_b32 v129, v201, v203, vcc
v_cndmask_b32 v130, v202, v200, vcc
v_cndmask_b32 v131, v203, v201, vcc
v_pk_mul_f32 v[24:25], v[24:25], s[56:57]
v_pk_mul_f32 v[26:27], v[26:27], s[56:57]
v_pk_mul_f32 v[36:37], v[36:37], s[56:57]
v_pk_mul_f32 v[38:39], v[38:39], s[56:57]
v_cvt_pk_bf16_f32 v204, v24, v25
v_cvt_pk_bf16_f32 v205, v26, v27
v_cvt_pk_bf16_f32 v206, v36, v37
v_cvt_pk_bf16_f32 v207, v38, v39
v_cndmask_b32 v100, v204, v206, vcc
v_cndmask_b32 v101, v205, v207, vcc
v_cndmask_b32 v102, v206, v204, vcc
v_cndmask_b32 v103, v207, v205, vcc
v_pk_mul_f32 v[28:29], v[28:29], s[56:57]
v_pk_mul_f32 v[30:31], v[30:31], s[56:57]
v_pk_mul_f32 v[40:41], v[40:41], s[56:57]
v_pk_mul_f32 v[42:43], v[42:43], s[56:57]
v_cvt_pk_bf16_f32 v192, v28, v29
v_cvt_pk_bf16_f32 v193, v30, v31
v_cvt_pk_bf16_f32 v194, v40, v41
v_cvt_pk_bf16_f32 v195, v42, v43
v_cndmask_b32 v116, v192, v194, vcc
v_cndmask_b32 v117, v193, v195, vcc
v_cndmask_b32 v118, v194, v192, vcc
v_cndmask_b32 v119, v195, v193, vcc
v_pk_mul_f32 v[32:33], v[32:33], s[56:57]
v_pk_mul_f32 v[34:35], v[34:35], s[56:57]
v_pk_mul_f32 v[44:45], v[44:45], s[56:57]
v_pk_mul_f32 v[46:47], v[46:47], s[56:57]
v_cvt_pk_bf16_f32 v196, v32, v33
v_cvt_pk_bf16_f32 v197, v34, v35
v_cvt_pk_bf16_f32 v198, v44, v45
v_cvt_pk_bf16_f32 v199, v46, v47
v_cndmask_b32 v132, v196, v198, vcc
v_cndmask_b32 v133, v197, v199, vcc
v_cndmask_b32 v134, v198, v196, vcc
v_cndmask_b32 v135, v199, v197, vcc
v_pk_mul_f32 v[48:49], v[48:49], s[56:57]
v_pk_mul_f32 v[50:51], v[50:51], s[56:57]
v_pk_mul_f32 v[60:61], v[60:61], s[56:57]
v_pk_mul_f32 v[62:63], v[62:63], s[56:57]
v_cvt_pk_bf16_f32 v200, v48, v49
v_cvt_pk_bf16_f32 v201, v50, v51
v_cvt_pk_bf16_f32 v202, v60, v61
v_cvt_pk_bf16_f32 v203, v62, v63
v_cndmask_b32 v104, v200, v202, vcc
v_cndmask_b32 v105, v201, v203, vcc
v_cndmask_b32 v106, v202, v200, vcc
v_cndmask_b32 v107, v203, v201, vcc
v_pk_mul_f32 v[52:53], v[52:53], s[56:57]
v_pk_mul_f32 v[54:55], v[54:55], s[56:57]
v_pk_mul_f32 v[64:65], v[64:65], s[56:57]
v_pk_mul_f32 v[66:67], v[66:67], s[56:57]
v_cvt_pk_bf16_f32 v204, v52, v53
v_cvt_pk_bf16_f32 v205, v54, v55
v_cvt_pk_bf16_f32 v206, v64, v65
v_cvt_pk_bf16_f32 v207, v66, v67
v_cndmask_b32 v120, v204, v206, vcc
v_cndmask_b32 v121, v205, v207, vcc
v_cndmask_b32 v122, v206, v204, vcc
v_cndmask_b32 v123, v207, v205, vcc
L_pg5:
s_cbranch_execz L_ret
s_nop 0
v_pk_mul_f32 v[56:57], v[56:57], s[56:57]
v_pk_mul_f32 v[58:59], v[58:59], s[56:57]
v_pk_mul_f32 v[68:69], v[68:69], s[56:57]
v_pk_mul_f32 v[70:71], v[70:71], s[56:57]
v_cvt_pk_bf16_f32 v192, v56, v57
v_cvt_pk_bf16_f32 v193, v58, v59
v_cvt_pk_bf16_f32 v194, v68, v69
v_cvt_pk_bf16_f32 v195, v70, v71
v_cndmask_b32 v136, v192, v194, vcc
v_cndmask_b32 v137, v193, v195, vcc
v_cndmask_b32 v138, v194, v192, vcc
v_cndmask_b32 v139, v195, v193, vcc
v_pk_mul_f32 v[72:73], v[72:73], s[56:57]
v_pk_mul_f32 v[74:75], v[74:75], s[56:57]
v_pk_mul_f32 v[84:85], v[84:85], s[56:57]
v_pk_mul_f32 v[86:87], v[86:87], s[56:57]
v_cvt_pk_bf16_f32 v196, v72, v73
v_cvt_pk_bf16_f32 v197, v74, v75
v_cvt_pk_bf16_f32 v198, v84, v85
v_cvt_pk_bf16_f32 v199, v86, v87
v_cndmask_b32 v108, v196, v198, vcc
v_cndmask_b32 v109, v197, v199, vcc
v_cndmask_b32 v110, v198, v196, vcc
v_cndmask_b32 v111, v199, v197, vcc
v_pk_mul_f32 v[76:77], v[76:77], s[56:57]
v_pk_mul_f32 v[78:79], v[78:79], s[56:57]
v_pk_mul_f32 v[88:89], v[88:89], s[56:57]
v_pk_mul_f32 v[90:91], v[90:91], s[56:57]
v_cvt_pk_bf16_f32 v200, v76, v77
v_cvt_pk_bf16_f32 v201, v78, v79
v_cvt_pk_bf16_f32 v202, v88, v89
v_cvt_pk_bf16_f32 v203, v90, v91
v_cndmask_b32 v124, v200, v202, vcc
v_cndmask_b32 v125, v201, v203, vcc
v_cndmask_b32 v126, v202, v200, vcc
v_cndmask_b32 v127, v203, v201, vcc
v_pk_mul_f32 v[80:81], v[80:81], s[56:57]
v_pk_mul_f32 v[82:83], v[82:83], s[56:57]
v_pk_mul_f32 v[92:93], v[92:93], s[56:57]
v_pk_mul_f32 v[94:95], v[94:95], s[56:57]
v_cvt_pk_bf16_f32 v204, v80, v81
v_cvt_pk_bf16_f32 v205, v82, v83
v_cvt_pk_bf16_f32 v206, v92, v93
v_cvt_pk_bf16_f32 v207, v94, v95
v_cndmask_b32 v140, v204, v206, vcc
v_cndmask_b32 v141, v205, v207, vcc
v_cndmask_b32 v142, v206, v204, vcc
v_cndmask_b32 v143, v207, v205, vcc
s_barrier
ds_read_b128 v[232:235], v251 offset:40960
ds_read_b128 v[236:239], v251 offset:41216
ds_read_b128 v[240:243], v251 offset:41472
ds_read_b128 v[244:247], v251 offset:41728
s_cmp_lg_u32 s50, 0
s_cbranch_scc1 L_nostart
s_lshl_b32 s59, s48, 4
v_mov_b32 v0, 0
v_mov_b32 v1, 1
s_mov_b64 exec, 1
buffer_atomic_add v1, v0, s[96:99], s59 offen sc1
s_mov_b64 exec, -1
L_nostart:
s_waitcnt lgkmcnt(3)
v_mfma_f32_16x16x32_bf16 v[144:147], v[232:235], v[96:99], 0
v_mfma_f32_16x16x32_bf16 v[148:151], v[232:235], v[112:115], 0
v_mfma_f32_16x16x32_bf16 v[152:155], v[232:235], v[128:131], 0
ds_read_b128 v[232:235], v251 offset:45056
s_waitcnt lgkmcnt(3)
v_mfma_f32_16x16x32_bf16 v[144:147], v[236:239], v[100:103], v[144:147]
v_mfma_f32_16x16x32_bf16 v[148:151], v[236:239], v[116:119], v[148:151]
v_mfma_f32_16x16x32_bf16 v[152:155], v[236:239], v[132:135], v[152:155]
ds_read_b128 v[236:239], v251 offset:45312
s_waitcnt lgkmcnt(3)
v_mfma_f32_16x16x32_bf16 v[144:147], v[240:243], v[104:107], v[144:147]
v_mfma_f32_16x16x32_bf16 v[148:151], v[240:243], v[120:123], v[148:151]
v_mfma_f32_16x16x32_bf16 v[152:155], v[240:243], v[136:139], v[152:155]
ds_read_b128 v[240:243], v251 offset:45568
s_waitcnt lgkmcnt(3)
v_mfma_f32_16x16x32_bf16 v[144:147], v[244:247], v[108:111], v[144:147]
v_mfma_f32_16x16x32_bf16 v[148:151], v[244:247], v[124:127], v[148:151]
v_mfma_f32_16x16x32_bf16 v[152:155], v[244:247], v[140:143], v[152:155]
ds_read_b128 v[244:247], v251 offset:45824
s_waitcnt lgkmcnt(3)
v_mfma_f32_16x16x32_bf16 v[156:159], v[232:235], v[96:99], 0
v_mfma_f32_16x16x32_bf16 v[160:163], v[232:235], v[112:115], 0
s_barrier
v_mfma_f32_16x16x32_bf16 v[164:167], v[232:235], v[128:131], 0
ds_read_b128 v[232:235], v251 offset:57344
s_waitcnt lgkmcnt(3)
v_mfma_f32_16x16x32_bf16 v[156:159], v[236:239], v[100:103], v[156:159]
v_mfma_f32_16x16x32_bf16 v[160:163], v[236:239], v[116:119], v[160:163]
v_mfma_f32_16x16x32_bf16 v[164:167], v[236:239], v[132:135], v[164:167]
ds_read_b128 v[236:239], v251 offset:57600
s_waitcnt lgkmcnt(3)
v_mfma_f32_16x16x32_bf16 v[156:159], v[240:243], v[104:107], v[156:159]
v_mfma_f32_16x16x32_bf16 v[160:163], v[240:243], v[120:123], v[160:163]
v_mfma_f32_16x16x32_bf16 v[164:167], v[240:243], v[136:139], v[164:167]
ds_read_b128 v[240:243], v251 offset:57856
s_waitcnt lgkmcnt(3)
v_mfma_f32_16x16x32_bf16 v[156:159], v[244:247], v[108:111], v[156:159]
v_mfma_f32_16x16x32_bf16 v[160:163], v[244:247], v[124:127], v[160:163]
v_mfma_f32_16x16x32_bf16 v[164:167], v[244:247], v[140:143], v[164:167]
ds_read_b128 v[244:247], v251 offset:58112
s_waitcnt lgkmcnt(3)
v_mfma_f32_16x16x32_bf16 v[168:171], v[232:235], v[96:99], 0
v_exp_f32 v144, v144
v_exp_f32 v145, v145
v_mfma_f32_16x16x32_bf16 v[172:175], v[232:235], v[112:115], 0
v_exp_f32 v146, v146
v_exp_f32 v147, v147
v_mfma_f32_16x16x32_bf16 v[176:179], v[232:235], v[128:131], 0
ds_read_b128 v[232:235], v251 offset:61440
s_waitcnt lgkmcnt(3)
v_mfma_f32_16x16x32_bf16 v[168:171], v[236:239], v[100:103], v[168:171]
v_cvt_pk_bf16_f32 v192, v144, v145
v_exp_f32 v148, v148
v_mfma_f32_16x16x32_bf16 v[172:175], v[236:239], v[116:119], v[172:175]
v_exp_f32 v149, v149
v_cvt_pk_bf16_f32 v193, v146, v147
v_exp_f32 v150, v150
v_mfma_f32_16x16x32_bf16 v[176:179], v[236:239], v[132:135], v[176:179]
ds_read_b128 v[236:239], v251 offset:61696
s_waitcnt lgkmcnt(3)
v_mfma_f32_16x16x32_bf16 v[168:171], v[240:243], v[104:107], v[168:171]
v_exp_f32 v151, v151
v_cvt_pk_bf16_f32 v196, v148, v149
v_mfma_f32_16x16x32_bf16 v[172:175], v[240:243], v[120:123], v[172:175]
v_exp_f32 v152, v152
v_exp_f32 v153, v153
v_cvt_pk_bf16_f32 v197, v150, v151
v_mfma_f32_16x16x32_bf16 v[176:179], v[240:243], v[136:139], v[176:179]
ds_read_b128 v[240:243], v251 offset:61952
s_waitcnt lgkmcnt(3)
v_mfma_f32_16x16x32_bf16 v[168:171], v[244:247], v[108:111], v[168:171]
v_exp_f32 v154, v154
v_exp_f32 v155, v155
v_mfma_f32_16x16x32_bf16 v[172:175], v[244:247], v[124:127], v[172:175]
v_cvt_pk_bf16_f32 v200, v152, v153
v_exp_f32 v156, v156
v_mfma_f32_16x16x32_bf16 v[176:179], v[244:247], v[140:143], v[176:179]
ds_read_b128 v[244:247], v251 offset:62208
s_waitcnt lgkmcnt(3)
v_mfma_f32_16x16x32_bf16 v[180:183], v[232:235], v[96:99], 0
v_exp_f32 v157, v157
v_cvt_pk_bf16_f32 v201, v154, v155
v_exp_f32 v158, v158
v_mfma_f32_16x16x32_bf16 v[184:187], v[232:235], v[112:115], 0
s_barrier
v_mfma_f32_16x16x32_bf16 v[188:191], v[232:235], v[128:131], 0
ds_read_b128 v[232:235], v250 offset:8192
s_waitcnt lgkmcnt(3)
v_mfma_f32_16x16x32_bf16 v[180:183], v[236:239], v[100:103], v[180:183]
v_exp_f32 v159, v159
v_cvt_pk_bf16_f32 v194, v156, v157
v_mfma_f32_16x16x32_bf16 v[184:187], v[236:239], v[116:119], v[184:187]
v_exp_f32 v160, v160
v_exp_f32 v161, v161
v_cvt_pk_bf16_f32 v195, v158, v159
v_mfma_f32_16x16x32_bf16 v[188:191], v[236:239], v[132:135], v[188:191]
ds_read_b128 v[236:239], v250 offset:8448
s_waitcnt lgkmcnt(3)
v_mfma_f32_16x16x32_bf16 v[180:183], v[240:243], v[104:107], v[180:183]
v_exp_f32 v162, v162
v_exp_f32 v163, v163
v_mfma_f32_16x16x32_bf16 v[184:187], v[240:243], v[120:123], v[184:187]
v_cvt_pk_bf16_f32 v198, v160, v161
v_exp_f32 v164, v164
v_mfma_f32_16x16x32_bf16 v[188:191], v[240:243], v[136:139], v[188:191]
ds_read_b128 v[240:243], v250 offset:8704
s_waitcnt lgkmcnt(3)
v_mfma_f32_16x16x32_bf16 v[180:183], v[244:247], v[108:111], v[180:183]
v_exp_f32 v165, v165
v_cvt_pk_bf16_f32 v199, v162, v163
v_exp_f32 v166, v166
v_mfma_f32_16x16x32_bf16 v[184:187], v[244:247], v[124:127], v[184:187]
v_exp_f32 v167, v167
v_cvt_pk_bf16_f32 v202, v164, v165
s_nop 0
v_cvt_pk_bf16_f32 v203, v166, v167
v_mfma_f32_16x16x32_bf16 v[188:191], v[244:247], v[140:143], v[188:191]
ds_read_b128 v[244:247], v250 offset:8960
s_waitcnt lgkmcnt(3)
v_mfma_f32_16x16x32_bf16 v[144:147], v[232:235], v[96:99], 0
v_exp_f32 v168, v168
v_mfma_f32_16x16x32_bf16 v[148:151], v[232:235], v[112:115], 0
v_exp_f32 v169, v169
v_mfma_f32_16x16x32_bf16 v[152:155], v[232:235], v[128:131], 0
ds_read_b128 v[232:235], v250 offset:12288
s_waitcnt lgkmcnt(3)
v_mfma_f32_16x16x32_bf16 v[144:147], v[236:239], v[100:103], v[144:147]
v_exp_f32 v170, v170
v_mfma_f32_16x16x32_bf16 v[148:151], v[236:239], v[116:119], v[148:151]
v_exp_f32 v171, v171
v_mfma_f32_16x16x32_bf16 v[152:155], v[236:239], v[132:135], v[152:155]
ds_read_b128 v[236:239], v250 offset:12544
s_waitcnt lgkmcnt(3)
v_mfma_f32_16x16x32_bf16 v[144:147], v[240:243], v[104:107], v[144:147]
v_cvt_pk_bf16_f32 v204, v168, v169
v_mfma_f32_16x16x32_bf16 v[148:151], v[240:243], v[120:123], v[148:151]
v_exp_f32 v172, v172
v_mfma_f32_16x16x32_bf16 v[152:155], v[240:243], v[136:139], v[152:155]
ds_read_b128 v[240:243], v250 offset:12800
s_waitcnt lgkmcnt(3)
v_mfma_f32_16x16x32_bf16 v[144:147], v[244:247], v[108:111], v[144:147]
v_exp_f32 v173, v173
v_cvt_pk_bf16_f32 v205, v170, v171
v_mfma_f32_16x16x32_bf16 v[148:151], v[244:247], v[124:127], v[148:151]
v_exp_f32 v174, v174
v_mfma_f32_16x16x32_bf16 v[152:155], v[244:247], v[140:143], v[152:155]
ds_read_b128 v[244:247], v250 offset:13056
s_waitcnt lgkmcnt(3)
v_mfma_f32_16x16x32_bf16 v[156:159], v[232:235], v[96:99], 0
v_exp_f32 v175, v175
v_mfma_f32_16x16x32_bf16 v[160:163], v[232:235], v[112:115], 0
v_cvt_pk_bf16_f32 v208, v172, v173
v_mfma_f32_16x16x32_bf16 v[164:167], v[232:235], v[128:131], 0
ds_read_b64_tr_b16 v[232:233], v253 offset:0
s_waitcnt lgkmcnt(3)
v_mfma_f32_16x16x32_bf16 v[156:159], v[236:239], v[100:103], v[156:159]
ds_read_b64_tr_b16 v[234:235], v253 offset:4096
v_exp_f32 v176, v176
v_mfma_f32_16x16x32_bf16 v[160:163], v[236:239], v[116:119], v[160:163]
v_exp_f32 v177, v177
v_mfma_f32_16x16x32_bf16 v[164:167], v[236:239], v[132:135], v[164:167]
ds_read_b64_tr_b16 v[236:237], v254 offset:0
s_waitcnt lgkmcnt(4)
v_mfma_f32_16x16x32_bf16 v[156:159], v[240:243], v[104:107], v[156:159]
ds_read_b64_tr_b16 v[238:239], v254 offset:4096
v_cvt_pk_bf16_f32 v209, v174, v175
v_mfma_f32_16x16x32_bf16 v[160:163], v[240:243], v[120:123], v[160:163]
v_exp_f32 v178, v178
v_mfma_f32_16x16x32_bf16 v[164:167], v[240:243], v[136:139], v[164:167]
ds_read_b64_tr_b16 v[240:241], v253 offset:256
s_waitcnt lgkmcnt(5)
v_mfma_f32_16x16x32_bf16 v[156:159], v[244:247], v[108:111], v[156:159]
ds_read_b64_tr_b16 v[242:243], v253 offset:4352
v_mfma_f32_16x16x32_bf16 v[160:163], v[244:247], v[124:127], v[160:163]
v_exp_f32 v179, v179
v_cvt_pk_bf16_f32 v212, v176, v177
v_mfma_f32_16x16x32_bf16 v[164:167], v[244:247], v[140:143], v[164:167]
ds_read_b64_tr_b16 v[244:245], v254 offset:256
s_waitcnt lgkmcnt(5)
v_mfma_f32_16x16x32_bf16 v[0:3], v[232:235], v[192:195], 0
ds_read_b64_tr_b16 v[246:247], v254 offset:4352
v_mfma_f32_16x16x32_bf16 v[4:7], v[232:235], v[196:199], 0
v_exp_f32 v180, v180
v_mfma_f32_16x16x32_bf16 v[8:11], v[232:235], v[200:203], 0
ds_read_b64_tr_b16 v[232:233], v253 offset:512
s_waitcnt lgkmcnt(5)
v_mfma_f32_16x16x32_bf16 v[12:15], v[236:239], v[192:195], 0
ds_read_b64_tr_b16 v[234:235], v253 offset:4608
v_exp_f32 v181, v181
v_mfma_f32_16x16x32_bf16 v[16:19], v[236:239], v[196:199], 0
v_cvt_pk_bf16_f32 v213, v178, v179
v_mfma_f32_16x16x32_bf16 v[20:23], v[236:239], v[200:203], 0
ds_read_b64_tr_b16 v[236:237], v254 offset:512
s_waitcnt lgkmcnt(5)
v_mfma_f32_16x16x32_bf16 v[24:27], v[240:243], v[192:195], 0
ds_read_b64_tr_b16 v[238:239], v254 offset:4608
v_exp_f32 v182, v182
v_mfma_f32_16x16x32_bf16 v[28:31], v[240:243], v[196:199], 0
v_exp_f32 v183, v183
v_mfma_f32_16x16x32_bf16 v[32:35], v[240:243], v[200:203], 0
ds_read_b64_tr_b16 v[240:241], v253 offset:768
s_waitcnt lgkmcnt(5)
v_mfma_f32_16x16x32_bf16 v[36:39], v[244:247], v[192:195], 0
ds_read_b64_tr_b16 v[242:243], v253 offset:4864
v_cvt_pk_bf16_f32 v206, v180, v181
v_mfma_f32_16x16x32_bf16 v[40:43], v[244:247], v[196:199], 0
v_exp_f32 v184, v184
v_mfma_f32_16x16x32_bf16 v[44:47], v[244:247], v[200:203], 0
ds_read_b64_tr_b16 v[244:245], v254 offset:768
s_waitcnt lgkmcnt(5)
v_mfma_f32_16x16x32_bf16 v[48:51], v[232:235], v[192:195], 0
ds_read_b64_tr_b16 v[246:247], v254 offset:4864
v_mfma_f32_16x16x32_bf16 v[52:55], v[232:235], v[196:199], 0
s_barrier
v_mfma_f32_16x16x32_bf16 v[56:59], v[232:235], v[200:203], 0
ds_read_b128 v[232:235], v250 offset:24576
s_waitcnt lgkmcnt(5)
v_mfma_f32_16x16x32_bf16 v[60:63], v[236:239], v[192:195], 0
v_exp_f32 v185, v185
v_cvt_pk_bf16_f32 v207, v182, v183
v_mfma_f32_16x16x32_bf16 v[64:67], v[236:239], v[196:199], 0
v_exp_f32 v186, v186
v_mfma_f32_16x16x32_bf16 v[68:71], v[236:239], v[200:203], 0
ds_read_b128 v[236:239], v250 offset:24832
s_waitcnt lgkmcnt(4)
v_mfma_f32_16x16x32_bf16 v[72:75], v[240:243], v[192:195], 0
v_exp_f32 v187, v187
v_mfma_f32_16x16x32_bf16 v[76:79], v[240:243], v[196:199], 0
v_cvt_pk_bf16_f32 v210, v184, v185
v_mfma_f32_16x16x32_bf16 v[80:83], v[240:243], v[200:203], 0
ds_read_b128 v[240:243], v250 offset:25088
s_waitcnt lgkmcnt(3)
v_mfma_f32_16x16x32_bf16 v[84:87], v[244:247], v[192:195], 0
v_exp_f32 v188, v188
v_mfma_f32_16x16x32_bf16 v[88:91], v[244:247], v[196:199], 0
v_exp_f32 v189, v189
v_cvt_pk_bf16_f32 v211, v186, v187
v_mfma_f32_16x16x32_bf16 v[92:95], v[244:247], v[200:203], 0
ds_read_b128 v[244:247], v250 offset:25344
v_mfma_f32_16x16x32_bf16 v[216:219], v[228:231], v[192:195], 0
v_exp_f32 v190, v190
v_mfma_f32_16x16x32_bf16 v[220:223], v[228:231], v[196:199], 0
v_exp_f32 v191, v191
v_mfma_f32_16x16x32_bf16 v[224:227], v[228:231], v[200:203], 0
v_cvt_pk_bf16_f32 v214, v188, v189
s_nop 0
v_cvt_pk_bf16_f32 v215, v190, v191
s_waitcnt lgkmcnt(3)
v_mfma_f32_16x16x32_bf16 v[168:171], v[232:235], v[96:99], 0
v_exp_f32 v144, v144
v_mfma_f32_16x16x32_bf16 v[172:175], v[232:235], v[112:115], 0
v_exp_f32 v145, v145
v_mfma_f32_16x16x32_bf16 v[176:179], v[232:235], v[128:131], 0
ds_read_b128 v[232:235], v250 offset:28672
s_waitcnt lgkmcnt(3)
v_mfma_f32_16x16x32_bf16 v[168:171], v[236:239], v[100:103], v[168:171]
v_exp_f32 v146, v146
v_mfma_f32_16x16x32_bf16 v[172:175], v[236:239], v[116:119], v[172:175]
v_exp_f32 v147, v147
v_mfma_f32_16x16x32_bf16 v[176:179], v[236:239], v[132:135], v[176:179]
ds_read_b128 v[236:239], v250 offset:28928
s_waitcnt lgkmcnt(3)
v_mfma_f32_16x16x32_bf16 v[168:171], v[240:243], v[104:107], v[168:171]
v_cvt_pk_bf16_f32 v192, v144, v145
v_mfma_f32_16x16x32_bf16 v[172:175], v[240:243], v[120:123], v[172:175]
v_exp_f32 v148, v148
v_mfma_f32_16x16x32_bf16 v[176:179], v[240:243], v[136:139], v[176:179]
ds_read_b128 v[240:243], v250 offset:29184
s_waitcnt lgkmcnt(3)
v_mfma_f32_16x16x32_bf16 v[168:171], v[244:247], v[108:111], v[168:171]
v_exp_f32 v149, v149
v_cvt_pk_bf16_f32 v193, v146, v147
v_mfma_f32_16x16x32_bf16 v[172:175], v[244:247], v[124:127], v[172:175]
v_exp_f32 v150, v150
v_mfma_f32_16x16x32_bf16 v[176:179], v[244:247], v[140:143], v[176:179]
ds_read_b128 v[244:247], v250 offset:29440
s_waitcnt lgkmcnt(3)
v_mfma_f32_16x16x32_bf16 v[180:183], v[232:235], v[96:99], 0
v_exp_f32 v151, v151
v_mfma_f32_16x16x32_bf16 v[184:187], v[232:235], v[112:115], 0
v_cvt_pk_bf16_f32 v196, v148, v149
v_mfma_f32_16x16x32_bf16 v[188:191], v[232:235], v[128:131], 0
ds_read_b64_tr_b16 v[232:233], v253 offset:16384
s_waitcnt lgkmcnt(3)
v_mfma_f32_16x16x32_bf16 v[180:183], v[236:239], v[100:103], v[180:183]
ds_read_b64_tr_b16 v[234:235], v253 offset:20480
v_exp_f32 v152, v152
v_mfma_f32_16x16x32_bf16 v[184:187], v[236:239], v[116:119], v[184:187]
v_exp_f32 v153, v153
v_mfma_f32_16x16x32_bf16 v[188:191], v[236:239], v[132:135], v[188:191]
ds_read_b64_tr_b16 v[236:237], v254 offset:16384
s_waitcnt lgkmcnt(4)
v_mfma_f32_16x16x32_bf16 v[180:183], v[240:243], v[104:107], v[180:183]
ds_read_b64_tr_b16 v[238:239], v254 offset:20480
v_cvt_pk_bf16_f32 v197, v150, v151
v_mfma_f32_16x16x32_bf16 v[184:187], v[240:243], v[120:123], v[184:187]
v_exp_f32 v154, v154
v_mfma_f32_16x16x32_bf16 v[188:191], v[240:243], v[136:139], v[188:191]
ds_read_b64_tr_b16 v[240:241], v253 offset:16640
s_waitcnt lgkmcnt(5)
v_mfma_f32_16x16x32_bf16 v[180:183], v[244:247], v[108:111], v[180:183]
ds_read_b64_tr_b16 v[242:243], v253 offset:20736
v_mfma_f32_16x16x32_bf16 v[184:187], v[244:247], v[124:127], v[184:187]
v_exp_f32 v155, v155
v_cvt_pk_bf16_f32 v200, v152, v153
v_mfma_f32_16x16x32_bf16 v[188:191], v[244:247], v[140:143], v[188:191]
ds_read_b64_tr_b16 v[244:245], v254 offset:16640
s_waitcnt lgkmcnt(5)
v_mfma_f32_16x16x32_bf16 v[0:3], v[232:235], v[204:207], v[0:3]
ds_read_b64_tr_b16 v[246:247], v254 offset:20736
v_mfma_f32_16x16x32_bf16 v[4:7], v[232:235], v[208:211], v[4:7]
v_exp_f32 v156, v156
v_mfma_f32_16x16x32_bf16 v[8:11], v[232:235], v[212:215], v[8:11]
ds_read_b64_tr_b16 v[232:233], v253 offset:16896
s_waitcnt lgkmcnt(5)
v_mfma_f32_16x16x32_bf16 v[12:15], v[236:239], v[204:207], v[12:15]
ds_read_b64_tr_b16 v[234:235], v253 offset:20992
v_exp_f32 v157, v157
v_mfma_f32_16x16x32_bf16 v[16:19], v[236:239], v[208:211], v[16:19]
v_cvt_pk_bf16_f32 v201, v154, v155
v_mfma_f32_16x16x32_bf16 v[20:23], v[236:239], v[212:215], v[20:23]
ds_read_b64_tr_b16 v[236:237], v254 offset:16896
s_waitcnt lgkmcnt(5)
v_mfma_f32_16x16x32_bf16 v[24:27], v[240:243], v[204:207], v[24:27]
ds_read_b64_tr_b16 v[238:239], v254 offset:20992
v_exp_f32 v158, v158
v_mfma_f32_16x16x32_bf16 v[28:31], v[240:243], v[208:211], v[28:31]
v_exp_f32 v159, v159
v_mfma_f32_16x16x32_bf16 v[32:35], v[240:243], v[212:215], v[32:35]
ds_read_b64_tr_b16 v[240:241], v253 offset:17152
s_waitcnt lgkmcnt(5)
v_mfma_f32_16x16x32_bf16 v[36:39], v[244:247], v[204:207], v[36:39]
ds_read_b64_tr_b16 v[242:243], v253 offset:21248
v_cvt_pk_bf16_f32 v194, v156, v157
v_mfma_f32_16x16x32_bf16 v[40:43], v[244:247], v[208:211], v[40:43]
v_exp_f32 v160, v160
v_mfma_f32_16x16x32_bf16 v[44:47], v[244:247], v[212:215], v[44:47]
ds_read_b64_tr_b16 v[244:245], v254 offset:17152
s_waitcnt lgkmcnt(5)
v_mfma_f32_16x16x32_bf16 v[48:51], v[232:235], v[204:207], v[48:51]
ds_read_b64_tr_b16 v[246:247], v254 offset:21248
v_mfma_f32_16x16x32_bf16 v[52:55], v[232:235], v[208:211], v[52:55]
s_barrier
v_mfma_f32_16x16x32_bf16 v[56:59], v[232:235], v[212:215], v[56:59]
ds_read_b128 v[232:235], v251 offset:8192
s_waitcnt lgkmcnt(5)
v_mfma_f32_16x16x32_bf16 v[60:63], v[236:239], v[204:207], v[60:63]
v_exp_f32 v161, v161
v_cvt_pk_bf16_f32 v195, v158, v159
v_mfma_f32_16x16x32_bf16 v[64:67], v[236:239], v[208:211], v[64:67]
v_exp_f32 v162, v162
v_mfma_f32_16x16x32_bf16 v[68:71], v[236:239], v[212:215], v[68:71]
ds_read_b128 v[236:239], v251 offset:8448
s_waitcnt lgkmcnt(4)
v_mfma_f32_16x16x32_bf16 v[72:75], v[240:243], v[204:207], v[72:75]
v_exp_f32 v163, v163
v_mfma_f32_16x16x32_bf16 v[76:79], v[240:243], v[208:211], v[76:79]
v_cvt_pk_bf16_f32 v198, v160, v161
v_mfma_f32_16x16x32_bf16 v[80:83], v[240:243], v[212:215], v[80:83]
ds_read_b128 v[240:243], v251 offset:8704
s_waitcnt lgkmcnt(3)
v_mfma_f32_16x16x32_bf16 v[84:87], v[244:247], v[204:207], v[84:87]
v_exp_f32 v164, v164
v_mfma_f32_16x16x32_bf16 v[88:91], v[244:247], v[208:211], v[88:91]
v_exp_f32 v165, v165
v_cvt_pk_bf16_f32 v199, v162, v163
v_mfma_f32_16x16x32_bf16 v[92:95], v[244:247], v[212:215], v[92:95]
ds_read_b128 v[244:247], v251 offset:8960
v_mfma_f32_16x16x32_bf16 v[216:219], v[228:231], v[204:207], v[216:219]
v_exp_f32 v166, v166
v_mfma_f32_16x16x32_bf16 v[220:223], v[228:231], v[208:211], v[220:223]
v_exp_f32 v167, v167
v_mfma_f32_16x16x32_bf16 v[224:227], v[228:231], v[212:215], v[224:227]
v_cvt_pk_bf16_f32 v202, v164, v165
s_nop 0
v_cvt_pk_bf16_f32 v203, v166, v167
s_waitcnt lgkmcnt(3)
v_mfma_f32_16x16x32_bf16 v[144:147], v[232:235], v[96:99], 0
v_exp_f32 v168, v168
v_mfma_f32_16x16x32_bf16 v[148:151], v[232:235], v[112:115], 0
v_exp_f32 v169, v169
v_mfma_f32_16x16x32_bf16 v[152:155], v[232:235], v[128:131], 0
ds_read_b128 v[232:235], v251 offset:12288
s_waitcnt lgkmcnt(3)
v_mfma_f32_16x16x32_bf16 v[144:147], v[236:239], v[100:103], v[144:147]
v_exp_f32 v170, v170
v_mfma_f32_16x16x32_bf16 v[148:151], v[236:239], v[116:119], v[148:151]
v_exp_f32 v171, v171
v_mfma_f32_16x16x32_bf16 v[152:155], v[236:239], v[132:135], v[152:155]
ds_read_b128 v[236:239], v251 offset:12544
s_waitcnt lgkmcnt(3)
v_mfma_f32_16x16x32_bf16 v[144:147], v[240:243], v[104:107], v[144:147]
v_cvt_pk_bf16_f32 v204, v168, v169
v_mfma_f32_16x16x32_bf16 v[148:151], v[240:243], v[120:123], v[148:151]
v_exp_f32 v172, v172
v_mfma_f32_16x16x32_bf16 v[152:155], v[240:243], v[136:139], v[152:155]
ds_read_b128 v[240:243], v251 offset:12800
s_waitcnt lgkmcnt(3)
v_mfma_f32_16x16x32_bf16 v[144:147], v[244:247], v[108:111], v[144:147]
v_exp_f32 v173, v173
v_cvt_pk_bf16_f32 v205, v170, v171
v_mfma_f32_16x16x32_bf16 v[148:151], v[244:247], v[124:127], v[148:151]
v_exp_f32 v174, v174
v_mfma_f32_16x16x32_bf16 v[152:155], v[244:247], v[140:143], v[152:155]
ds_read_b128 v[244:247], v251 offset:13056
s_waitcnt lgkmcnt(3)
v_mfma_f32_16x16x32_bf16 v[156:159], v[232:235], v[96:99], 0
v_exp_f32 v175, v175
v_mfma_f32_16x16x32_bf16 v[160:163], v[232:235], v[112:115], 0
v_cvt_pk_bf16_f32 v208, v172, v173
v_mfma_f32_16x16x32_bf16 v[164:167], v[232:235], v[128:131], 0
ds_read_b64_tr_b16 v[232:233], v248 offset:0
s_waitcnt lgkmcnt(3)
v_mfma_f32_16x16x32_bf16 v[156:159], v[236:239], v[100:103], v[156:159]
ds_read_b64_tr_b16 v[234:235], v248 offset:4096
v_exp_f32 v176, v176
v_mfma_f32_16x16x32_bf16 v[160:163], v[236:239], v[116:119], v[160:163]
v_exp_f32 v177, v177
v_mfma_f32_16x16x32_bf16 v[164:167], v[236:239], v[132:135], v[164:167]
ds_read_b64_tr_b16 v[236:237], v249 offset:0
s_waitcnt lgkmcnt(4)
v_mfma_f32_16x16x32_bf16 v[156:159], v[240:243], v[104:107], v[156:159]
ds_read_b64_tr_b16 v[238:239], v249 offset:4096
v_cvt_pk_bf16_f32 v209, v174, v175
v_mfma_f32_16x16x32_bf16 v[160:163], v[240:243], v[120:123], v[160:163]
v_exp_f32 v178, v178
v_mfma_f32_16x16x32_bf16 v[164:167], v[240:243], v[136:139], v[164:167]
ds_read_b64_tr_b16 v[240:241], v248 offset:256
s_waitcnt lgkmcnt(5)
v_mfma_f32_16x16x32_bf16 v[156:159], v[244:247], v[108:111], v[156:159]
ds_read_b64_tr_b16 v[242:243], v248 offset:4352
v_mfma_f32_16x16x32_bf16 v[160:163], v[244:247], v[124:127], v[160:163]
v_exp_f32 v179, v179
v_cvt_pk_bf16_f32 v212, v176, v177
v_mfma_f32_16x16x32_bf16 v[164:167], v[244:247], v[140:143], v[164:167]
ds_read_b64_tr_b16 v[244:245], v249 offset:256
s_waitcnt lgkmcnt(5)
v_mfma_f32_16x16x32_bf16 v[0:3], v[232:235], v[192:195], v[0:3]
ds_read_b64_tr_b16 v[246:247], v249 offset:4352
v_mfma_f32_16x16x32_bf16 v[4:7], v[232:235], v[196:199], v[4:7]
v_exp_f32 v180, v180
v_mfma_f32_16x16x32_bf16 v[8:11], v[232:235], v[200:203], v[8:11]
ds_read_b64_tr_b16 v[232:233], v248 offset:512
s_waitcnt lgkmcnt(5)
v_mfma_f32_16x16x32_bf16 v[12:15], v[236:239], v[192:195], v[12:15]
ds_read_b64_tr_b16 v[234:235], v248 offset:4608
v_exp_f32 v181, v181
v_mfma_f32_16x16x32_bf16 v[16:19], v[236:239], v[196:199], v[16:19]
v_cvt_pk_bf16_f32 v213, v178, v179
v_mfma_f32_16x16x32_bf16 v[20:23], v[236:239], v[200:203], v[20:23]
ds_read_b64_tr_b16 v[236:237], v249 offset:512
s_waitcnt lgkmcnt(5)
v_mfma_f32_16x16x32_bf16 v[24:27], v[240:243], v[192:195], v[24:27]
ds_read_b64_tr_b16 v[238:239], v249 offset:4608
v_exp_f32 v182, v182
v_mfma_f32_16x16x32_bf16 v[28:31], v[240:243], v[196:199], v[28:31]
v_exp_f32 v183, v183
v_mfma_f32_16x16x32_bf16 v[32:35], v[240:243], v[200:203], v[32:35]
ds_read_b64_tr_b16 v[240:241], v248 offset:768
s_waitcnt lgkmcnt(5)
v_mfma_f32_16x16x32_bf16 v[36:39], v[244:247], v[192:195], v[36:39]
ds_read_b64_tr_b16 v[242:243], v248 offset:4864
v_cvt_pk_bf16_f32 v206, v180, v181
v_mfma_f32_16x16x32_bf16 v[40:43], v[244:247], v[196:199], v[40:43]
v_exp_f32 v184, v184
v_mfma_f32_16x16x32_bf16 v[44:47], v[244:247], v[200:203], v[44:47]
ds_read_b64_tr_b16 v[244:245], v249 offset:768
s_waitcnt lgkmcnt(5)
v_mfma_f32_16x16x32_bf16 v[48:51], v[232:235], v[192:195], v[48:51]
ds_read_b64_tr_b16 v[246:247], v249 offset:4864
v_mfma_f32_16x16x32_bf16 v[52:55], v[232:235], v[196:199], v[52:55]
s_barrier
v_mfma_f32_16x16x32_bf16 v[56:59], v[232:235], v[200:203], v[56:59]
ds_read_b128 v[232:235], v251 offset:24576
s_waitcnt lgkmcnt(5)
v_mfma_f32_16x16x32_bf16 v[60:63], v[236:239], v[192:195], v[60:63]
v_exp_f32 v185, v185
v_cvt_pk_bf16_f32 v207, v182, v183
v_mfma_f32_16x16x32_bf16 v[64:67], v[236:239], v[196:199], v[64:67]
v_exp_f32 v186, v186
v_mfma_f32_16x16x32_bf16 v[68:71], v[236:239], v[200:203], v[68:71]
ds_read_b128 v[236:239], v251 offset:24832
s_waitcnt lgkmcnt(4)
v_mfma_f32_16x16x32_bf16 v[72:75], v[240:243], v[192:195], v[72:75]
v_exp_f32 v187, v187
v_mfma_f32_16x16x32_bf16 v[76:79], v[240:243], v[196:199], v[76:79]
v_cvt_pk_bf16_f32 v210, v184, v185
v_mfma_f32_16x16x32_bf16 v[80:83], v[240:243], v[200:203], v[80:83]
ds_read_b128 v[240:243], v251 offset:25088
s_waitcnt lgkmcnt(3)
v_mfma_f32_16x16x32_bf16 v[84:87], v[244:247], v[192:195], v[84:87]
v_exp_f32 v188, v188
v_mfma_f32_16x16x32_bf16 v[88:91], v[244:247], v[196:199], v[88:91]
v_exp_f32 v189, v189
v_cvt_pk_bf16_f32 v211, v186, v187
v_mfma_f32_16x16x32_bf16 v[92:95], v[244:247], v[200:203], v[92:95]
ds_read_b128 v[244:247], v251 offset:25344
v_mfma_f32_16x16x32_bf16 v[216:219], v[228:231], v[192:195], v[216:219]
v_exp_f32 v190, v190
v_mfma_f32_16x16x32_bf16 v[220:223], v[228:231], v[196:199], v[220:223]
v_exp_f32 v191, v191
v_mfma_f32_16x16x32_bf16 v[224:227], v[228:231], v[200:203], v[224:227]
v_cvt_pk_bf16_f32 v214, v188, v189
s_nop 0
v_cvt_pk_bf16_f32 v215, v190, v191
s_waitcnt lgkmcnt(3)
v_mfma_f32_16x16x32_bf16 v[168:171], v[232:235], v[96:99], 0
v_exp_f32 v144, v144
v_mfma_f32_16x16x32_bf16 v[172:175], v[232:235], v[112:115], 0
v_exp_f32 v145, v145
v_mfma_f32_16x16x32_bf16 v[176:179], v[232:235], v[128:131], 0
ds_read_b128 v[232:235], v251 offset:28672
s_waitcnt lgkmcnt(3)
v_mfma_f32_16x16x32_bf16 v[168:171], v[236:239], v[100:103], v[168:171]
v_exp_f32 v146, v146
v_mfma_f32_16x16x32_bf16 v[172:175], v[236:239], v[116:119], v[172:175]
v_exp_f32 v147, v147
v_mfma_f32_16x16x32_bf16 v[176:179], v[236:239], v[132:135], v[176:179]
ds_read_b128 v[236:239], v251 offset:28928
s_waitcnt lgkmcnt(3)
v_mfma_f32_16x16x32_bf16 v[168:171], v[240:243], v[104:107], v[168:171]
v_cvt_pk_bf16_f32 v192, v144, v145
v_mfma_f32_16x16x32_bf16 v[172:175], v[240:243], v[120:123], v[172:175]
v_exp_f32 v148, v148
v_mfma_f32_16x16x32_bf16 v[176:179], v[240:243], v[136:139], v[176:179]
ds_read_b128 v[240:243], v251 offset:29184
s_waitcnt lgkmcnt(3)
v_mfma_f32_16x16x32_bf16 v[168:171], v[244:247], v[108:111], v[168:171]
v_exp_f32 v149, v149
v_cvt_pk_bf16_f32 v193, v146, v147
v_mfma_f32_16x16x32_bf16 v[172:175], v[244:247], v[124:127], v[172:175]
v_exp_f32 v150, v150
v_mfma_f32_16x16x32_bf16 v[176:179], v[244:247], v[140:143], v[176:179]
ds_read_b128 v[244:247], v251 offset:29440
s_waitcnt lgkmcnt(3)
v_mfma_f32_16x16x32_bf16 v[180:183], v[232:235], v[96:99], 0
v_exp_f32 v151, v151
v_mfma_f32_16x16x32_bf16 v[184:187], v[232:235], v[112:115], 0
v_cvt_pk_bf16_f32 v196, v148, v149
v_mfma_f32_16x16x32_bf16 v[188:191], v[232:235], v[128:131], 0
ds_read_b64_tr_b16 v[232:233], v248 offset:16384
s_waitcnt lgkmcnt(3)
v_mfma_f32_16x16x32_bf16 v[180:183], v[236:239], v[100:103], v[180:183]
ds_read_b64_tr_b16 v[234:235], v248 offset:20480
v_exp_f32 v152, v152
v_mfma_f32_16x16x32_bf16 v[184:187], v[236:239], v[116:119], v[184:187]
v_exp_f32 v153, v153
v_mfma_f32_16x16x32_bf16 v[188:191], v[236:239], v[132:135], v[188:191]
ds_read_b64_tr_b16 v[236:237], v249 offset:16384
s_waitcnt lgkmcnt(4)
v_mfma_f32_16x16x32_bf16 v[180:183], v[240:243], v[104:107], v[180:183]
ds_read_b64_tr_b16 v[238:239], v249 offset:20480
v_cvt_pk_bf16_f32 v197, v150, v151
v_mfma_f32_16x16x32_bf16 v[184:187], v[240:243], v[120:123], v[184:187]
L_pg6:
s_cbranch_execz L_ret
v_exp_f32 v154, v154
v_mfma_f32_16x16x32_bf16 v[188:191], v[240:243], v[136:139], v[188:191]
ds_read_b64_tr_b16 v[240:241], v248 offset:16640
s_waitcnt lgkmcnt(5)
v_mfma_f32_16x16x32_bf16 v[180:183], v[244:247], v[108:111], v[180:183]
ds_read_b64_tr_b16 v[242:243], v248 offset:20736
v_mfma_f32_16x16x32_bf16 v[184:187], v[244:247], v[124:127], v[184:187]
v_exp_f32 v155, v155
v_cvt_pk_bf16_f32 v200, v152, v153
v_mfma_f32_16x16x32_bf16 v[188:191], v[244:247], v[140:143], v[188:191]
ds_read_b64_tr_b16 v[244:245], v249 offset:16640
s_waitcnt lgkmcnt(5)
v_mfma_f32_16x16x32_bf16 v[0:3], v[232:235], v[204:207], v[0:3]
ds_read_b64_tr_b16 v[246:247], v249 offset:20736
v_mfma_f32_16x16x32_bf16 v[4:7], v[232:235], v[208:211], v[4:7]
v_exp_f32 v156, v156
v_mfma_f32_16x16x32_bf16 v[8:11], v[232:235], v[212:215], v[8:11]
ds_read_b64_tr_b16 v[232:233], v248 offset:16896
s_waitcnt lgkmcnt(5)
v_mfma_f32_16x16x32_bf16 v[12:15], v[236:239], v[204:207], v[12:15]
ds_read_b64_tr_b16 v[234:235], v248 offset:20992
v_exp_f32 v157, v157
v_mfma_f32_16x16x32_bf16 v[16:19], v[236:239], v[208:211], v[16:19]
v_cvt_pk_bf16_f32 v201, v154, v155
v_mfma_f32_16x16x32_bf16 v[20:23], v[236:239], v[212:215], v[20:23]
ds_read_b64_tr_b16 v[236:237], v249 offset:16896
s_waitcnt lgkmcnt(5)
v_mfma_f32_16x16x32_bf16 v[24:27], v[240:243], v[204:207], v[24:27]
ds_read_b64_tr_b16 v[238:239], v249 offset:20992
v_exp_f32 v158, v158
v_mfma_f32_16x16x32_bf16 v[28:31], v[240:243], v[208:211], v[28:31]
v_exp_f32 v159, v159
v_mfma_f32_16x16x32_bf16 v[32:35], v[240:243], v[212:215], v[32:35]
ds_read_b64_tr_b16 v[240:241], v248 offset:17152
s_waitcnt lgkmcnt(5)
v_mfma_f32_16x16x32_bf16 v[36:39], v[244:247], v[204:207], v[36:39]
ds_read_b64_tr_b16 v[242:243], v248 offset:21248
v_cvt_pk_bf16_f32 v194, v156, v157
v_mfma_f32_16x16x32_bf16 v[40:43], v[244:247], v[208:211], v[40:43]
v_exp_f32 v160, v160
v_mfma_f32_16x16x32_bf16 v[44:47], v[244:247], v[212:215], v[44:47]
ds_read_b64_tr_b16 v[244:245], v249 offset:17152
s_waitcnt lgkmcnt(5)
v_mfma_f32_16x16x32_bf16 v[48:51], v[232:235], v[204:207], v[48:51]
ds_read_b64_tr_b16 v[246:247], v249 offset:21248
v_mfma_f32_16x16x32_bf16 v[52:55], v[232:235], v[208:211], v[52:55]
s_barrier
v_mfma_f32_16x16x32_bf16 v[56:59], v[232:235], v[212:215], v[56:59]
ds_read_b128 v[232:235], v251 offset:40960
s_waitcnt lgkmcnt(5)
v_mfma_f32_16x16x32_bf16 v[60:63], v[236:239], v[204:207], v[60:63]
v_exp_f32 v161, v161
v_cvt_pk_bf16_f32 v195, v158, v159
v_mfma_f32_16x16x32_bf16 v[64:67], v[236:239], v[208:211], v[64:67]
v_exp_f32 v162, v162
v_mfma_f32_16x16x32_bf16 v[68:71], v[236:239], v[212:215], v[68:71]
ds_read_b128 v[236:239], v251 offset:41216
s_waitcnt lgkmcnt(4)
v_mfma_f32_16x16x32_bf16 v[72:75], v[240:243], v[204:207], v[72:75]
v_exp_f32 v163, v163
v_mfma_f32_16x16x32_bf16 v[76:79], v[240:243], v[208:211], v[76:79]
v_cvt_pk_bf16_f32 v198, v160, v161
v_mfma_f32_16x16x32_bf16 v[80:83], v[240:243], v[212:215], v[80:83]
ds_read_b128 v[240:243], v251 offset:41472
s_waitcnt lgkmcnt(3)
v_mfma_f32_16x16x32_bf16 v[84:87], v[244:247], v[204:207], v[84:87]
v_exp_f32 v164, v164
v_mfma_f32_16x16x32_bf16 v[88:91], v[244:247], v[208:211], v[88:91]
v_exp_f32 v165, v165
v_cvt_pk_bf16_f32 v199, v162, v163
v_mfma_f32_16x16x32_bf16 v[92:95], v[244:247], v[212:215], v[92:95]
ds_read_b128 v[244:247], v251 offset:41728
v_mfma_f32_16x16x32_bf16 v[216:219], v[228:231], v[204:207], v[216:219]
v_exp_f32 v166, v166
v_mfma_f32_16x16x32_bf16 v[220:223], v[228:231], v[208:211], v[220:223]
v_exp_f32 v167, v167
v_mfma_f32_16x16x32_bf16 v[224:227], v[228:231], v[212:215], v[224:227]
v_cvt_pk_bf16_f32 v202, v164, v165
s_nop 0
v_cvt_pk_bf16_f32 v203, v166, v167
s_waitcnt lgkmcnt(3)
v_mfma_f32_16x16x32_bf16 v[144:147], v[232:235], v[96:99], 0
v_exp_f32 v168, v168
v_mfma_f32_16x16x32_bf16 v[148:151], v[232:235], v[112:115], 0
v_exp_f32 v169, v169
v_mfma_f32_16x16x32_bf16 v[152:155], v[232:235], v[128:131], 0
ds_read_b128 v[232:235], v251 offset:45056
s_waitcnt lgkmcnt(3)
v_mfma_f32_16x16x32_bf16 v[144:147], v[236:239], v[100:103], v[144:147]
v_exp_f32 v170, v170
v_mfma_f32_16x16x32_bf16 v[148:151], v[236:239], v[116:119], v[148:151]
v_exp_f32 v171, v171
v_mfma_f32_16x16x32_bf16 v[152:155], v[236:239], v[132:135], v[152:155]
ds_read_b128 v[236:239], v251 offset:45312
s_waitcnt lgkmcnt(3)
v_mfma_f32_16x16x32_bf16 v[144:147], v[240:243], v[104:107], v[144:147]
v_cvt_pk_bf16_f32 v204, v168, v169
v_mfma_f32_16x16x32_bf16 v[148:151], v[240:243], v[120:123], v[148:151]
v_exp_f32 v172, v172
v_mfma_f32_16x16x32_bf16 v[152:155], v[240:243], v[136:139], v[152:155]
ds_read_b128 v[240:243], v251 offset:45568
s_waitcnt lgkmcnt(3)
v_mfma_f32_16x16x32_bf16 v[144:147], v[244:247], v[108:111], v[144:147]
v_exp_f32 v173, v173
v_cvt_pk_bf16_f32 v205, v170, v171
v_mfma_f32_16x16x32_bf16 v[148:151], v[244:247], v[124:127], v[148:151]
v_exp_f32 v174, v174
v_mfma_f32_16x16x32_bf16 v[152:155], v[244:247], v[140:143], v[152:155]
ds_read_b128 v[244:247], v251 offset:45824
s_waitcnt lgkmcnt(3)
v_mfma_f32_16x16x32_bf16 v[156:159], v[232:235], v[96:99], 0
v_exp_f32 v175, v175
v_mfma_f32_16x16x32_bf16 v[160:163], v[232:235], v[112:115], 0
v_cvt_pk_bf16_f32 v208, v172, v173
v_mfma_f32_16x16x32_bf16 v[164:167], v[232:235], v[128:131], 0
ds_read_b64_tr_b16 v[232:233], v248 offset:32768
s_waitcnt lgkmcnt(3)
v_mfma_f32_16x16x32_bf16 v[156:159], v[236:239], v[100:103], v[156:159]
ds_read_b64_tr_b16 v[234:235], v248 offset:36864
v_exp_f32 v176, v176
v_mfma_f32_16x16x32_bf16 v[160:163], v[236:239], v[116:119], v[160:163]
v_exp_f32 v177, v177
v_mfma_f32_16x16x32_bf16 v[164:167], v[236:239], v[132:135], v[164:167]
ds_read_b64_tr_b16 v[236:237], v249 offset:32768
s_waitcnt lgkmcnt(4)
v_mfma_f32_16x16x32_bf16 v[156:159], v[240:243], v[104:107], v[156:159]
ds_read_b64_tr_b16 v[238:239], v249 offset:36864
v_cvt_pk_bf16_f32 v209, v174, v175
v_mfma_f32_16x16x32_bf16 v[160:163], v[240:243], v[120:123], v[160:163]
v_exp_f32 v178, v178
v_mfma_f32_16x16x32_bf16 v[164:167], v[240:243], v[136:139], v[164:167]
ds_read_b64_tr_b16 v[240:241], v248 offset:33024
s_waitcnt lgkmcnt(5)
v_mfma_f32_16x16x32_bf16 v[156:159], v[244:247], v[108:111], v[156:159]
ds_read_b64_tr_b16 v[242:243], v248 offset:37120
v_mfma_f32_16x16x32_bf16 v[160:163], v[244:247], v[124:127], v[160:163]
v_exp_f32 v179, v179
v_cvt_pk_bf16_f32 v212, v176, v177
v_mfma_f32_16x16x32_bf16 v[164:167], v[244:247], v[140:143], v[164:167]
ds_read_b64_tr_b16 v[244:245], v249 offset:33024
s_waitcnt lgkmcnt(5)
v_mfma_f32_16x16x32_bf16 v[0:3], v[232:235], v[192:195], v[0:3]
ds_read_b64_tr_b16 v[246:247], v249 offset:37120
v_mfma_f32_16x16x32_bf16 v[4:7], v[232:235], v[196:199], v[4:7]
v_exp_f32 v180, v180
v_mfma_f32_16x16x32_bf16 v[8:11], v[232:235], v[200:203], v[8:11]
ds_read_b64_tr_b16 v[232:233], v248 offset:33280
s_waitcnt lgkmcnt(5)
v_mfma_f32_16x16x32_bf16 v[12:15], v[236:239], v[192:195], v[12:15]
ds_read_b64_tr_b16 v[234:235], v248 offset:37376
v_exp_f32 v181, v181
v_mfma_f32_16x16x32_bf16 v[16:19], v[236:239], v[196:199], v[16:19]
v_cvt_pk_bf16_f32 v213, v178, v179
v_mfma_f32_16x16x32_bf16 v[20:23], v[236:239], v[200:203], v[20:23]
ds_read_b64_tr_b16 v[236:237], v249 offset:33280
s_waitcnt lgkmcnt(5)
v_mfma_f32_16x16x32_bf16 v[24:27], v[240:243], v[192:195], v[24:27]
ds_read_b64_tr_b16 v[238:239], v249 offset:37376
v_exp_f32 v182, v182
v_mfma_f32_16x16x32_bf16 v[28:31], v[240:243], v[196:199], v[28:31]
v_exp_f32 v183, v183
v_mfma_f32_16x16x32_bf16 v[32:35], v[240:243], v[200:203], v[32:35]
ds_read_b64_tr_b16 v[240:241], v248 offset:33536
s_waitcnt lgkmcnt(5)
v_mfma_f32_16x16x32_bf16 v[36:39], v[244:247], v[192:195], v[36:39]
ds_read_b64_tr_b16 v[242:243], v248 offset:37632
v_cvt_pk_bf16_f32 v206, v180, v181
v_mfma_f32_16x16x32_bf16 v[40:43], v[244:247], v[196:199], v[40:43]
v_exp_f32 v184, v184
v_mfma_f32_16x16x32_bf16 v[44:47], v[244:247], v[200:203], v[44:47]
ds_read_b64_tr_b16 v[244:245], v249 offset:33536
s_waitcnt lgkmcnt(5)
v_mfma_f32_16x16x32_bf16 v[48:51], v[232:235], v[192:195], v[48:51]
ds_read_b64_tr_b16 v[246:247], v249 offset:37632
v_mfma_f32_16x16x32_bf16 v[52:55], v[232:235], v[196:199], v[52:55]
s_barrier
v_mfma_f32_16x16x32_bf16 v[56:59], v[232:235], v[200:203], v[56:59]
ds_read_b128 v[232:235], v251 offset:57344
s_waitcnt lgkmcnt(5)
v_mfma_f32_16x16x32_bf16 v[60:63], v[236:239], v[192:195], v[60:63]
v_exp_f32 v185, v185
v_cvt_pk_bf16_f32 v207, v182, v183
v_mfma_f32_16x16x32_bf16 v[64:67], v[236:239], v[196:199], v[64:67]
v_exp_f32 v186, v186
v_mfma_f32_16x16x32_bf16 v[68:71], v[236:239], v[200:203], v[68:71]
ds_read_b128 v[236:239], v251 offset:57600
s_waitcnt lgkmcnt(4)
v_mfma_f32_16x16x32_bf16 v[72:75], v[240:243], v[192:195], v[72:75]
v_exp_f32 v187, v187
v_mfma_f32_16x16x32_bf16 v[76:79], v[240:243], v[196:199], v[76:79]
v_cvt_pk_bf16_f32 v210, v184, v185
v_mfma_f32_16x16x32_bf16 v[80:83], v[240:243], v[200:203], v[80:83]
ds_read_b128 v[240:243], v251 offset:57856
s_waitcnt lgkmcnt(3)
v_mfma_f32_16x16x32_bf16 v[84:87], v[244:247], v[192:195], v[84:87]
v_exp_f32 v188, v188
v_mfma_f32_16x16x32_bf16 v[88:91], v[244:247], v[196:199], v[88:91]
v_exp_f32 v189, v189
v_cvt_pk_bf16_f32 v211, v186, v187
v_mfma_f32_16x16x32_bf16 v[92:95], v[244:247], v[200:203], v[92:95]
ds_read_b128 v[244:247], v251 offset:58112
v_mfma_f32_16x16x32_bf16 v[216:219], v[228:231], v[192:195], v[216:219]
v_exp_f32 v190, v190
v_mfma_f32_16x16x32_bf16 v[220:223], v[228:231], v[196:199], v[220:223]
v_exp_f32 v191, v191
v_mfma_f32_16x16x32_bf16 v[224:227], v[228:231], v[200:203], v[224:227]
v_cvt_pk_bf16_f32 v214, v188, v189
s_nop 0
v_cvt_pk_bf16_f32 v215, v190, v191
s_waitcnt lgkmcnt(3)
v_mfma_f32_16x16x32_bf16 v[168:171], v[232:235], v[96:99], 0
v_exp_f32 v144, v144
v_mfma_f32_16x16x32_bf16 v[172:175], v[232:235], v[112:115], 0
v_exp_f32 v145, v145
v_mfma_f32_16x16x32_bf16 v[176:179], v[232:235], v[128:131], 0
ds_read_b128 v[232:235], v251 offset:61440
s_waitcnt lgkmcnt(3)
v_mfma_f32_16x16x32_bf16 v[168:171], v[236:239], v[100:103], v[168:171]
v_exp_f32 v146, v146
v_mfma_f32_16x16x32_bf16 v[172:175], v[236:239], v[116:119], v[172:175]
v_exp_f32 v147, v147
v_mfma_f32_16x16x32_bf16 v[176:179], v[236:239], v[132:135], v[176:179]
ds_read_b128 v[236:239], v251 offset:61696
s_waitcnt lgkmcnt(3)
v_mfma_f32_16x16x32_bf16 v[168:171], v[240:243], v[104:107], v[168:171]
v_cvt_pk_bf16_f32 v192, v144, v145
v_mfma_f32_16x16x32_bf16 v[172:175], v[240:243], v[120:123], v[172:175]
v_exp_f32 v148, v148
v_mfma_f32_16x16x32_bf16 v[176:179], v[240:243], v[136:139], v[176:179]
ds_read_b128 v[240:243], v251 offset:61952
s_waitcnt lgkmcnt(3)
v_mfma_f32_16x16x32_bf16 v[168:171], v[244:247], v[108:111], v[168:171]
v_exp_f32 v149, v149
v_cvt_pk_bf16_f32 v193, v146, v147
v_mfma_f32_16x16x32_bf16 v[172:175], v[244:247], v[124:127], v[172:175]
v_exp_f32 v150, v150
v_mfma_f32_16x16x32_bf16 v[176:179], v[244:247], v[140:143], v[176:179]
ds_read_b128 v[244:247], v251 offset:62208
s_waitcnt lgkmcnt(3)
v_mfma_f32_16x16x32_bf16 v[180:183], v[232:235], v[96:99], 0
v_exp_f32 v151, v151
v_mfma_f32_16x16x32_bf16 v[184:187], v[232:235], v[112:115], 0
v_cvt_pk_bf16_f32 v196, v148, v149
v_mfma_f32_16x16x32_bf16 v[188:191], v[232:235], v[128:131], 0
ds_read_b64_tr_b16 v[232:233], v248 offset:49152
s_waitcnt lgkmcnt(3)
v_mfma_f32_16x16x32_bf16 v[180:183], v[236:239], v[100:103], v[180:183]
ds_read_b64_tr_b16 v[234:235], v248 offset:53248
v_exp_f32 v152, v152
v_mfma_f32_16x16x32_bf16 v[184:187], v[236:239], v[116:119], v[184:187]
v_exp_f32 v153, v153
v_mfma_f32_16x16x32_bf16 v[188:191], v[236:239], v[132:135], v[188:191]
ds_read_b64_tr_b16 v[236:237], v249 offset:49152
s_waitcnt lgkmcnt(4)
v_mfma_f32_16x16x32_bf16 v[180:183], v[240:243], v[104:107], v[180:183]
ds_read_b64_tr_b16 v[238:239], v249 offset:53248
v_cvt_pk_bf16_f32 v197, v150, v151
v_mfma_f32_16x16x32_bf16 v[184:187], v[240:243], v[120:123], v[184:187]
v_exp_f32 v154, v154
v_mfma_f32_16x16x32_bf16 v[188:191], v[240:243], v[136:139], v[188:191]
ds_read_b64_tr_b16 v[240:241], v248 offset:49408
s_waitcnt lgkmcnt(5)
v_mfma_f32_16x16x32_bf16 v[180:183], v[244:247], v[108:111], v[180:183]
ds_read_b64_tr_b16 v[242:243], v248 offset:53504
v_mfma_f32_16x16x32_bf16 v[184:187], v[244:247], v[124:127], v[184:187]
v_exp_f32 v155, v155
v_cvt_pk_bf16_f32 v200, v152, v153
v_mfma_f32_16x16x32_bf16 v[188:191], v[244:247], v[140:143], v[188:191]
ds_read_b64_tr_b16 v[244:245], v249 offset:49408
s_waitcnt lgkmcnt(5)
v_mfma_f32_16x16x32_bf16 v[0:3], v[232:235], v[204:207], v[0:3]
ds_read_b64_tr_b16 v[246:247], v249 offset:53504
v_mfma_f32_16x16x32_bf16 v[4:7], v[232:235], v[208:211], v[4:7]
v_exp_f32 v156, v156
v_mfma_f32_16x16x32_bf16 v[8:11], v[232:235], v[212:215], v[8:11]
ds_read_b64_tr_b16 v[232:233], v248 offset:49664
s_waitcnt lgkmcnt(5)
v_mfma_f32_16x16x32_bf16 v[12:15], v[236:239], v[204:207], v[12:15]
ds_read_b64_tr_b16 v[234:235], v248 offset:53760
v_exp_f32 v157, v157
v_mfma_f32_16x16x32_bf16 v[16:19], v[236:239], v[208:211], v[16:19]
v_cvt_pk_bf16_f32 v201, v154, v155
v_mfma_f32_16x16x32_bf16 v[20:23], v[236:239], v[212:215], v[20:23]
ds_read_b64_tr_b16 v[236:237], v249 offset:49664
s_waitcnt lgkmcnt(5)
v_mfma_f32_16x16x32_bf16 v[24:27], v[240:243], v[204:207], v[24:27]
ds_read_b64_tr_b16 v[238:239], v249 offset:53760
v_exp_f32 v158, v158
v_mfma_f32_16x16x32_bf16 v[28:31], v[240:243], v[208:211], v[28:31]
v_exp_f32 v159, v159
v_mfma_f32_16x16x32_bf16 v[32:35], v[240:243], v[212:215], v[32:35]
ds_read_b64_tr_b16 v[240:241], v248 offset:49920
s_waitcnt lgkmcnt(5)
v_mfma_f32_16x16x32_bf16 v[36:39], v[244:247], v[204:207], v[36:39]
ds_read_b64_tr_b16 v[242:243], v248 offset:54016
v_cvt_pk_bf16_f32 v194, v156, v157
v_mfma_f32_16x16x32_bf16 v[40:43], v[244:247], v[208:211], v[40:43]
v_exp_f32 v160, v160
v_mfma_f32_16x16x32_bf16 v[44:47], v[244:247], v[212:215], v[44:47]
ds_read_b64_tr_b16 v[244:245], v249 offset:49920
s_waitcnt lgkmcnt(5)
v_mfma_f32_16x16x32_bf16 v[48:51], v[232:235], v[204:207], v[48:51]
ds_read_b64_tr_b16 v[246:247], v249 offset:54016
v_mfma_f32_16x16x32_bf16 v[52:55], v[232:235], v[208:211], v[52:55]
s_barrier
v_mfma_f32_16x16x32_bf16 v[56:59], v[232:235], v[212:215], v[56:59]
ds_read_b128 v[232:235], v250 offset:8192
s_waitcnt lgkmcnt(5)
v_mfma_f32_16x16x32_bf16 v[60:63], v[236:239], v[204:207], v[60:63]
v_exp_f32 v161, v161
v_cvt_pk_bf16_f32 v195, v158, v159
v_mfma_f32_16x16x32_bf16 v[64:67], v[236:239], v[208:211], v[64:67]
v_exp_f32 v162, v162
v_mfma_f32_16x16x32_bf16 v[68:71], v[236:239], v[212:215], v[68:71]
ds_read_b128 v[236:239], v250 offset:8448
s_waitcnt lgkmcnt(4)
v_mfma_f32_16x16x32_bf16 v[72:75], v[240:243], v[204:207], v[72:75]
v_exp_f32 v163, v163
v_mfma_f32_16x16x32_bf16 v[76:79], v[240:243], v[208:211], v[76:79]
v_cvt_pk_bf16_f32 v198, v160, v161
v_mfma_f32_16x16x32_bf16 v[80:83], v[240:243], v[212:215], v[80:83]
ds_read_b128 v[240:243], v250 offset:8704
s_waitcnt lgkmcnt(3)
v_mfma_f32_16x16x32_bf16 v[84:87], v[244:247], v[204:207], v[84:87]
v_exp_f32 v164, v164
v_mfma_f32_16x16x32_bf16 v[88:91], v[244:247], v[208:211], v[88:91]
v_exp_f32 v165, v165
v_cvt_pk_bf16_f32 v199, v162, v163
v_mfma_f32_16x16x32_bf16 v[92:95], v[244:247], v[212:215], v[92:95]
ds_read_b128 v[244:247], v250 offset:8960
v_mfma_f32_16x16x32_bf16 v[216:219], v[228:231], v[204:207], v[216:219]
v_exp_f32 v166, v166
v_mfma_f32_16x16x32_bf16 v[220:223], v[228:231], v[208:211], v[220:223]
v_exp_f32 v167, v167
v_mfma_f32_16x16x32_bf16 v[224:227], v[228:231], v[212:215], v[224:227]
v_cvt_pk_bf16_f32 v202, v164, v165
s_nop 0
v_cvt_pk_bf16_f32 v203, v166, v167
s_waitcnt lgkmcnt(3)
v_mfma_f32_16x16x32_bf16 v[144:147], v[232:235], v[96:99], 0
v_exp_f32 v168, v168
v_mfma_f32_16x16x32_bf16 v[148:151], v[232:235], v[112:115], 0
v_exp_f32 v169, v169
v_mfma_f32_16x16x32_bf16 v[152:155], v[232:235], v[128:131], 0
ds_read_b128 v[232:235], v250 offset:12288
s_waitcnt lgkmcnt(3)
v_mfma_f32_16x16x32_bf16 v[144:147], v[236:239], v[100:103], v[144:147]
v_exp_f32 v170, v170
v_mfma_f32_16x16x32_bf16 v[148:151], v[236:239], v[116:119], v[148:151]
v_exp_f32 v171, v171
v_mfma_f32_16x16x32_bf16 v[152:155], v[236:239], v[132:135], v[152:155]
ds_read_b128 v[236:239], v250 offset:12544
s_waitcnt lgkmcnt(3)
v_mfma_f32_16x16x32_bf16 v[144:147], v[240:243], v[104:107], v[144:147]
v_cvt_pk_bf16_f32 v204, v168, v169
v_mfma_f32_16x16x32_bf16 v[148:151], v[240:243], v[120:123], v[148:151]
v_exp_f32 v172, v172
v_mfma_f32_16x16x32_bf16 v[152:155], v[240:243], v[136:139], v[152:155]
ds_read_b128 v[240:243], v250 offset:12800
s_waitcnt lgkmcnt(3)
v_mfma_f32_16x16x32_bf16 v[144:147], v[244:247], v[108:111], v[144:147]
v_exp_f32 v173, v173
v_cvt_pk_bf16_f32 v205, v170, v171
v_mfma_f32_16x16x32_bf16 v[148:151], v[244:247], v[124:127], v[148:151]
v_exp_f32 v174, v174
v_mfma_f32_16x16x32_bf16 v[152:155], v[244:247], v[140:143], v[152:155]
ds_read_b128 v[244:247], v250 offset:13056
s_waitcnt lgkmcnt(3)
v_mfma_f32_16x16x32_bf16 v[156:159], v[232:235], v[96:99], 0
v_exp_f32 v175, v175
v_mfma_f32_16x16x32_bf16 v[160:163], v[232:235], v[112:115], 0
v_cvt_pk_bf16_f32 v208, v172, v173
v_mfma_f32_16x16x32_bf16 v[164:167], v[232:235], v[128:131], 0
ds_read_b64_tr_b16 v[232:233], v253 offset:0
s_waitcnt lgkmcnt(3)
v_mfma_f32_16x16x32_bf16 v[156:159], v[236:239], v[100:103], v[156:159]
ds_read_b64_tr_b16 v[234:235], v253 offset:4096
v_exp_f32 v176, v176
v_mfma_f32_16x16x32_bf16 v[160:163], v[236:239], v[116:119], v[160:163]
v_exp_f32 v177, v177
v_mfma_f32_16x16x32_bf16 v[164:167], v[236:239], v[132:135], v[164:167]
ds_read_b64_tr_b16 v[236:237], v254 offset:0
s_waitcnt lgkmcnt(4)
v_mfma_f32_16x16x32_bf16 v[156:159], v[240:243], v[104:107], v[156:159]
ds_read_b64_tr_b16 v[238:239], v254 offset:4096
v_cvt_pk_bf16_f32 v209, v174, v175
v_mfma_f32_16x16x32_bf16 v[160:163], v[240:243], v[120:123], v[160:163]
v_exp_f32 v178, v178
v_mfma_f32_16x16x32_bf16 v[164:167], v[240:243], v[136:139], v[164:167]
ds_read_b64_tr_b16 v[240:241], v253 offset:256
s_waitcnt lgkmcnt(5)
v_mfma_f32_16x16x32_bf16 v[156:159], v[244:247], v[108:111], v[156:159]
ds_read_b64_tr_b16 v[242:243], v253 offset:4352
v_mfma_f32_16x16x32_bf16 v[160:163], v[244:247], v[124:127], v[160:163]
v_exp_f32 v179, v179
v_cvt_pk_bf16_f32 v212, v176, v177
v_mfma_f32_16x16x32_bf16 v[164:167], v[244:247], v[140:143], v[164:167]
ds_read_b64_tr_b16 v[244:245], v254 offset:256
s_waitcnt lgkmcnt(5)
v_mfma_f32_16x16x32_bf16 v[0:3], v[232:235], v[192:195], v[0:3]
ds_read_b64_tr_b16 v[246:247], v254 offset:4352
v_mfma_f32_16x16x32_bf16 v[4:7], v[232:235], v[196:199], v[4:7]
v_exp_f32 v180, v180
v_mfma_f32_16x16x32_bf16 v[8:11], v[232:235], v[200:203], v[8:11]
ds_read_b64_tr_b16 v[232:233], v253 offset:512
s_waitcnt lgkmcnt(5)
v_mfma_f32_16x16x32_bf16 v[12:15], v[236:239], v[192:195], v[12:15]
ds_read_b64_tr_b16 v[234:235], v253 offset:4608
v_exp_f32 v181, v181
v_mfma_f32_16x16x32_bf16 v[16:19], v[236:239], v[196:199], v[16:19]
v_cvt_pk_bf16_f32 v213, v178, v179
v_mfma_f32_16x16x32_bf16 v[20:23], v[236:239], v[200:203], v[20:23]
ds_read_b64_tr_b16 v[236:237], v254 offset:512
s_waitcnt lgkmcnt(5)
v_mfma_f32_16x16x32_bf16 v[24:27], v[240:243], v[192:195], v[24:27]
ds_read_b64_tr_b16 v[238:239], v254 offset:4608
v_exp_f32 v182, v182
v_mfma_f32_16x16x32_bf16 v[28:31], v[240:243], v[196:199], v[28:31]
v_exp_f32 v183, v183
v_mfma_f32_16x16x32_bf16 v[32:35], v[240:243], v[200:203], v[32:35]
ds_read_b64_tr_b16 v[240:241], v253 offset:768
s_waitcnt lgkmcnt(5)
v_mfma_f32_16x16x32_bf16 v[36:39], v[244:247], v[192:195], v[36:39]
ds_read_b64_tr_b16 v[242:243], v253 offset:4864
v_cvt_pk_bf16_f32 v206, v180, v181
v_mfma_f32_16x16x32_bf16 v[40:43], v[244:247], v[196:199], v[40:43]
v_exp_f32 v184, v184
v_mfma_f32_16x16x32_bf16 v[44:47], v[244:247], v[200:203], v[44:47]
ds_read_b64_tr_b16 v[244:245], v254 offset:768
s_waitcnt lgkmcnt(5)
v_mfma_f32_16x16x32_bf16 v[48:51], v[232:235], v[192:195], v[48:51]
ds_read_b64_tr_b16 v[246:247], v254 offset:4864
v_mfma_f32_16x16x32_bf16 v[52:55], v[232:235], v[196:199], v[52:55]
s_barrier
v_mfma_f32_16x16x32_bf16 v[56:59], v[232:235], v[200:203], v[56:59]
ds_read_b128 v[232:235], v250 offset:24576
s_waitcnt lgkmcnt(5)
v_mfma_f32_16x16x32_bf16 v[60:63], v[236:239], v[192:195], v[60:63]
v_exp_f32 v185, v185
v_cvt_pk_bf16_f32 v207, v182, v183
v_mfma_f32_16x16x32_bf16 v[64:67], v[236:239], v[196:199], v[64:67]
v_exp_f32 v186, v186
v_mfma_f32_16x16x32_bf16 v[68:71], v[236:239], v[200:203], v[68:71]
ds_read_b128 v[236:239], v250 offset:24832
s_waitcnt lgkmcnt(4)
v_mfma_f32_16x16x32_bf16 v[72:75], v[240:243], v[192:195], v[72:75]
v_exp_f32 v187, v187
v_mfma_f32_16x16x32_bf16 v[76:79], v[240:243], v[196:199], v[76:79]
v_cvt_pk_bf16_f32 v210, v184, v185
v_mfma_f32_16x16x32_bf16 v[80:83], v[240:243], v[200:203], v[80:83]
ds_read_b128 v[240:243], v250 offset:25088
s_waitcnt lgkmcnt(3)
v_mfma_f32_16x16x32_bf16 v[84:87], v[244:247], v[192:195], v[84:87]
v_exp_f32 v188, v188
v_mfma_f32_16x16x32_bf16 v[88:91], v[244:247], v[196:199], v[88:91]
v_exp_f32 v189, v189
v_cvt_pk_bf16_f32 v211, v186, v187
v_mfma_f32_16x16x32_bf16 v[92:95], v[244:247], v[200:203], v[92:95]
ds_read_b128 v[244:247], v250 offset:25344
v_mfma_f32_16x16x32_bf16 v[216:219], v[228:231], v[192:195], v[216:219]
v_exp_f32 v190, v190
v_mfma_f32_16x16x32_bf16 v[220:223], v[228:231], v[196:199], v[220:223]
v_exp_f32 v191, v191
v_mfma_f32_16x16x32_bf16 v[224:227], v[228:231], v[200:203], v[224:227]
v_cvt_pk_bf16_f32 v214, v188, v189
s_nop 0
v_cvt_pk_bf16_f32 v215, v190, v191
s_waitcnt lgkmcnt(3)
v_mfma_f32_16x16x32_bf16 v[168:171], v[232:235], v[96:99], 0
v_exp_f32 v144, v144
v_mfma_f32_16x16x32_bf16 v[172:175], v[232:235], v[112:115], 0
v_exp_f32 v145, v145
v_mfma_f32_16x16x32_bf16 v[176:179], v[232:235], v[128:131], 0
ds_read_b128 v[232:235], v250 offset:28672
s_waitcnt lgkmcnt(3)
v_mfma_f32_16x16x32_bf16 v[168:171], v[236:239], v[100:103], v[168:171]
v_exp_f32 v146, v146
v_mfma_f32_16x16x32_bf16 v[172:175], v[236:239], v[116:119], v[172:175]
v_exp_f32 v147, v147
v_mfma_f32_16x16x32_bf16 v[176:179], v[236:239], v[132:135], v[176:179]
ds_read_b128 v[236:239], v250 offset:28928
s_waitcnt lgkmcnt(3)
v_mfma_f32_16x16x32_bf16 v[168:171], v[240:243], v[104:107], v[168:171]
v_cvt_pk_bf16_f32 v192, v144, v145
v_mfma_f32_16x16x32_bf16 v[172:175], v[240:243], v[120:123], v[172:175]
v_exp_f32 v148, v148
v_mfma_f32_16x16x32_bf16 v[176:179], v[240:243], v[136:139], v[176:179]
ds_read_b128 v[240:243], v250 offset:29184
s_waitcnt lgkmcnt(3)
v_mfma_f32_16x16x32_bf16 v[168:171], v[244:247], v[108:111], v[168:171]
v_exp_f32 v149, v149
v_cvt_pk_bf16_f32 v193, v146, v147
v_mfma_f32_16x16x32_bf16 v[172:175], v[244:247], v[124:127], v[172:175]
v_exp_f32 v150, v150
v_mfma_f32_16x16x32_bf16 v[176:179], v[244:247], v[140:143], v[176:179]
ds_read_b128 v[244:247], v250 offset:29440
s_waitcnt lgkmcnt(3)
v_mfma_f32_16x16x32_bf16 v[180:183], v[232:235], v[96:99], 0
v_exp_f32 v151, v151
v_mfma_f32_16x16x32_bf16 v[184:187], v[232:235], v[112:115], 0
v_cvt_pk_bf16_f32 v196, v148, v149
v_mfma_f32_16x16x32_bf16 v[188:191], v[232:235], v[128:131], 0
ds_read_b64_tr_b16 v[232:233], v253 offset:16384
s_waitcnt lgkmcnt(3)
v_mfma_f32_16x16x32_bf16 v[180:183], v[236:239], v[100:103], v[180:183]
ds_read_b64_tr_b16 v[234:235], v253 offset:20480
v_exp_f32 v152, v152
v_mfma_f32_16x16x32_bf16 v[184:187], v[236:239], v[116:119], v[184:187]
v_exp_f32 v153, v153
v_mfma_f32_16x16x32_bf16 v[188:191], v[236:239], v[132:135], v[188:191]
ds_read_b64_tr_b16 v[236:237], v254 offset:16384
s_waitcnt lgkmcnt(4)
v_mfma_f32_16x16x32_bf16 v[180:183], v[240:243], v[104:107], v[180:183]
ds_read_b64_tr_b16 v[238:239], v254 offset:20480
v_cvt_pk_bf16_f32 v197, v150, v151
v_mfma_f32_16x16x32_bf16 v[184:187], v[240:243], v[120:123], v[184:187]
v_exp_f32 v154, v154
v_mfma_f32_16x16x32_bf16 v[188:191], v[240:243], v[136:139], v[188:191]
ds_read_b64_tr_b16 v[240:241], v253 offset:16640
s_waitcnt lgkmcnt(5)
v_mfma_f32_16x16x32_bf16 v[180:183], v[244:247], v[108:111], v[180:183]
ds_read_b64_tr_b16 v[242:243], v253 offset:20736
v_mfma_f32_16x16x32_bf16 v[184:187], v[244:247], v[124:127], v[184:187]
v_exp_f32 v155, v155
v_cvt_pk_bf16_f32 v200, v152, v153
v_mfma_f32_16x16x32_bf16 v[188:191], v[244:247], v[140:143], v[188:191]
ds_read_b64_tr_b16 v[244:245], v254 offset:16640
s_waitcnt lgkmcnt(5)
v_mfma_f32_16x16x32_bf16 v[0:3], v[232:235], v[204:207], v[0:3]
ds_read_b64_tr_b16 v[246:247], v254 offset:20736
v_mfma_f32_16x16x32_bf16 v[4:7], v[232:235], v[208:211], v[4:7]
v_exp_f32 v156, v156
v_mfma_f32_16x16x32_bf16 v[8:11], v[232:235], v[212:215], v[8:11]
ds_read_b64_tr_b16 v[232:233], v253 offset:16896
s_waitcnt lgkmcnt(5)
v_mfma_f32_16x16x32_bf16 v[12:15], v[236:239], v[204:207], v[12:15]
ds_read_b64_tr_b16 v[234:235], v253 offset:20992
v_exp_f32 v157, v157
v_mfma_f32_16x16x32_bf16 v[16:19], v[236:239], v[208:211], v[16:19]
v_cvt_pk_bf16_f32 v201, v154, v155
v_mfma_f32_16x16x32_bf16 v[20:23], v[236:239], v[212:215], v[20:23]
ds_read_b64_tr_b16 v[236:237], v254 offset:16896
s_waitcnt lgkmcnt(5)
v_mfma_f32_16x16x32_bf16 v[24:27], v[240:243], v[204:207], v[24:27]
ds_read_b64_tr_b16 v[238:239], v254 offset:20992
v_exp_f32 v158, v158
v_mfma_f32_16x16x32_bf16 v[28:31], v[240:243], v[208:211], v[28:31]
v_exp_f32 v159, v159
v_mfma_f32_16x16x32_bf16 v[32:35], v[240:243], v[212:215], v[32:35]
ds_read_b64_tr_b16 v[240:241], v253 offset:17152
s_waitcnt lgkmcnt(5)
v_mfma_f32_16x16x32_bf16 v[36:39], v[244:247], v[204:207], v[36:39]
ds_read_b64_tr_b16 v[242:243], v253 offset:21248
v_cvt_pk_bf16_f32 v194, v156, v157
v_mfma_f32_16x16x32_bf16 v[40:43], v[244:247], v[208:211], v[40:43]
v_exp_f32 v160, v160
v_mfma_f32_16x16x32_bf16 v[44:47], v[244:247], v[212:215], v[44:47]
ds_read_b64_tr_b16 v[244:245], v254 offset:17152
s_waitcnt lgkmcnt(5)
v_mfma_f32_16x16x32_bf16 v[48:51], v[232:235], v[204:207], v[48:51]
ds_read_b64_tr_b16 v[246:247], v254 offset:21248
v_mfma_f32_16x16x32_bf16 v[52:55], v[232:235], v[208:211], v[52:55]
s_barrier
v_mfma_f32_16x16x32_bf16 v[56:59], v[232:235], v[212:215], v[56:59]
ds_read_b128 v[232:235], v251 offset:8192
s_waitcnt lgkmcnt(5)
v_mfma_f32_16x16x32_bf16 v[60:63], v[236:239], v[204:207], v[60:63]
v_exp_f32 v161, v161
v_cvt_pk_bf16_f32 v195, v158, v159
v_mfma_f32_16x16x32_bf16 v[64:67], v[236:239], v[208:211], v[64:67]
v_exp_f32 v162, v162
v_mfma_f32_16x16x32_bf16 v[68:71], v[236:239], v[212:215], v[68:71]
ds_read_b128 v[236:239], v251 offset:8448
s_waitcnt lgkmcnt(4)
v_mfma_f32_16x16x32_bf16 v[72:75], v[240:243], v[204:207], v[72:75]
v_exp_f32 v163, v163
v_mfma_f32_16x16x32_bf16 v[76:79], v[240:243], v[208:211], v[76:79]
v_cvt_pk_bf16_f32 v198, v160, v161
v_mfma_f32_16x16x32_bf16 v[80:83], v[240:243], v[212:215], v[80:83]
ds_read_b128 v[240:243], v251 offset:8704
s_waitcnt lgkmcnt(3)
v_mfma_f32_16x16x32_bf16 v[84:87], v[244:247], v[204:207], v[84:87]
v_exp_f32 v164, v164
v_mfma_f32_16x16x32_bf16 v[88:91], v[244:247], v[208:211], v[88:91]
v_exp_f32 v165, v165
v_cvt_pk_bf16_f32 v199, v162, v163
v_mfma_f32_16x16x32_bf16 v[92:95], v[244:247], v[212:215], v[92:95]
ds_read_b128 v[244:247], v251 offset:8960
v_mfma_f32_16x16x32_bf16 v[216:219], v[228:231], v[204:207], v[216:219]
v_exp_f32 v166, v166
v_mfma_f32_16x16x32_bf16 v[220:223], v[228:231], v[208:211], v[220:223]
v_exp_f32 v167, v167
v_mfma_f32_16x16x32_bf16 v[224:227], v[228:231], v[212:215], v[224:227]
v_cvt_pk_bf16_f32 v202, v164, v165
s_nop 0
v_cvt_pk_bf16_f32 v203, v166, v167
s_waitcnt lgkmcnt(3)
v_mfma_f32_16x16x32_bf16 v[144:147], v[232:235], v[96:99], 0
v_exp_f32 v168, v168
v_mfma_f32_16x16x32_bf16 v[148:151], v[232:235], v[112:115], 0
v_exp_f32 v169, v169
v_mfma_f32_16x16x32_bf16 v[152:155], v[232:235], v[128:131], 0
ds_read_b128 v[232:235], v251 offset:12288
s_waitcnt lgkmcnt(3)
v_mfma_f32_16x16x32_bf16 v[144:147], v[236:239], v[100:103], v[144:147]
v_exp_f32 v170, v170
v_mfma_f32_16x16x32_bf16 v[148:151], v[236:239], v[116:119], v[148:151]
v_exp_f32 v171, v171
v_mfma_f32_16x16x32_bf16 v[152:155], v[236:239], v[132:135], v[152:155]
ds_read_b128 v[236:239], v251 offset:12544
s_waitcnt lgkmcnt(3)
v_mfma_f32_16x16x32_bf16 v[144:147], v[240:243], v[104:107], v[144:147]
L_pg7:
s_cbranch_execz L_ret
v_cvt_pk_bf16_f32 v204, v168, v169
v_mfma_f32_16x16x32_bf16 v[148:151], v[240:243], v[120:123], v[148:151]
v_exp_f32 v172, v172
v_mfma_f32_16x16x32_bf16 v[152:155], v[240:243], v[136:139], v[152:155]
ds_read_b128 v[240:243], v251 offset:12800
s_waitcnt lgkmcnt(3)
v_mfma_f32_16x16x32_bf16 v[144:147], v[244:247], v[108:111], v[144:147]
v_exp_f32 v173, v173
v_cvt_pk_bf16_f32 v205, v170, v171
v_mfma_f32_16x16x32_bf16 v[148:151], v[244:247], v[124:127], v[148:151]
v_exp_f32 v174, v174
v_mfma_f32_16x16x32_bf16 v[152:155], v[244:247], v[140:143], v[152:155]
ds_read_b128 v[244:247], v251 offset:13056
s_waitcnt lgkmcnt(3)
v_mfma_f32_16x16x32_bf16 v[156:159], v[232:235], v[96:99], 0
v_exp_f32 v175, v175
v_mfma_f32_16x16x32_bf16 v[160:163], v[232:235], v[112:115], 0
v_cvt_pk_bf16_f32 v208, v172, v173
v_mfma_f32_16x16x32_bf16 v[164:167], v[232:235], v[128:131], 0
ds_read_b64_tr_b16 v[232:233], v248 offset:0
s_waitcnt lgkmcnt(3)
v_mfma_f32_16x16x32_bf16 v[156:159], v[236:239], v[100:103], v[156:159]
ds_read_b64_tr_b16 v[234:235], v248 offset:4096
v_exp_f32 v176, v176
v_mfma_f32_16x16x32_bf16 v[160:163], v[236:239], v[116:119], v[160:163]
v_exp_f32 v177, v177
v_mfma_f32_16x16x32_bf16 v[164:167], v[236:239], v[132:135], v[164:167]
ds_read_b64_tr_b16 v[236:237], v249 offset:0
s_waitcnt lgkmcnt(4)
v_mfma_f32_16x16x32_bf16 v[156:159], v[240:243], v[104:107], v[156:159]
ds_read_b64_tr_b16 v[238:239], v249 offset:4096
v_cvt_pk_bf16_f32 v209, v174, v175
v_mfma_f32_16x16x32_bf16 v[160:163], v[240:243], v[120:123], v[160:163]
v_exp_f32 v178, v178
v_mfma_f32_16x16x32_bf16 v[164:167], v[240:243], v[136:139], v[164:167]
ds_read_b64_tr_b16 v[240:241], v248 offset:256
s_waitcnt lgkmcnt(5)
v_mfma_f32_16x16x32_bf16 v[156:159], v[244:247], v[108:111], v[156:159]
ds_read_b64_tr_b16 v[242:243], v248 offset:4352
v_mfma_f32_16x16x32_bf16 v[160:163], v[244:247], v[124:127], v[160:163]
v_exp_f32 v179, v179
v_cvt_pk_bf16_f32 v212, v176, v177
v_mfma_f32_16x16x32_bf16 v[164:167], v[244:247], v[140:143], v[164:167]
ds_read_b64_tr_b16 v[244:245], v249 offset:256
s_waitcnt lgkmcnt(5)
v_mfma_f32_16x16x32_bf16 v[0:3], v[232:235], v[192:195], v[0:3]
ds_read_b64_tr_b16 v[246:247], v249 offset:4352
v_mfma_f32_16x16x32_bf16 v[4:7], v[232:235], v[196:199], v[4:7]
v_exp_f32 v180, v180
v_mfma_f32_16x16x32_bf16 v[8:11], v[232:235], v[200:203], v[8:11]
ds_read_b64_tr_b16 v[232:233], v248 offset:512
s_waitcnt lgkmcnt(5)
v_mfma_f32_16x16x32_bf16 v[12:15], v[236:239], v[192:195], v[12:15]
ds_read_b64_tr_b16 v[234:235], v248 offset:4608
v_exp_f32 v181, v181
v_mfma_f32_16x16x32_bf16 v[16:19], v[236:239], v[196:199], v[16:19]
v_cvt_pk_bf16_f32 v213, v178, v179
v_mfma_f32_16x16x32_bf16 v[20:23], v[236:239], v[200:203], v[20:23]
ds_read_b64_tr_b16 v[236:237], v249 offset:512
s_waitcnt lgkmcnt(5)
v_mfma_f32_16x16x32_bf16 v[24:27], v[240:243], v[192:195], v[24:27]
ds_read_b64_tr_b16 v[238:239], v249 offset:4608
v_exp_f32 v182, v182
v_mfma_f32_16x16x32_bf16 v[28:31], v[240:243], v[196:199], v[28:31]
v_exp_f32 v183, v183
v_mfma_f32_16x16x32_bf16 v[32:35], v[240:243], v[200:203], v[32:35]
ds_read_b64_tr_b16 v[240:241], v248 offset:768
s_waitcnt lgkmcnt(5)
v_mfma_f32_16x16x32_bf16 v[36:39], v[244:247], v[192:195], v[36:39]
ds_read_b64_tr_b16 v[242:243], v248 offset:4864
v_cvt_pk_bf16_f32 v206, v180, v181
v_mfma_f32_16x16x32_bf16 v[40:43], v[244:247], v[196:199], v[40:43]
v_exp_f32 v184, v184
v_mfma_f32_16x16x32_bf16 v[44:47], v[244:247], v[200:203], v[44:47]
ds_read_b64_tr_b16 v[244:245], v249 offset:768
s_waitcnt lgkmcnt(5)
v_mfma_f32_16x16x32_bf16 v[48:51], v[232:235], v[192:195], v[48:51]
ds_read_b64_tr_b16 v[246:247], v249 offset:4864
v_mfma_f32_16x16x32_bf16 v[52:55], v[232:235], v[196:199], v[52:55]
s_barrier
v_mfma_f32_16x16x32_bf16 v[56:59], v[232:235], v[200:203], v[56:59]
ds_read_b128 v[232:235], v251 offset:24576
s_waitcnt lgkmcnt(5)
v_mfma_f32_16x16x32_bf16 v[60:63], v[236:239], v[192:195], v[60:63]
v_exp_f32 v185, v185
v_cvt_pk_bf16_f32 v207, v182, v183
v_mfma_f32_16x16x32_bf16 v[64:67], v[236:239], v[196:199], v[64:67]
v_exp_f32 v186, v186
v_mfma_f32_16x16x32_bf16 v[68:71], v[236:239], v[200:203], v[68:71]
ds_read_b128 v[236:239], v251 offset:24832
s_waitcnt lgkmcnt(4)
v_mfma_f32_16x16x32_bf16 v[72:75], v[240:243], v[192:195], v[72:75]
v_exp_f32 v187, v187
v_mfma_f32_16x16x32_bf16 v[76:79], v[240:243], v[196:199], v[76:79]
v_cvt_pk_bf16_f32 v210, v184, v185
v_mfma_f32_16x16x32_bf16 v[80:83], v[240:243], v[200:203], v[80:83]
ds_read_b128 v[240:243], v251 offset:25088
s_waitcnt lgkmcnt(3)
v_mfma_f32_16x16x32_bf16 v[84:87], v[244:247], v[192:195], v[84:87]
v_exp_f32 v188, v188
v_mfma_f32_16x16x32_bf16 v[88:91], v[244:247], v[196:199], v[88:91]
v_exp_f32 v189, v189
v_cvt_pk_bf16_f32 v211, v186, v187
v_mfma_f32_16x16x32_bf16 v[92:95], v[244:247], v[200:203], v[92:95]
ds_read_b128 v[244:247], v251 offset:25344
v_mfma_f32_16x16x32_bf16 v[216:219], v[228:231], v[192:195], v[216:219]
v_exp_f32 v190, v190
v_mfma_f32_16x16x32_bf16 v[220:223], v[228:231], v[196:199], v[220:223]
v_exp_f32 v191, v191
v_mfma_f32_16x16x32_bf16 v[224:227], v[228:231], v[200:203], v[224:227]
v_cvt_pk_bf16_f32 v214, v188, v189
s_nop 0
v_cvt_pk_bf16_f32 v215, v190, v191
s_waitcnt lgkmcnt(3)
v_mfma_f32_16x16x32_bf16 v[168:171], v[232:235], v[96:99], 0
v_exp_f32 v144, v144
v_mfma_f32_16x16x32_bf16 v[172:175], v[232:235], v[112:115], 0
v_exp_f32 v145, v145
v_mfma_f32_16x16x32_bf16 v[176:179], v[232:235], v[128:131], 0
ds_read_b128 v[232:235], v251 offset:28672
s_waitcnt lgkmcnt(3)
v_mfma_f32_16x16x32_bf16 v[168:171], v[236:239], v[100:103], v[168:171]
v_exp_f32 v146, v146
v_mfma_f32_16x16x32_bf16 v[172:175], v[236:239], v[116:119], v[172:175]
v_exp_f32 v147, v147
v_mfma_f32_16x16x32_bf16 v[176:179], v[236:239], v[132:135], v[176:179]
ds_read_b128 v[236:239], v251 offset:28928
s_waitcnt lgkmcnt(3)
v_mfma_f32_16x16x32_bf16 v[168:171], v[240:243], v[104:107], v[168:171]
v_cvt_pk_bf16_f32 v192, v144, v145
v_mfma_f32_16x16x32_bf16 v[172:175], v[240:243], v[120:123], v[172:175]
v_exp_f32 v148, v148
v_mfma_f32_16x16x32_bf16 v[176:179], v[240:243], v[136:139], v[176:179]
ds_read_b128 v[240:243], v251 offset:29184
s_waitcnt lgkmcnt(3)
v_mfma_f32_16x16x32_bf16 v[168:171], v[244:247], v[108:111], v[168:171]
v_exp_f32 v149, v149
v_cvt_pk_bf16_f32 v193, v146, v147
v_mfma_f32_16x16x32_bf16 v[172:175], v[244:247], v[124:127], v[172:175]
v_exp_f32 v150, v150
v_mfma_f32_16x16x32_bf16 v[176:179], v[244:247], v[140:143], v[176:179]
ds_read_b128 v[244:247], v251 offset:29440
s_waitcnt lgkmcnt(3)
v_mfma_f32_16x16x32_bf16 v[180:183], v[232:235], v[96:99], 0
v_exp_f32 v151, v151
v_mfma_f32_16x16x32_bf16 v[184:187], v[232:235], v[112:115], 0
v_cvt_pk_bf16_f32 v196, v148, v149
v_mfma_f32_16x16x32_bf16 v[188:191], v[232:235], v[128:131], 0
ds_read_b64_tr_b16 v[232:233], v248 offset:16384
s_waitcnt lgkmcnt(3)
v_mfma_f32_16x16x32_bf16 v[180:183], v[236:239], v[100:103], v[180:183]
ds_read_b64_tr_b16 v[234:235], v248 offset:20480
v_exp_f32 v152, v152
v_mfma_f32_16x16x32_bf16 v[184:187], v[236:239], v[116:119], v[184:187]
v_exp_f32 v153, v153
v_mfma_f32_16x16x32_bf16 v[188:191], v[236:239], v[132:135], v[188:191]
ds_read_b64_tr_b16 v[236:237], v249 offset:16384
s_waitcnt lgkmcnt(4)
v_mfma_f32_16x16x32_bf16 v[180:183], v[240:243], v[104:107], v[180:183]
ds_read_b64_tr_b16 v[238:239], v249 offset:20480
v_cvt_pk_bf16_f32 v197, v150, v151
v_mfma_f32_16x16x32_bf16 v[184:187], v[240:243], v[120:123], v[184:187]
v_exp_f32 v154, v154
v_mfma_f32_16x16x32_bf16 v[188:191], v[240:243], v[136:139], v[188:191]
ds_read_b64_tr_b16 v[240:241], v248 offset:16640
s_waitcnt lgkmcnt(5)
v_mfma_f32_16x16x32_bf16 v[180:183], v[244:247], v[108:111], v[180:183]
ds_read_b64_tr_b16 v[242:243], v248 offset:20736
v_mfma_f32_16x16x32_bf16 v[184:187], v[244:247], v[124:127], v[184:187]
v_exp_f32 v155, v155
v_cvt_pk_bf16_f32 v200, v152, v153
v_mfma_f32_16x16x32_bf16 v[188:191], v[244:247], v[140:143], v[188:191]
ds_read_b64_tr_b16 v[244:245], v249 offset:16640
s_waitcnt lgkmcnt(5)
v_mfma_f32_16x16x32_bf16 v[0:3], v[232:235], v[204:207], v[0:3]
ds_read_b64_tr_b16 v[246:247], v249 offset:20736
v_mfma_f32_16x16x32_bf16 v[4:7], v[232:235], v[208:211], v[4:7]
v_exp_f32 v156, v156
v_mfma_f32_16x16x32_bf16 v[8:11], v[232:235], v[212:215], v[8:11]
ds_read_b64_tr_b16 v[232:233], v248 offset:16896
s_waitcnt lgkmcnt(5)
v_mfma_f32_16x16x32_bf16 v[12:15], v[236:239], v[204:207], v[12:15]
ds_read_b64_tr_b16 v[234:235], v248 offset:20992
v_exp_f32 v157, v157
v_mfma_f32_16x16x32_bf16 v[16:19], v[236:239], v[208:211], v[16:19]
v_cvt_pk_bf16_f32 v201, v154, v155
v_mfma_f32_16x16x32_bf16 v[20:23], v[236:239], v[212:215], v[20:23]
ds_read_b64_tr_b16 v[236:237], v249 offset:16896
s_waitcnt lgkmcnt(5)
v_mfma_f32_16x16x32_bf16 v[24:27], v[240:243], v[204:207], v[24:27]
ds_read_b64_tr_b16 v[238:239], v249 offset:20992
v_exp_f32 v158, v158
v_mfma_f32_16x16x32_bf16 v[28:31], v[240:243], v[208:211], v[28:31]
v_exp_f32 v159, v159
v_mfma_f32_16x16x32_bf16 v[32:35], v[240:243], v[212:215], v[32:35]
ds_read_b64_tr_b16 v[240:241], v248 offset:17152
s_waitcnt lgkmcnt(5)
v_mfma_f32_16x16x32_bf16 v[36:39], v[244:247], v[204:207], v[36:39]
ds_read_b64_tr_b16 v[242:243], v248 offset:21248
v_cvt_pk_bf16_f32 v194, v156, v157
v_mfma_f32_16x16x32_bf16 v[40:43], v[244:247], v[208:211], v[40:43]
v_exp_f32 v160, v160
v_mfma_f32_16x16x32_bf16 v[44:47], v[244:247], v[212:215], v[44:47]
ds_read_b64_tr_b16 v[244:245], v249 offset:17152
s_waitcnt lgkmcnt(5)
v_mfma_f32_16x16x32_bf16 v[48:51], v[232:235], v[204:207], v[48:51]
ds_read_b64_tr_b16 v[246:247], v249 offset:21248
v_mfma_f32_16x16x32_bf16 v[52:55], v[232:235], v[208:211], v[52:55]
s_barrier
v_mfma_f32_16x16x32_bf16 v[56:59], v[232:235], v[212:215], v[56:59]
ds_read_b128 v[232:235], v251 offset:40960
s_waitcnt lgkmcnt(5)
v_mfma_f32_16x16x32_bf16 v[60:63], v[236:239], v[204:207], v[60:63]
v_exp_f32 v161, v161
v_cvt_pk_bf16_f32 v195, v158, v159
v_mfma_f32_16x16x32_bf16 v[64:67], v[236:239], v[208:211], v[64:67]
v_exp_f32 v162, v162
v_mfma_f32_16x16x32_bf16 v[68:71], v[236:239], v[212:215], v[68:71]
ds_read_b128 v[236:239], v251 offset:41216
s_waitcnt lgkmcnt(4)
v_mfma_f32_16x16x32_bf16 v[72:75], v[240:243], v[204:207], v[72:75]
v_exp_f32 v163, v163
v_mfma_f32_16x16x32_bf16 v[76:79], v[240:243], v[208:211], v[76:79]
v_cvt_pk_bf16_f32 v198, v160, v161
v_mfma_f32_16x16x32_bf16 v[80:83], v[240:243], v[212:215], v[80:83]
ds_read_b128 v[240:243], v251 offset:41472
s_waitcnt lgkmcnt(3)
v_mfma_f32_16x16x32_bf16 v[84:87], v[244:247], v[204:207], v[84:87]
v_exp_f32 v164, v164
v_mfma_f32_16x16x32_bf16 v[88:91], v[244:247], v[208:211], v[88:91]
v_exp_f32 v165, v165
v_cvt_pk_bf16_f32 v199, v162, v163
v_mfma_f32_16x16x32_bf16 v[92:95], v[244:247], v[212:215], v[92:95]
ds_read_b128 v[244:247], v251 offset:41728
v_mfma_f32_16x16x32_bf16 v[216:219], v[228:231], v[204:207], v[216:219]
v_exp_f32 v166, v166
v_mfma_f32_16x16x32_bf16 v[220:223], v[228:231], v[208:211], v[220:223]
v_exp_f32 v167, v167
v_mfma_f32_16x16x32_bf16 v[224:227], v[228:231], v[212:215], v[224:227]
v_cvt_pk_bf16_f32 v202, v164, v165
s_nop 0
v_cvt_pk_bf16_f32 v203, v166, v167
s_waitcnt lgkmcnt(3)
v_mfma_f32_16x16x32_bf16 v[144:147], v[232:235], v[96:99], 0
v_exp_f32 v168, v168
v_mfma_f32_16x16x32_bf16 v[148:151], v[232:235], v[112:115], 0
v_exp_f32 v169, v169
v_mfma_f32_16x16x32_bf16 v[152:155], v[232:235], v[128:131], 0
ds_read_b128 v[232:235], v251 offset:45056
s_waitcnt lgkmcnt(3)
v_mfma_f32_16x16x32_bf16 v[144:147], v[236:239], v[100:103], v[144:147]
v_exp_f32 v170, v170
v_mfma_f32_16x16x32_bf16 v[148:151], v[236:239], v[116:119], v[148:151]
v_exp_f32 v171, v171
v_mfma_f32_16x16x32_bf16 v[152:155], v[236:239], v[132:135], v[152:155]
ds_read_b128 v[236:239], v251 offset:45312
s_waitcnt lgkmcnt(3)
v_mfma_f32_16x16x32_bf16 v[144:147], v[240:243], v[104:107], v[144:147]
v_cvt_pk_bf16_f32 v204, v168, v169
v_mfma_f32_16x16x32_bf16 v[148:151], v[240:243], v[120:123], v[148:151]
v_exp_f32 v172, v172
v_mfma_f32_16x16x32_bf16 v[152:155], v[240:243], v[136:139], v[152:155]
ds_read_b128 v[240:243], v251 offset:45568
s_waitcnt lgkmcnt(3)
v_mfma_f32_16x16x32_bf16 v[144:147], v[244:247], v[108:111], v[144:147]
v_exp_f32 v173, v173
v_cvt_pk_bf16_f32 v205, v170, v171
v_mfma_f32_16x16x32_bf16 v[148:151], v[244:247], v[124:127], v[148:151]
v_exp_f32 v174, v174
v_mfma_f32_16x16x32_bf16 v[152:155], v[244:247], v[140:143], v[152:155]
ds_read_b128 v[244:247], v251 offset:45824
s_waitcnt lgkmcnt(3)
v_mfma_f32_16x16x32_bf16 v[156:159], v[232:235], v[96:99], 0
v_exp_f32 v175, v175
v_mfma_f32_16x16x32_bf16 v[160:163], v[232:235], v[112:115], 0
v_cvt_pk_bf16_f32 v208, v172, v173
v_mfma_f32_16x16x32_bf16 v[164:167], v[232:235], v[128:131], 0
ds_read_b64_tr_b16 v[232:233], v248 offset:32768
s_waitcnt lgkmcnt(3)
v_mfma_f32_16x16x32_bf16 v[156:159], v[236:239], v[100:103], v[156:159]
ds_read_b64_tr_b16 v[234:235], v248 offset:36864
v_exp_f32 v176, v176
v_mfma_f32_16x16x32_bf16 v[160:163], v[236:239], v[116:119], v[160:163]
v_exp_f32 v177, v177
v_mfma_f32_16x16x32_bf16 v[164:167], v[236:239], v[132:135], v[164:167]
ds_read_b64_tr_b16 v[236:237], v249 offset:32768
s_waitcnt lgkmcnt(4)
v_mfma_f32_16x16x32_bf16 v[156:159], v[240:243], v[104:107], v[156:159]
ds_read_b64_tr_b16 v[238:239], v249 offset:36864
v_cvt_pk_bf16_f32 v209, v174, v175
v_mfma_f32_16x16x32_bf16 v[160:163], v[240:243], v[120:123], v[160:163]
v_exp_f32 v178, v178
v_mfma_f32_16x16x32_bf16 v[164:167], v[240:243], v[136:139], v[164:167]
ds_read_b64_tr_b16 v[240:241], v248 offset:33024
s_waitcnt lgkmcnt(5)
v_mfma_f32_16x16x32_bf16 v[156:159], v[244:247], v[108:111], v[156:159]
ds_read_b64_tr_b16 v[242:243], v248 offset:37120
v_mfma_f32_16x16x32_bf16 v[160:163], v[244:247], v[124:127], v[160:163]
v_exp_f32 v179, v179
v_cvt_pk_bf16_f32 v212, v176, v177
v_mfma_f32_16x16x32_bf16 v[164:167], v[244:247], v[140:143], v[164:167]
ds_read_b64_tr_b16 v[244:245], v249 offset:33024
s_waitcnt lgkmcnt(5)
v_mfma_f32_16x16x32_bf16 v[0:3], v[232:235], v[192:195], v[0:3]
ds_read_b64_tr_b16 v[246:247], v249 offset:37120
v_mfma_f32_16x16x32_bf16 v[4:7], v[232:235], v[196:199], v[4:7]
v_exp_f32 v180, v180
v_mfma_f32_16x16x32_bf16 v[8:11], v[232:235], v[200:203], v[8:11]
ds_read_b64_tr_b16 v[232:233], v248 offset:33280
s_waitcnt lgkmcnt(5)
v_mfma_f32_16x16x32_bf16 v[12:15], v[236:239], v[192:195], v[12:15]
ds_read_b64_tr_b16 v[234:235], v248 offset:37376
v_exp_f32 v181, v181
v_mfma_f32_16x16x32_bf16 v[16:19], v[236:239], v[196:199], v[16:19]
v_cvt_pk_bf16_f32 v213, v178, v179
v_mfma_f32_16x16x32_bf16 v[20:23], v[236:239], v[200:203], v[20:23]
ds_read_b64_tr_b16 v[236:237], v249 offset:33280
s_waitcnt lgkmcnt(5)
v_mfma_f32_16x16x32_bf16 v[24:27], v[240:243], v[192:195], v[24:27]
ds_read_b64_tr_b16 v[238:239], v249 offset:37376
v_exp_f32 v182, v182
v_mfma_f32_16x16x32_bf16 v[28:31], v[240:243], v[196:199], v[28:31]
v_exp_f32 v183, v183
v_mfma_f32_16x16x32_bf16 v[32:35], v[240:243], v[200:203], v[32:35]
ds_read_b64_tr_b16 v[240:241], v248 offset:33536
s_waitcnt lgkmcnt(5)
v_mfma_f32_16x16x32_bf16 v[36:39], v[244:247], v[192:195], v[36:39]
ds_read_b64_tr_b16 v[242:243], v248 offset:37632
v_cvt_pk_bf16_f32 v206, v180, v181
v_mfma_f32_16x16x32_bf16 v[40:43], v[244:247], v[196:199], v[40:43]
v_exp_f32 v184, v184
v_mfma_f32_16x16x32_bf16 v[44:47], v[244:247], v[200:203], v[44:47]
ds_read_b64_tr_b16 v[244:245], v249 offset:33536
s_waitcnt lgkmcnt(5)
v_mfma_f32_16x16x32_bf16 v[48:51], v[232:235], v[192:195], v[48:51]
ds_read_b64_tr_b16 v[246:247], v249 offset:37632
v_mfma_f32_16x16x32_bf16 v[52:55], v[232:235], v[196:199], v[52:55]
s_barrier
v_mfma_f32_16x16x32_bf16 v[56:59], v[232:235], v[200:203], v[56:59]
ds_read_b128 v[232:235], v251 offset:57344
s_waitcnt lgkmcnt(5)
v_mfma_f32_16x16x32_bf16 v[60:63], v[236:239], v[192:195], v[60:63]
v_exp_f32 v185, v185
v_cvt_pk_bf16_f32 v207, v182, v183
v_mfma_f32_16x16x32_bf16 v[64:67], v[236:239], v[196:199], v[64:67]
v_exp_f32 v186, v186
v_mfma_f32_16x16x32_bf16 v[68:71], v[236:239], v[200:203], v[68:71]
ds_read_b128 v[236:239], v251 offset:57600
s_waitcnt lgkmcnt(4)
v_mfma_f32_16x16x32_bf16 v[72:75], v[240:243], v[192:195], v[72:75]
v_exp_f32 v187, v187
v_mfma_f32_16x16x32_bf16 v[76:79], v[240:243], v[196:199], v[76:79]
v_cvt_pk_bf16_f32 v210, v184, v185
v_mfma_f32_16x16x32_bf16 v[80:83], v[240:243], v[200:203], v[80:83]
ds_read_b128 v[240:243], v251 offset:57856
s_waitcnt lgkmcnt(3)
v_mfma_f32_16x16x32_bf16 v[84:87], v[244:247], v[192:195], v[84:87]
v_exp_f32 v188, v188
v_mfma_f32_16x16x32_bf16 v[88:91], v[244:247], v[196:199], v[88:91]
v_exp_f32 v189, v189
v_cvt_pk_bf16_f32 v211, v186, v187
v_mfma_f32_16x16x32_bf16 v[92:95], v[244:247], v[200:203], v[92:95]
ds_read_b128 v[244:247], v251 offset:58112
v_mfma_f32_16x16x32_bf16 v[216:219], v[228:231], v[192:195], v[216:219]
v_exp_f32 v190, v190
v_mfma_f32_16x16x32_bf16 v[220:223], v[228:231], v[196:199], v[220:223]
v_exp_f32 v191, v191
v_mfma_f32_16x16x32_bf16 v[224:227], v[228:231], v[200:203], v[224:227]
v_cvt_pk_bf16_f32 v214, v188, v189
s_nop 0
v_cvt_pk_bf16_f32 v215, v190, v191
s_waitcnt lgkmcnt(3)
v_mfma_f32_16x16x32_bf16 v[168:171], v[232:235], v[96:99], 0
v_exp_f32 v144, v144
v_mfma_f32_16x16x32_bf16 v[172:175], v[232:235], v[112:115], 0
v_exp_f32 v145, v145
v_mfma_f32_16x16x32_bf16 v[176:179], v[232:235], v[128:131], 0
ds_read_b128 v[232:235], v251 offset:61440
s_waitcnt lgkmcnt(3)
v_mfma_f32_16x16x32_bf16 v[168:171], v[236:239], v[100:103], v[168:171]
v_exp_f32 v146, v146
v_mfma_f32_16x16x32_bf16 v[172:175], v[236:239], v[116:119], v[172:175]
v_exp_f32 v147, v147
v_mfma_f32_16x16x32_bf16 v[176:179], v[236:239], v[132:135], v[176:179]
ds_read_b128 v[236:239], v251 offset:61696
s_waitcnt lgkmcnt(3)
v_mfma_f32_16x16x32_bf16 v[168:171], v[240:243], v[104:107], v[168:171]
v_cvt_pk_bf16_f32 v192, v144, v145
v_mfma_f32_16x16x32_bf16 v[172:175], v[240:243], v[120:123], v[172:175]
v_exp_f32 v148, v148
v_mfma_f32_16x16x32_bf16 v[176:179], v[240:243], v[136:139], v[176:179]
ds_read_b128 v[240:243], v251 offset:61952
s_waitcnt lgkmcnt(3)
v_mfma_f32_16x16x32_bf16 v[168:171], v[244:247], v[108:111], v[168:171]
v_exp_f32 v149, v149
v_cvt_pk_bf16_f32 v193, v146, v147
v_mfma_f32_16x16x32_bf16 v[172:175], v[244:247], v[124:127], v[172:175]
v_exp_f32 v150, v150
v_mfma_f32_16x16x32_bf16 v[176:179], v[244:247], v[140:143], v[176:179]
ds_read_b128 v[244:247], v251 offset:62208
s_waitcnt lgkmcnt(3)
v_mfma_f32_16x16x32_bf16 v[180:183], v[232:235], v[96:99], 0
v_exp_f32 v151, v151
v_mfma_f32_16x16x32_bf16 v[184:187], v[232:235], v[112:115], 0
v_cvt_pk_bf16_f32 v196, v148, v149
v_mfma_f32_16x16x32_bf16 v[188:191], v[232:235], v[128:131], 0
ds_read_b64_tr_b16 v[232:233], v248 offset:49152
s_waitcnt lgkmcnt(3)
v_mfma_f32_16x16x32_bf16 v[180:183], v[236:239], v[100:103], v[180:183]
ds_read_b64_tr_b16 v[234:235], v248 offset:53248
v_exp_f32 v152, v152
v_mfma_f32_16x16x32_bf16 v[184:187], v[236:239], v[116:119], v[184:187]
v_exp_f32 v153, v153
v_mfma_f32_16x16x32_bf16 v[188:191], v[236:239], v[132:135], v[188:191]
ds_read_b64_tr_b16 v[236:237], v249 offset:49152
s_waitcnt lgkmcnt(4)
v_mfma_f32_16x16x32_bf16 v[180:183], v[240:243], v[104:107], v[180:183]
ds_read_b64_tr_b16 v[238:239], v249 offset:53248
v_cvt_pk_bf16_f32 v197, v150, v151
v_mfma_f32_16x16x32_bf16 v[184:187], v[240:243], v[120:123], v[184:187]
v_exp_f32 v154, v154
v_mfma_f32_16x16x32_bf16 v[188:191], v[240:243], v[136:139], v[188:191]
ds_read_b64_tr_b16 v[240:241], v248 offset:49408
s_waitcnt lgkmcnt(5)
v_mfma_f32_16x16x32_bf16 v[180:183], v[244:247], v[108:111], v[180:183]
ds_read_b64_tr_b16 v[242:243], v248 offset:53504
v_mfma_f32_16x16x32_bf16 v[184:187], v[244:247], v[124:127], v[184:187]
v_exp_f32 v155, v155
v_cvt_pk_bf16_f32 v200, v152, v153
v_mfma_f32_16x16x32_bf16 v[188:191], v[244:247], v[140:143], v[188:191]
ds_read_b64_tr_b16 v[244:245], v249 offset:49408
s_waitcnt lgkmcnt(5)
v_mfma_f32_16x16x32_bf16 v[0:3], v[232:235], v[204:207], v[0:3]
ds_read_b64_tr_b16 v[246:247], v249 offset:53504
v_mfma_f32_16x16x32_bf16 v[4:7], v[232:235], v[208:211], v[4:7]
v_exp_f32 v156, v156
v_mfma_f32_16x16x32_bf16 v[8:11], v[232:235], v[212:215], v[8:11]
ds_read_b64_tr_b16 v[232:233], v248 offset:49664
s_waitcnt lgkmcnt(5)
v_mfma_f32_16x16x32_bf16 v[12:15], v[236:239], v[204:207], v[12:15]
ds_read_b64_tr_b16 v[234:235], v248 offset:53760
v_exp_f32 v157, v157
v_mfma_f32_16x16x32_bf16 v[16:19], v[236:239], v[208:211], v[16:19]
v_cvt_pk_bf16_f32 v201, v154, v155
v_mfma_f32_16x16x32_bf16 v[20:23], v[236:239], v[212:215], v[20:23]
ds_read_b64_tr_b16 v[236:237], v249 offset:49664
s_waitcnt lgkmcnt(5)
v_mfma_f32_16x16x32_bf16 v[24:27], v[240:243], v[204:207], v[24:27]
ds_read_b64_tr_b16 v[238:239], v249 offset:53760
v_exp_f32 v158, v158
v_mfma_f32_16x16x32_bf16 v[28:31], v[240:243], v[208:211], v[28:31]
v_exp_f32 v159, v159
v_mfma_f32_16x16x32_bf16 v[32:35], v[240:243], v[212:215], v[32:35]
ds_read_b64_tr_b16 v[240:241], v248 offset:49920
s_waitcnt lgkmcnt(5)
v_mfma_f32_16x16x32_bf16 v[36:39], v[244:247], v[204:207], v[36:39]
ds_read_b64_tr_b16 v[242:243], v248 offset:54016
v_cvt_pk_bf16_f32 v194, v156, v157
v_mfma_f32_16x16x32_bf16 v[40:43], v[244:247], v[208:211], v[40:43]
v_exp_f32 v160, v160
v_mfma_f32_16x16x32_bf16 v[44:47], v[244:247], v[212:215], v[44:47]
ds_read_b64_tr_b16 v[244:245], v249 offset:49920
s_waitcnt lgkmcnt(5)
v_mfma_f32_16x16x32_bf16 v[48:51], v[232:235], v[204:207], v[48:51]
ds_read_b64_tr_b16 v[246:247], v249 offset:54016
v_mfma_f32_16x16x32_bf16 v[52:55], v[232:235], v[208:211], v[52:55]
s_barrier
v_mfma_f32_16x16x32_bf16 v[56:59], v[232:235], v[212:215], v[56:59]
ds_read_b128 v[232:235], v250 offset:8192
s_waitcnt lgkmcnt(5)
v_mfma_f32_16x16x32_bf16 v[60:63], v[236:239], v[204:207], v[60:63]
v_exp_f32 v161, v161
v_cvt_pk_bf16_f32 v195, v158, v159
v_mfma_f32_16x16x32_bf16 v[64:67], v[236:239], v[208:211], v[64:67]
v_exp_f32 v162, v162
v_mfma_f32_16x16x32_bf16 v[68:71], v[236:239], v[212:215], v[68:71]
ds_read_b128 v[236:239], v250 offset:8448
s_waitcnt lgkmcnt(4)
v_mfma_f32_16x16x32_bf16 v[72:75], v[240:243], v[204:207], v[72:75]
v_exp_f32 v163, v163
v_mfma_f32_16x16x32_bf16 v[76:79], v[240:243], v[208:211], v[76:79]
v_cvt_pk_bf16_f32 v198, v160, v161
v_mfma_f32_16x16x32_bf16 v[80:83], v[240:243], v[212:215], v[80:83]
ds_read_b128 v[240:243], v250 offset:8704
s_waitcnt lgkmcnt(3)
v_mfma_f32_16x16x32_bf16 v[84:87], v[244:247], v[204:207], v[84:87]
v_exp_f32 v164, v164
v_mfma_f32_16x16x32_bf16 v[88:91], v[244:247], v[208:211], v[88:91]
v_exp_f32 v165, v165
v_cvt_pk_bf16_f32 v199, v162, v163
v_mfma_f32_16x16x32_bf16 v[92:95], v[244:247], v[212:215], v[92:95]
ds_read_b128 v[244:247], v250 offset:8960
v_mfma_f32_16x16x32_bf16 v[216:219], v[228:231], v[204:207], v[216:219]
v_exp_f32 v166, v166
v_mfma_f32_16x16x32_bf16 v[220:223], v[228:231], v[208:211], v[220:223]
v_exp_f32 v167, v167
v_mfma_f32_16x16x32_bf16 v[224:227], v[228:231], v[212:215], v[224:227]
v_cvt_pk_bf16_f32 v202, v164, v165
s_nop 0
v_cvt_pk_bf16_f32 v203, v166, v167
s_waitcnt lgkmcnt(3)
v_mfma_f32_16x16x32_bf16 v[144:147], v[232:235], v[96:99], 0
v_exp_f32 v168, v168
v_mfma_f32_16x16x32_bf16 v[148:151], v[232:235], v[112:115], 0
v_exp_f32 v169, v169
v_mfma_f32_16x16x32_bf16 v[152:155], v[232:235], v[128:131], 0
ds_read_b128 v[232:235], v250 offset:12288
s_waitcnt lgkmcnt(3)
v_mfma_f32_16x16x32_bf16 v[144:147], v[236:239], v[100:103], v[144:147]
v_exp_f32 v170, v170
v_mfma_f32_16x16x32_bf16 v[148:151], v[236:239], v[116:119], v[148:151]
v_exp_f32 v171, v171
v_mfma_f32_16x16x32_bf16 v[152:155], v[236:239], v[132:135], v[152:155]
ds_read_b128 v[236:239], v250 offset:12544
s_waitcnt lgkmcnt(3)
v_mfma_f32_16x16x32_bf16 v[144:147], v[240:243], v[104:107], v[144:147]
v_cvt_pk_bf16_f32 v204, v168, v169
v_mfma_f32_16x16x32_bf16 v[148:151], v[240:243], v[120:123], v[148:151]
v_exp_f32 v172, v172
v_mfma_f32_16x16x32_bf16 v[152:155], v[240:243], v[136:139], v[152:155]
ds_read_b128 v[240:243], v250 offset:12800
s_waitcnt lgkmcnt(3)
v_mfma_f32_16x16x32_bf16 v[144:147], v[244:247], v[108:111], v[144:147]
v_exp_f32 v173, v173
v_cvt_pk_bf16_f32 v205, v170, v171
v_mfma_f32_16x16x32_bf16 v[148:151], v[244:247], v[124:127], v[148:151]
v_exp_f32 v174, v174
v_mfma_f32_16x16x32_bf16 v[152:155], v[244:247], v[140:143], v[152:155]
ds_read_b128 v[244:247], v250 offset:13056
s_waitcnt lgkmcnt(3)
v_mfma_f32_16x16x32_bf16 v[156:159], v[232:235], v[96:99], 0
v_exp_f32 v175, v175
v_mfma_f32_16x16x32_bf16 v[160:163], v[232:235], v[112:115], 0
v_cvt_pk_bf16_f32 v208, v172, v173
v_mfma_f32_16x16x32_bf16 v[164:167], v[232:235], v[128:131], 0
ds_read_b64_tr_b16 v[232:233], v253 offset:0
s_waitcnt lgkmcnt(3)
v_mfma_f32_16x16x32_bf16 v[156:159], v[236:239], v[100:103], v[156:159]
ds_read_b64_tr_b16 v[234:235], v253 offset:4096
v_exp_f32 v176, v176
v_mfma_f32_16x16x32_bf16 v[160:163], v[236:239], v[116:119], v[160:163]
v_exp_f32 v177, v177
v_mfma_f32_16x16x32_bf16 v[164:167], v[236:239], v[132:135], v[164:167]
ds_read_b64_tr_b16 v[236:237], v254 offset:0
s_waitcnt lgkmcnt(4)
v_mfma_f32_16x16x32_bf16 v[156:159], v[240:243], v[104:107], v[156:159]
ds_read_b64_tr_b16 v[238:239], v254 offset:4096
v_cvt_pk_bf16_f32 v209, v174, v175
v_mfma_f32_16x16x32_bf16 v[160:163], v[240:243], v[120:123], v[160:163]
v_exp_f32 v178, v178
v_mfma_f32_16x16x32_bf16 v[164:167], v[240:243], v[136:139], v[164:167]
ds_read_b64_tr_b16 v[240:241], v253 offset:256
s_waitcnt lgkmcnt(5)
v_mfma_f32_16x16x32_bf16 v[156:159], v[244:247], v[108:111], v[156:159]
ds_read_b64_tr_b16 v[242:243], v253 offset:4352
v_mfma_f32_16x16x32_bf16 v[160:163], v[244:247], v[124:127], v[160:163]
v_exp_f32 v179, v179
v_cvt_pk_bf16_f32 v212, v176, v177
v_mfma_f32_16x16x32_bf16 v[164:167], v[244:247], v[140:143], v[164:167]
ds_read_b64_tr_b16 v[244:245], v254 offset:256
s_waitcnt lgkmcnt(5)
v_mfma_f32_16x16x32_bf16 v[0:3], v[232:235], v[192:195], v[0:3]
ds_read_b64_tr_b16 v[246:247], v254 offset:4352
v_mfma_f32_16x16x32_bf16 v[4:7], v[232:235], v[196:199], v[4:7]
v_exp_f32 v180, v180
v_mfma_f32_16x16x32_bf16 v[8:11], v[232:235], v[200:203], v[8:11]
ds_read_b64_tr_b16 v[232:233], v253 offset:512
s_waitcnt lgkmcnt(5)
v_mfma_f32_16x16x32_bf16 v[12:15], v[236:239], v[192:195], v[12:15]
ds_read_b64_tr_b16 v[234:235], v253 offset:4608
v_exp_f32 v181, v181
v_mfma_f32_16x16x32_bf16 v[16:19], v[236:239], v[196:199], v[16:19]
v_cvt_pk_bf16_f32 v213, v178, v179
v_mfma_f32_16x16x32_bf16 v[20:23], v[236:239], v[200:203], v[20:23]
ds_read_b64_tr_b16 v[236:237], v254 offset:512
s_waitcnt lgkmcnt(5)
v_mfma_f32_16x16x32_bf16 v[24:27], v[240:243], v[192:195], v[24:27]
ds_read_b64_tr_b16 v[238:239], v254 offset:4608
v_exp_f32 v182, v182
v_mfma_f32_16x16x32_bf16 v[28:31], v[240:243], v[196:199], v[28:31]
v_exp_f32 v183, v183
v_mfma_f32_16x16x32_bf16 v[32:35], v[240:243], v[200:203], v[32:35]
ds_read_b64_tr_b16 v[240:241], v253 offset:768
s_waitcnt lgkmcnt(5)
v_mfma_f32_16x16x32_bf16 v[36:39], v[244:247], v[192:195], v[36:39]
ds_read_b64_tr_b16 v[242:243], v253 offset:4864
v_cvt_pk_bf16_f32 v206, v180, v181
v_mfma_f32_16x16x32_bf16 v[40:43], v[244:247], v[196:199], v[40:43]
v_exp_f32 v184, v184
v_mfma_f32_16x16x32_bf16 v[44:47], v[244:247], v[200:203], v[44:47]
ds_read_b64_tr_b16 v[244:245], v254 offset:768
s_waitcnt lgkmcnt(5)
v_mfma_f32_16x16x32_bf16 v[48:51], v[232:235], v[192:195], v[48:51]
ds_read_b64_tr_b16 v[246:247], v254 offset:4864
v_mfma_f32_16x16x32_bf16 v[52:55], v[232:235], v[196:199], v[52:55]
s_barrier
v_mfma_f32_16x16x32_bf16 v[56:59], v[232:235], v[200:203], v[56:59]
ds_read_b128 v[232:235], v250 offset:24576
s_waitcnt lgkmcnt(5)
v_mfma_f32_16x16x32_bf16 v[60:63], v[236:239], v[192:195], v[60:63]
v_exp_f32 v185, v185
v_cvt_pk_bf16_f32 v207, v182, v183
v_mfma_f32_16x16x32_bf16 v[64:67], v[236:239], v[196:199], v[64:67]
v_exp_f32 v186, v186
v_mfma_f32_16x16x32_bf16 v[68:71], v[236:239], v[200:203], v[68:71]
ds_read_b128 v[236:239], v250 offset:24832
s_waitcnt lgkmcnt(4)
v_mfma_f32_16x16x32_bf16 v[72:75], v[240:243], v[192:195], v[72:75]
v_exp_f32 v187, v187
v_mfma_f32_16x16x32_bf16 v[76:79], v[240:243], v[196:199], v[76:79]
L_pg8:
s_cbranch_execz L_ret
v_cvt_pk_bf16_f32 v210, v184, v185
v_mfma_f32_16x16x32_bf16 v[80:83], v[240:243], v[200:203], v[80:83]
ds_read_b128 v[240:243], v250 offset:25088
s_waitcnt lgkmcnt(3)
v_mfma_f32_16x16x32_bf16 v[84:87], v[244:247], v[192:195], v[84:87]
v_exp_f32 v188, v188
v_mfma_f32_16x16x32_bf16 v[88:91], v[244:247], v[196:199], v[88:91]
v_exp_f32 v189, v189
v_cvt_pk_bf16_f32 v211, v186, v187
v_mfma_f32_16x16x32_bf16 v[92:95], v[244:247], v[200:203], v[92:95]
ds_read_b128 v[244:247], v250 offset:25344
v_mfma_f32_16x16x32_bf16 v[216:219], v[228:231], v[192:195], v[216:219]
v_exp_f32 v190, v190
v_mfma_f32_16x16x32_bf16 v[220:223], v[228:231], v[196:199], v[220:223]
v_exp_f32 v191, v191
v_mfma_f32_16x16x32_bf16 v[224:227], v[228:231], v[200:203], v[224:227]
v_cvt_pk_bf16_f32 v214, v188, v189
s_nop 0
v_cvt_pk_bf16_f32 v215, v190, v191
s_waitcnt lgkmcnt(3)
v_mfma_f32_16x16x32_bf16 v[168:171], v[232:235], v[96:99], 0
v_exp_f32 v144, v144
v_mfma_f32_16x16x32_bf16 v[172:175], v[232:235], v[112:115], 0
v_exp_f32 v145, v145
v_mfma_f32_16x16x32_bf16 v[176:179], v[232:235], v[128:131], 0
ds_read_b128 v[232:235], v250 offset:28672
s_waitcnt lgkmcnt(3)
v_mfma_f32_16x16x32_bf16 v[168:171], v[236:239], v[100:103], v[168:171]
v_exp_f32 v146, v146
v_mfma_f32_16x16x32_bf16 v[172:175], v[236:239], v[116:119], v[172:175]
v_exp_f32 v147, v147
v_mfma_f32_16x16x32_bf16 v[176:179], v[236:239], v[132:135], v[176:179]
ds_read_b128 v[236:239], v250 offset:28928
s_waitcnt lgkmcnt(3)
v_mfma_f32_16x16x32_bf16 v[168:171], v[240:243], v[104:107], v[168:171]
v_cvt_pk_bf16_f32 v192, v144, v145
v_mfma_f32_16x16x32_bf16 v[172:175], v[240:243], v[120:123], v[172:175]
v_exp_f32 v148, v148
v_mfma_f32_16x16x32_bf16 v[176:179], v[240:243], v[136:139], v[176:179]
ds_read_b128 v[240:243], v250 offset:29184
s_waitcnt lgkmcnt(3)
v_mfma_f32_16x16x32_bf16 v[168:171], v[244:247], v[108:111], v[168:171]
v_exp_f32 v149, v149
v_cvt_pk_bf16_f32 v193, v146, v147
v_mfma_f32_16x16x32_bf16 v[172:175], v[244:247], v[124:127], v[172:175]
v_exp_f32 v150, v150
v_mfma_f32_16x16x32_bf16 v[176:179], v[244:247], v[140:143], v[176:179]
ds_read_b128 v[244:247], v250 offset:29440
s_waitcnt lgkmcnt(3)
v_mfma_f32_16x16x32_bf16 v[180:183], v[232:235], v[96:99], 0
v_exp_f32 v151, v151
v_mfma_f32_16x16x32_bf16 v[184:187], v[232:235], v[112:115], 0
v_cvt_pk_bf16_f32 v196, v148, v149
v_exp_f32 v152, v152
v_mfma_f32_16x16x32_bf16 v[188:191], v[232:235], v[128:131], 0
ds_read_b64_tr_b16 v[232:233], v253 offset:16384
s_waitcnt lgkmcnt(3)
v_mfma_f32_16x16x32_bf16 v[180:183], v[236:239], v[100:103], v[180:183]
ds_read_b64_tr_b16 v[234:235], v253 offset:20480
v_mfma_f32_16x16x32_bf16 v[184:187], v[236:239], v[116:119], v[184:187]
v_exp_f32 v153, v153
v_cvt_pk_bf16_f32 v197, v150, v151
v_mfma_f32_16x16x32_bf16 v[188:191], v[236:239], v[132:135], v[188:191]
ds_read_b64_tr_b16 v[236:237], v254 offset:16384
s_waitcnt lgkmcnt(4)
v_mfma_f32_16x16x32_bf16 v[180:183], v[240:243], v[104:107], v[180:183]
ds_read_b64_tr_b16 v[238:239], v254 offset:20480
v_mfma_f32_16x16x32_bf16 v[184:187], v[240:243], v[120:123], v[184:187]
v_exp_f32 v154, v154
v_mfma_f32_16x16x32_bf16 v[188:191], v[240:243], v[136:139], v[188:191]
ds_read_b64_tr_b16 v[240:241], v253 offset:16640
s_waitcnt lgkmcnt(5)
v_mfma_f32_16x16x32_bf16 v[180:183], v[244:247], v[108:111], v[180:183]
ds_read_b64_tr_b16 v[242:243], v253 offset:20736
v_exp_f32 v155, v155
v_mfma_f32_16x16x32_bf16 v[184:187], v[244:247], v[124:127], v[184:187]
v_cvt_pk_bf16_f32 v200, v152, v153
v_mfma_f32_16x16x32_bf16 v[188:191], v[244:247], v[140:143], v[188:191]
ds_read_b64_tr_b16 v[244:245], v254 offset:16640
s_waitcnt lgkmcnt(5)
v_mfma_f32_16x16x32_bf16 v[0:3], v[232:235], v[204:207], v[0:3]
ds_read_b64_tr_b16 v[246:247], v254 offset:20736
v_exp_f32 v156, v156
v_mfma_f32_16x16x32_bf16 v[4:7], v[232:235], v[208:211], v[4:7]
v_exp_f32 v157, v157
v_mfma_f32_16x16x32_bf16 v[8:11], v[232:235], v[212:215], v[8:11]
ds_read_b64_tr_b16 v[232:233], v253 offset:16896
s_waitcnt lgkmcnt(5)
v_mfma_f32_16x16x32_bf16 v[12:15], v[236:239], v[204:207], v[12:15]
ds_read_b64_tr_b16 v[234:235], v253 offset:20992
v_cvt_pk_bf16_f32 v201, v154, v155
v_mfma_f32_16x16x32_bf16 v[16:19], v[236:239], v[208:211], v[16:19]
v_exp_f32 v158, v158
v_mfma_f32_16x16x32_bf16 v[20:23], v[236:239], v[212:215], v[20:23]
ds_read_b64_tr_b16 v[236:237], v254 offset:16896
s_waitcnt lgkmcnt(5)
v_mfma_f32_16x16x32_bf16 v[24:27], v[240:243], v[204:207], v[24:27]
ds_read_b64_tr_b16 v[238:239], v254 offset:20992
v_mfma_f32_16x16x32_bf16 v[28:31], v[240:243], v[208:211], v[28:31]
v_exp_f32 v159, v159
v_cvt_pk_bf16_f32 v194, v156, v157
v_mfma_f32_16x16x32_bf16 v[32:35], v[240:243], v[212:215], v[32:35]
ds_read_b64_tr_b16 v[240:241], v253 offset:17152
s_waitcnt lgkmcnt(5)
v_mfma_f32_16x16x32_bf16 v[36:39], v[244:247], v[204:207], v[36:39]
ds_read_b64_tr_b16 v[242:243], v253 offset:21248
v_exp_f32 v160, v160
v_mfma_f32_16x16x32_bf16 v[40:43], v[244:247], v[208:211], v[40:43]
v_exp_f32 v161, v161
v_mfma_f32_16x16x32_bf16 v[44:47], v[244:247], v[212:215], v[44:47]
ds_read_b64_tr_b16 v[244:245], v254 offset:17152
s_waitcnt lgkmcnt(5)
v_mfma_f32_16x16x32_bf16 v[48:51], v[232:235], v[204:207], v[48:51]
ds_read_b64_tr_b16 v[246:247], v254 offset:21248
v_cvt_pk_bf16_f32 v195, v158, v159
v_mfma_f32_16x16x32_bf16 v[52:55], v[232:235], v[208:211], v[52:55]
s_barrier
v_mfma_f32_16x16x32_bf16 v[56:59], v[232:235], v[212:215], v[56:59]
ds_read_b64_tr_b16 v[232:233], v248 offset:0
s_waitcnt lgkmcnt(5)
v_mfma_f32_16x16x32_bf16 v[60:63], v[236:239], v[204:207], v[60:63]
ds_read_b64_tr_b16 v[234:235], v248 offset:4096
v_mfma_f32_16x16x32_bf16 v[64:67], v[236:239], v[208:211], v[64:67]
v_exp_f32 v162, v162
v_mfma_f32_16x16x32_bf16 v[68:71], v[236:239], v[212:215], v[68:71]
ds_read_b64_tr_b16 v[236:237], v249 offset:0
s_waitcnt lgkmcnt(5)
v_mfma_f32_16x16x32_bf16 v[72:75], v[240:243], v[204:207], v[72:75]
ds_read_b64_tr_b16 v[238:239], v249 offset:4096
v_exp_f32 v163, v163
v_mfma_f32_16x16x32_bf16 v[76:79], v[240:243], v[208:211], v[76:79]
v_cvt_pk_bf16_f32 v198, v160, v161
v_mfma_f32_16x16x32_bf16 v[80:83], v[240:243], v[212:215], v[80:83]
ds_read_b64_tr_b16 v[240:241], v248 offset:256
s_waitcnt lgkmcnt(5)
v_mfma_f32_16x16x32_bf16 v[84:87], v[244:247], v[204:207], v[84:87]
ds_read_b64_tr_b16 v[242:243], v248 offset:4352
v_exp_f32 v164, v164
v_mfma_f32_16x16x32_bf16 v[88:91], v[244:247], v[208:211], v[88:91]
v_exp_f32 v165, v165
v_mfma_f32_16x16x32_bf16 v[92:95], v[244:247], v[212:215], v[92:95]
ds_read_b64_tr_b16 v[244:245], v249 offset:256
ds_read_b64_tr_b16 v[246:247], v249 offset:4352
v_mfma_f32_16x16x32_bf16 v[216:219], v[228:231], v[204:207], v[216:219]
v_cvt_pk_bf16_f32 v199, v162, v163
v_mfma_f32_16x16x32_bf16 v[220:223], v[228:231], v[208:211], v[220:223]
v_exp_f32 v166, v166
v_mfma_f32_16x16x32_bf16 v[224:227], v[228:231], v[212:215], v[224:227]
v_exp_f32 v167, v167
v_cvt_pk_bf16_f32 v202, v164, v165
s_nop 0
v_cvt_pk_bf16_f32 v203, v166, v167
s_nop 1
s_lshl_b32 s52, s48, 4
s_cmp_lg_u32 s50, 0
s_cbranch_scc1 L_np1
buffer_load_dword v144, off, s[96:99], s52 sc0 sc1
L_np1:
s_waitcnt lgkmcnt(6)
v_mfma_f32_16x16x32_bf16 v[0:3], v[232:235], v[192:195], v[0:3]
v_exp_f32 v168, v168
v_exp_f32 v169, v169
v_mfma_f32_16x16x32_bf16 v[4:7], v[232:235], v[196:199], v[4:7]
v_exp_f32 v170, v170
v_exp_f32 v171, v171
v_mfma_f32_16x16x32_bf16 v[8:11], v[232:235], v[200:203], v[8:11]
ds_read_b64_tr_b16 v[232:233], v248 offset:512
s_waitcnt lgkmcnt(5)
v_mfma_f32_16x16x32_bf16 v[12:15], v[236:239], v[192:195], v[12:15]
ds_read_b64_tr_b16 v[234:235], v248 offset:4608
v_cvt_pk_bf16_f32 v204, v168, v169
v_mfma_f32_16x16x32_bf16 v[16:19], v[236:239], v[196:199], v[16:19]
v_exp_f32 v172, v172
v_exp_f32 v173, v173
v_cvt_pk_bf16_f32 v205, v170, v171
v_mfma_f32_16x16x32_bf16 v[20:23], v[236:239], v[200:203], v[20:23]
ds_read_b64_tr_b16 v[236:237], v249 offset:512
s_waitcnt lgkmcnt(5)
v_mfma_f32_16x16x32_bf16 v[24:27], v[240:243], v[192:195], v[24:27]
ds_read_b64_tr_b16 v[238:239], v249 offset:4608
v_exp_f32 v174, v174
v_mfma_f32_16x16x32_bf16 v[28:31], v[240:243], v[196:199], v[28:31]
v_exp_f32 v175, v175
v_cvt_pk_bf16_f32 v208, v172, v173
v_mfma_f32_16x16x32_bf16 v[32:35], v[240:243], v[200:203], v[32:35]
ds_read_b64_tr_b16 v[240:241], v248 offset:768
s_waitcnt lgkmcnt(5)
v_mfma_f32_16x16x32_bf16 v[36:39], v[244:247], v[192:195], v[36:39]
ds_read_b64_tr_b16 v[242:243], v248 offset:4864
v_exp_f32 v176, v176
v_mfma_f32_16x16x32_bf16 v[40:43], v[244:247], v[196:199], v[40:43]
v_exp_f32 v177, v177
v_cvt_pk_bf16_f32 v209, v174, v175
v_exp_f32 v178, v178
v_mfma_f32_16x16x32_bf16 v[44:47], v[244:247], v[200:203], v[44:47]
ds_read_b64_tr_b16 v[244:245], v249 offset:768
s_waitcnt lgkmcnt(5)
v_mfma_f32_16x16x32_bf16 v[48:51], v[232:235], v[192:195], v[48:51]
ds_read_b64_tr_b16 v[246:247], v249 offset:4864
v_exp_f32 v179, v179
v_mfma_f32_16x16x32_bf16 v[52:55], v[232:235], v[196:199], v[52:55]
s_barrier
v_mfma_f32_16x16x32_bf16 v[56:59], v[232:235], v[200:203], v[56:59]
ds_read_b64_tr_b16 v[232:233], v248 offset:8192
s_waitcnt lgkmcnt(5)
v_mfma_f32_16x16x32_bf16 v[60:63], v[236:239], v[192:195], v[60:63]
ds_read_b64_tr_b16 v[234:235], v248 offset:12288
v_cvt_pk_bf16_f32 v212, v176, v177
v_exp_f32 v180, v180
v_mfma_f32_16x16x32_bf16 v[64:67], v[236:239], v[196:199], v[64:67]
v_exp_f32 v181, v181
v_cvt_pk_bf16_f32 v213, v178, v179
v_mfma_f32_16x16x32_bf16 v[68:71], v[236:239], v[200:203], v[68:71]
ds_read_b64_tr_b16 v[236:237], v249 offset:8192
s_waitcnt lgkmcnt(5)
v_mfma_f32_16x16x32_bf16 v[72:75], v[240:243], v[192:195], v[72:75]
ds_read_b64_tr_b16 v[238:239], v249 offset:12288
v_exp_f32 v182, v182
v_mfma_f32_16x16x32_bf16 v[76:79], v[240:243], v[196:199], v[76:79]
v_exp_f32 v183, v183
v_cvt_pk_bf16_f32 v206, v180, v181
v_exp_f32 v184, v184
v_mfma_f32_16x16x32_bf16 v[80:83], v[240:243], v[200:203], v[80:83]
ds_read_b64_tr_b16 v[240:241], v248 offset:8448
s_waitcnt lgkmcnt(5)
v_mfma_f32_16x16x32_bf16 v[84:87], v[244:247], v[192:195], v[84:87]
ds_read_b64_tr_b16 v[242:243], v248 offset:12544
v_exp_f32 v185, v185
v_mfma_f32_16x16x32_bf16 v[88:91], v[244:247], v[196:199], v[88:91]
v_cvt_pk_bf16_f32 v207, v182, v183
v_exp_f32 v186, v186
v_mfma_f32_16x16x32_bf16 v[92:95], v[244:247], v[200:203], v[92:95]
ds_read_b64_tr_b16 v[244:245], v249 offset:8448
ds_read_b64_tr_b16 v[246:247], v249 offset:12544
v_mfma_f32_16x16x32_bf16 v[216:219], v[228:231], v[192:195], v[216:219]
v_exp_f32 v187, v187
v_cvt_pk_bf16_f32 v210, v184, v185
v_exp_f32 v188, v188
v_mfma_f32_16x16x32_bf16 v[220:223], v[228:231], v[196:199], v[220:223]
v_exp_f32 v189, v189
v_cvt_pk_bf16_f32 v211, v186, v187
v_mfma_f32_16x16x32_bf16 v[224:227], v[228:231], v[200:203], v[224:227]
v_exp_f32 v190, v190
v_exp_f32 v191, v191
v_cvt_pk_bf16_f32 v214, v188, v189
s_nop 0
v_cvt_pk_bf16_f32 v215, v190, v191
s_nop 1
s_waitcnt lgkmcnt(6)
v_mfma_f32_16x16x32_bf16 v[0:3], v[232:235], v[204:207], v[0:3]
v_mfma_f32_16x16x32_bf16 v[4:7], v[232:235], v[208:211], v[4:7]
v_mfma_f32_16x16x32_bf16 v[8:11], v[232:235], v[212:215], v[8:11]
ds_read_b64_tr_b16 v[232:233], v248 offset:8704
s_waitcnt lgkmcnt(5)
v_mfma_f32_16x16x32_bf16 v[12:15], v[236:239], v[204:207], v[12:15]
ds_read_b64_tr_b16 v[234:235], v248 offset:12800
v_mfma_f32_16x16x32_bf16 v[16:19], v[236:239], v[208:211], v[16:19]
v_mfma_f32_16x16x32_bf16 v[20:23], v[236:239], v[212:215], v[20:23]
ds_read_b64_tr_b16 v[236:237], v249 offset:8704
s_waitcnt lgkmcnt(5)
v_mfma_f32_16x16x32_bf16 v[24:27], v[240:243], v[204:207], v[24:27]
ds_read_b64_tr_b16 v[238:239], v249 offset:12800
v_mfma_f32_16x16x32_bf16 v[28:31], v[240:243], v[208:211], v[28:31]
v_mfma_f32_16x16x32_bf16 v[32:35], v[240:243], v[212:215], v[32:35]
ds_read_b64_tr_b16 v[240:241], v248 offset:8960
s_waitcnt lgkmcnt(5)
v_mfma_f32_16x16x32_bf16 v[36:39], v[244:247], v[204:207], v[36:39]
ds_read_b64_tr_b16 v[242:243], v248 offset:13056
v_mfma_f32_16x16x32_bf16 v[40:43], v[244:247], v[208:211], v[40:43]
v_mfma_f32_16x16x32_bf16 v[44:47], v[244:247], v[212:215], v[44:47]
ds_read_b64_tr_b16 v[244:245], v249 offset:8960
s_waitcnt lgkmcnt(5)
v_mfma_f32_16x16x32_bf16 v[48:51], v[232:235], v[204:207], v[48:51]
ds_read_b64_tr_b16 v[246:247], v249 offset:13056
v_mfma_f32_16x16x32_bf16 v[52:55], v[232:235], v[208:211], v[52:55]
v_mfma_f32_16x16x32_bf16 v[56:59], v[232:235], v[212:215], v[56:59]
s_waitcnt lgkmcnt(4)
v_mfma_f32_16x16x32_bf16 v[60:63], v[236:239], v[204:207], v[60:63]
v_mfma_f32_16x16x32_bf16 v[64:67], v[236:239], v[208:211], v[64:67]
v_mfma_f32_16x16x32_bf16 v[68:71], v[236:239], v[212:215], v[68:71]
s_waitcnt lgkmcnt(2)
v_mfma_f32_16x16x32_bf16 v[72:75], v[240:243], v[204:207], v[72:75]
v_mfma_f32_16x16x32_bf16 v[76:79], v[240:243], v[208:211], v[76:79]
v_mfma_f32_16x16x32_bf16 v[80:83], v[240:243], v[212:215], v[80:83]
s_waitcnt lgkmcnt(0)
v_mfma_f32_16x16x32_bf16 v[84:87], v[244:247], v[204:207], v[84:87]
v_mfma_f32_16x16x32_bf16 v[88:91], v[244:247], v[208:211], v[88:91]
v_mfma_f32_16x16x32_bf16 v[92:95], v[244:247], v[212:215], v[92:95]
v_mfma_f32_16x16x32_bf16 v[216:219], v[228:231], v[204:207], v[216:219]
v_mfma_f32_16x16x32_bf16 v[220:223], v[228:231], v[208:211], v[220:223]
v_mfma_f32_16x16x32_bf16 v[224:227], v[228:231], v[212:215], v[224:227]
s_nop 7
s_nop 1
v_mov_b32_e64 v214, 0
s_lshl_b32 s52, s48, 4
v_min3_f32 v253, v216, v220, v224
v_max3_f32 v254, v216, v220, v224
v_add_f32 v255, v216, v220
v_add_f32 v255, v255, v224
v_cmp_nle_f32 vcc, 0x33800000, v253
s_nop 0
s_mov_b64 s[58:59], vcc
v_cmp_nge_f32 vcc, 0x4b800000, v254
s_or_b64 s[58:59], s[58:59], vcc
v_cmp_u_f32 vcc, v255, v255
s_or_b64 s[58:59], s[58:59], vcc
s_cbranch_scc1 L_slow
L_norm:
v_rcp_f32 v216, v216
v_rcp_f32 v220, v220
v_rcp_f32_e64 v224, v224
s_mul_i32 s58, s50, 12288
s_add_u32 s58, s58, 114688
s_nop 0
s_xor_b32 s59, s50, 2
s_mul_i32 s59, s59, 12288
s_add_u32 s59, s59, 114688
v_mov_b32 v217, v216
v_mov_b32 v221, v220
v_mov_b32 v225, v224
v_lshlrev_b32 v253, 4, v252
v_add_u32 v254, s59, v253
v_add_u32 v253, s58, v253
v_pk_mul_f32 v[0:1], v[0:1], v[216:217]
v_pk_mul_f32 v[2:3], v[2:3], v[216:217]
v_pk_mul_f32 v[12:13], v[12:13], v[216:217]
v_pk_mul_f32 v[14:15], v[14:15], v[216:217]
v_cvt_pk_bf16_f32 v96, v0, v1
v_cvt_pk_bf16_f32 v97, v2, v3
v_cvt_pk_bf16_f32 v98, v12, v13
v_cvt_pk_bf16_f32 v99, v14, v15
ds_write_b128 v253, v[96:99] offset:0
v_pk_mul_f32 v[4:5], v[4:5], v[220:221]
v_pk_mul_f32 v[6:7], v[6:7], v[220:221]
v_pk_mul_f32 v[16:17], v[16:17], v[220:221]
v_pk_mul_f32 v[18:19], v[18:19], v[220:221]
v_cvt_pk_bf16_f32 v100, v4, v5
v_cvt_pk_bf16_f32 v101, v6, v7
v_cvt_pk_bf16_f32 v102, v16, v17
v_cvt_pk_bf16_f32 v103, v18, v19
ds_write_b128 v253, v[100:103] offset:1024
v_pk_mul_f32 v[8:9], v[8:9], v[224:225]
v_pk_mul_f32 v[10:11], v[10:11], v[224:225]
v_pk_mul_f32 v[20:21], v[20:21], v[224:225]
v_pk_mul_f32 v[22:23], v[22:23], v[224:225]
v_cvt_pk_bf16_f32 v104, v8, v9
v_cvt_pk_bf16_f32 v105, v10, v11
v_cvt_pk_bf16_f32 v106, v20, v21
v_cvt_pk_bf16_f32 v107, v22, v23
ds_write_b128 v253, v[104:107] offset:2048
v_pk_mul_f32 v[24:25], v[24:25], v[216:217]
v_pk_mul_f32 v[26:27], v[26:27], v[216:217]
v_pk_mul_f32 v[36:37], v[36:37], v[216:217]
v_pk_mul_f32 v[38:39], v[38:39], v[216:217]
v_cvt_pk_bf16_f32 v108, v24, v25
v_cvt_pk_bf16_f32 v109, v26, v27
v_cvt_pk_bf16_f32 v110, v36, v37
v_cvt_pk_bf16_f32 v111, v38, v39
ds_write_b128 v253, v[108:111] offset:3072
v_pk_mul_f32 v[28:29], v[28:29], v[220:221]
v_pk_mul_f32 v[30:31], v[30:31], v[220:221]
v_pk_mul_f32 v[40:41], v[40:41], v[220:221]
v_pk_mul_f32 v[42:43], v[42:43], v[220:221]
v_cvt_pk_bf16_f32 v112, v28, v29
v_cvt_pk_bf16_f32 v113, v30, v31
v_cvt_pk_bf16_f32 v114, v40, v41
v_cvt_pk_bf16_f32 v115, v42, v43
ds_write_b128 v253, v[112:115] offset:4096
v_pk_mul_f32 v[32:33], v[32:33], v[224:225]
v_pk_mul_f32 v[34:35], v[34:35], v[224:225]
v_pk_mul_f32 v[44:45], v[44:45], v[224:225]
v_pk_mul_f32 v[46:47], v[46:47], v[224:225]
v_cvt_pk_bf16_f32 v116, v32, v33
v_cvt_pk_bf16_f32 v117, v34, v35
v_cvt_pk_bf16_f32 v118, v44, v45
v_cvt_pk_bf16_f32 v119, v46, v47
ds_write_b128 v253, v[116:119] offset:5120
v_pk_mul_f32 v[48:49], v[48:49], v[216:217]
v_pk_mul_f32 v[50:51], v[50:51], v[216:217]
v_pk_mul_f32 v[60:61], v[60:61], v[216:217]
v_pk_mul_f32 v[62:63], v[62:63], v[216:217]
v_cvt_pk_bf16_f32 v120, v48, v49
v_cvt_pk_bf16_f32 v121, v50, v51
v_cvt_pk_bf16_f32 v122, v60, v61
v_cvt_pk_bf16_f32 v123, v62, v63
ds_write_b128 v253, v[120:123] offset:6144
v_pk_mul_f32 v[52:53], v[52:53], v[220:221]
v_pk_mul_f32 v[54:55], v[54:55], v[220:221]
v_pk_mul_f32 v[64:65], v[64:65], v[220:221]
v_pk_mul_f32 v[66:67], v[66:67], v[220:221]
v_cvt_pk_bf16_f32 v124, v52, v53
v_cvt_pk_bf16_f32 v125, v54, v55
v_cvt_pk_bf16_f32 v126, v64, v65
v_cvt_pk_bf16_f32 v127, v66, v67
ds_write_b128 v253, v[124:127] offset:7168
v_pk_mul_f32 v[56:57], v[56:57], v[224:225]
v_pk_mul_f32 v[58:59], v[58:59], v[224:225]
v_pk_mul_f32 v[68:69], v[68:69], v[224:225]
v_pk_mul_f32 v[70:71], v[70:71], v[224:225]
v_cvt_pk_bf16_f32 v128, v56, v57
v_cvt_pk_bf16_f32 v129, v58, v59
v_cvt_pk_bf16_f32 v130, v68, v69
v_cvt_pk_bf16_f32 v131, v70, v71
ds_write_b128 v253, v[128:131] offset:8192
v_pk_mul_f32 v[72:73], v[72:73], v[216:217]
v_pk_mul_f32 v[74:75], v[74:75], v[216:217]
v_pk_mul_f32 v[84:85], v[84:85], v[216:217]
v_pk_mul_f32 v[86:87], v[86:87], v[216:217]
v_cvt_pk_bf16_f32 v132, v72, v73
v_cvt_pk_bf16_f32 v133, v74, v75
v_cvt_pk_bf16_f32 v134, v84, v85
v_cvt_pk_bf16_f32 v135, v86, v87
ds_write_b128 v253, v[132:135] offset:9216
v_pk_mul_f32 v[76:77], v[76:77], v[220:221]
v_pk_mul_f32 v[78:79], v[78:79], v[220:221]
v_pk_mul_f32 v[88:89], v[88:89], v[220:221]
v_pk_mul_f32 v[90:91], v[90:91], v[220:221]
v_cvt_pk_bf16_f32 v136, v76, v77
v_cvt_pk_bf16_f32 v137, v78, v79
v_cvt_pk_bf16_f32 v138, v88, v89
v_cvt_pk_bf16_f32 v139, v90, v91
ds_write_b128 v253, v[136:139] offset:10240
v_pk_mul_f32 v[80:81], v[80:81], v[224:225]
v_pk_mul_f32 v[82:83], v[82:83], v[224:225]
v_pk_mul_f32 v[92:93], v[92:93], v[224:225]
v_pk_mul_f32 v[94:95], v[94:95], v[224:225]
v_cvt_pk_bf16_f32 v140, v80, v81
v_cvt_pk_bf16_f32 v141, v82, v83
v_cvt_pk_bf16_f32 v142, v92, v93
v_cvt_pk_bf16_f32 v143, v94, v95
ds_write_b128 v253, v[140:143] offset:11264
v_and_b32 v48, 3, v252
v_lshlrev_b32 v48, 3, v48
v_bfe_u32 v49, v252, 2, 3
v_lshl_add_u32 v48, v49, 6, v48
v_bfe_u32 v49, v252, 4, 1
v_lshl_add_u32 v48, v49, 5, v48
v_lshrrev_b32_e64 v49, 5, v252
v_lshl_add_u32 v48, v49, 10, v48
s_nop 0
s_lshr_b32 s58, s50, 1
s_mul_i32 s58, s58, 16896
v_add_u32 v48, s58, v48
v_xor_b32 v49, 32, v48
s_cmp_lg_u32 s50, 0
s_cbranch_scc1 L_poll0_ok
s_mov_b32 s51, 0
s_branch L_poll0b
L_poll0:
buffer_load_dword v144, v214, s[96:99], s52 offen sc0 sc1
L_poll0b:
s_nop 0
s_waitcnt vmcnt(0)
v_readfirstlane_b32 s58, v144
s_add_u32 s51, s51, 1
s_cmp_ge_u32 s58, 16
s_cbranch_scc1 L_poll0_ok
s_cmp_lt_u32 s51, 0x100000
s_cbranch_scc1 L_poll0
L_poll0_ok:
s_waitcnt lgkmcnt(0)
s_barrier
ds_read_b64_tr_b16 v[232:233], v48 offset:0
ds_read_b64_tr_b16 v[234:235], v48 offset:2048
ds_read_b64_tr_b16 v[236:237], v48 offset:4096
ds_read_b64_tr_b16 v[238:239], v48 offset:6144
ds_read_b64_tr_b16 v[240:241], v48 offset:8192
ds_read_b64_tr_b16 v[242:243], v48 offset:10240
ds_read_b64_tr_b16 v[244:245], v48 offset:12288
ds_read_b64_tr_b16 v[246:247], v48 offset:14336
s_waitcnt lgkmcnt(6)
v_mfma_f32_16x16x32_bf16 v[0:3], v[232:235], v[96:99], 0
v_mfma_f32_16x16x32_bf16 v[4:7], v[232:235], v[100:103], 0
v_xor_b32 v50, 0x4000, v48
v_xor_b32 v51, 0x4000, v49
ds_read_b128 v[144:147], v254 offset:0
ds_read_b128 v[148:151], v254 offset:1024
v_mfma_f32_16x16x32_bf16 v[8:11], v[232:235], v[104:107], 0
ds_read_b64_tr_b16 v[232:233], v49 offset:0
s_waitcnt lgkmcnt(7)
v_mfma_f32_16x16x32_bf16 v[0:3], v[236:239], v[108:111], v[0:3]
ds_read_b64_tr_b16 v[234:235], v49 offset:2048
v_mfma_f32_16x16x32_bf16 v[4:7], v[236:239], v[112:115], v[4:7]
ds_read_b128 v[152:155], v254 offset:2048
ds_read_b128 v[156:159], v254 offset:3072
v_mfma_f32_16x16x32_bf16 v[8:11], v[236:239], v[116:119], v[8:11]
ds_read_b64_tr_b16 v[236:237], v49 offset:4096
s_waitcnt lgkmcnt(9)
v_mfma_f32_16x16x32_bf16 v[0:3], v[240:243], v[120:123], v[0:3]
ds_read_b64_tr_b16 v[238:239], v49 offset:6144
v_mfma_f32_16x16x32_bf16 v[4:7], v[240:243], v[124:127], v[4:7]
ds_read_b128 v[160:163], v254 offset:4096
ds_read_b128 v[164:167], v254 offset:5120
v_mfma_f32_16x16x32_bf16 v[8:11], v[240:243], v[128:131], v[8:11]
ds_read_b64_tr_b16 v[240:241], v49 offset:8192
s_waitcnt lgkmcnt(11)
v_mfma_f32_16x16x32_bf16 v[0:3], v[244:247], v[132:135], v[0:3]
ds_read_b64_tr_b16 v[242:243], v49 offset:10240
v_mfma_f32_16x16x32_bf16 v[4:7], v[244:247], v[136:139], v[4:7]
ds_read_b128 v[168:171], v254 offset:6144
ds_read_b128 v[172:175], v254 offset:7168
v_mfma_f32_16x16x32_bf16 v[8:11], v[244:247], v[140:143], v[8:11]
ds_read_b64_tr_b16 v[244:245], v49 offset:12288
s_waitcnt lgkmcnt(11)
v_mfma_f32_16x16x32_bf16 v[12:15], v[232:235], v[96:99], 0
ds_read_b64_tr_b16 v[246:247], v49 offset:14336
v_mfma_f32_16x16x32_bf16 v[16:19], v[232:235], v[100:103], 0
ds_read_b128 v[176:179], v254 offset:8192
ds_read_b128 v[180:183], v254 offset:9216
v_mfma_f32_16x16x32_bf16 v[20:23], v[232:235], v[104:107], 0
ds_read_b64_tr_b16 v[232:233], v50 offset:0
s_waitcnt lgkmcnt(11)
v_mfma_f32_16x16x32_bf16 v[12:15], v[236:239], v[108:111], v[12:15]
ds_read_b64_tr_b16 v[234:235], v50 offset:2048
v_mfma_f32_16x16x32_bf16 v[16:19], v[236:239], v[112:115], v[16:19]
ds_read_b128 v[184:187], v254 offset:10240
ds_read_b128 v[188:191], v254 offset:11264
v_mfma_f32_16x16x32_bf16 v[20:23], v[236:239], v[116:119], v[20:23]
ds_read_b64_tr_b16 v[236:237], v50 offset:4096
s_waitcnt lgkmcnt(11)
v_mfma_f32_16x16x32_bf16 v[12:15], v[240:243], v[120:123], v[12:15]
ds_read_b64_tr_b16 v[238:239], v50 offset:6144
v_mfma_f32_16x16x32_bf16 v[16:19], v[240:243], v[124:127], v[16:19]
v_add_u32 v56, 81920, v48
v_add_u32 v57, 81920, v49
v_add_u32 v58, 81920, v50
v_mfma_f32_16x16x32_bf16 v[20:23], v[240:243], v[128:131], v[20:23]
ds_read_b64_tr_b16 v[240:241], v50 offset:8192
s_waitcnt lgkmcnt(9)
v_mfma_f32_16x16x32_bf16 v[12:15], v[244:247], v[132:135], v[12:15]
ds_read_b64_tr_b16 v[242:243], v50 offset:10240
v_mfma_f32_16x16x32_bf16 v[16:19], v[244:247], v[136:139], v[16:19]
v_add_u32 v59, 81920, v51
v_and_b32 v255, 7, v252
v_lshlrev_b32 v255, 4, v255
v_mfma_f32_16x16x32_bf16 v[20:23], v[244:247], v[140:143], v[20:23]
ds_read_b64_tr_b16 v[244:245], v50 offset:12288
s_waitcnt lgkmcnt(7)
v_mfma_f32_16x16x32_bf16 v[0:3], v[232:235], v[144:147], v[0:3]
ds_read_b64_tr_b16 v[246:247], v50 offset:14336
v_mfma_f32_16x16x32_bf16 v[4:7], v[232:235], v[148:151], v[4:7]
v_bfe_u32 v52, v252, 3, 1
v_lshl_add_u32 v255, v52, 10, v255
v_lshrrev_b32 v52, 4, v252
v_mfma_f32_16x16x32_bf16 v[8:11], v[232:235], v[152:155], v[8:11]
ds_read_b64_tr_b16 v[232:233], v51 offset:0
s_waitcnt lgkmcnt(5)
v_mfma_f32_16x16x32_bf16 v[0:3], v[236:239], v[156:159], v[0:3]
ds_read_b64_tr_b16 v[234:235], v51 offset:2048
v_mfma_f32_16x16x32_bf16 v[4:7], v[236:239], v[160:163], v[4:7]
v_lshl_add_u32 v255, v52, 7, v255
s_and_b32 s58, s50, 1
s_mul_i32 s58, s58, 6144
v_mfma_f32_16x16x32_bf16 v[8:11], v[236:239], v[164:167], v[8:11]
ds_read_b64_tr_b16 v[236:237], v51 offset:4096
s_waitcnt lgkmcnt(5)
v_mfma_f32_16x16x32_bf16 v[0:3], v[240:243], v[168:171], v[0:3]
ds_read_b64_tr_b16 v[238:239], v51 offset:6144
v_mfma_f32_16x16x32_bf16 v[4:7], v[240:243], v[172:175], v[4:7]
s_add_u32 s62, s69, s58
s_lshr_b32 s58, s50, 1
s_lshl_b32 s58, s58, 9
v_mfma_f32_16x16x32_bf16 v[8:11], v[240:243], v[176:179], v[8:11]
ds_read_b64_tr_b16 v[240:241], v51 offset:8192
s_waitcnt lgkmcnt(5)
v_mfma_f32_16x16x32_bf16 v[0:3], v[244:247], v[180:183], v[0:3]
ds_read_b64_tr_b16 v[242:243], v51 offset:10240
v_mfma_f32_16x16x32_bf16 v[4:7], v[244:247], v[184:187], v[4:7]
s_add_u32 s62, s62, s58
v_mfma_f32_16x16x32_bf16 v[8:11], v[244:247], v[188:191], v[8:11]
ds_read_b64_tr_b16 v[244:245], v51 offset:12288
s_waitcnt lgkmcnt(5)
v_mfma_f32_16x16x32_bf16 v[12:15], v[232:235], v[144:147], v[12:15]
ds_read_b64_tr_b16 v[246:247], v51 offset:14336
v_mfma_f32_16x16x32_bf16 v[16:19], v[232:235], v[148:151], v[16:19]
v_mfma_f32_16x16x32_bf16 v[20:23], v[232:235], v[152:155], v[20:23]
ds_read_b64_tr_b16 v[232:233], v48 offset:32768
s_waitcnt lgkmcnt(5)
v_mfma_f32_16x16x32_bf16 v[12:15], v[236:239], v[156:159], v[12:15]
ds_read_b64_tr_b16 v[234:235], v48 offset:34816
v_mfma_f32_16x16x32_bf16 v[16:19], v[236:239], v[160:163], v[16:19]
v_cvt_pk_bf16_f32 v24, v0, v1
v_cvt_pk_bf16_f32 v25, v2, v3
v_mfma_f32_16x16x32_bf16 v[20:23], v[236:239], v[164:167], v[20:23]
ds_read_b64_tr_b16 v[236:237], v48 offset:36864
s_waitcnt lgkmcnt(5)
v_mfma_f32_16x16x32_bf16 v[12:15], v[240:243], v[168:171], v[12:15]
ds_read_b64_tr_b16 v[238:239], v48 offset:38912
v_mfma_f32_16x16x32_bf16 v[16:19], v[240:243], v[172:175], v[16:19]
v_cvt_pk_bf16_f32 v28, v4, v5
v_cvt_pk_bf16_f32 v29, v6, v7
v_mfma_f32_16x16x32_bf16 v[20:23], v[240:243], v[176:179], v[20:23]
ds_read_b64_tr_b16 v[240:241], v48 offset:40960
s_waitcnt lgkmcnt(5)
v_mfma_f32_16x16x32_bf16 v[12:15], v[244:247], v[180:183], v[12:15]
ds_read_b64_tr_b16 v[242:243], v48 offset:43008
L_pg9:
s_cbranch_execz L_ret
v_mfma_f32_16x16x32_bf16 v[16:19], v[244:247], v[184:187], v[16:19]
v_cvt_pk_bf16_f32 v32, v8, v9
v_cvt_pk_bf16_f32 v33, v10, v11
v_mfma_f32_16x16x32_bf16 v[20:23], v[244:247], v[188:191], v[20:23]
ds_read_b64_tr_b16 v[244:245], v48 offset:45056
ds_read_b64_tr_b16 v[246:247], v48 offset:47104
s_waitcnt lgkmcnt(6)
v_mfma_f32_16x16x32_bf16 v[0:3], v[232:235], v[96:99], 0
v_mfma_f32_16x16x32_bf16 v[4:7], v[232:235], v[100:103], 0
v_mfma_f32_16x16x32_bf16 v[8:11], v[232:235], v[104:107], 0
ds_read_b64_tr_b16 v[232:233], v50 offset:32768
s_waitcnt lgkmcnt(5)
v_mfma_f32_16x16x32_bf16 v[0:3], v[236:239], v[108:111], v[0:3]
ds_read_b64_tr_b16 v[234:235], v50 offset:34816
v_mfma_f32_16x16x32_bf16 v[4:7], v[236:239], v[112:115], v[4:7]
v_cvt_pk_bf16_f32 v26, v12, v13
v_cvt_pk_bf16_f32 v27, v14, v15
v_mfma_f32_16x16x32_bf16 v[8:11], v[236:239], v[116:119], v[8:11]
ds_read_b64_tr_b16 v[236:237], v50 offset:36864
s_waitcnt lgkmcnt(5)
v_mfma_f32_16x16x32_bf16 v[0:3], v[240:243], v[120:123], v[0:3]
ds_read_b64_tr_b16 v[238:239], v50 offset:38912
v_mfma_f32_16x16x32_bf16 v[4:7], v[240:243], v[124:127], v[4:7]
v_cvt_pk_bf16_f32 v30, v16, v17
v_cvt_pk_bf16_f32 v31, v18, v19
v_mfma_f32_16x16x32_bf16 v[8:11], v[240:243], v[128:131], v[8:11]
ds_read_b64_tr_b16 v[240:241], v50 offset:40960
s_waitcnt lgkmcnt(5)
v_mfma_f32_16x16x32_bf16 v[0:3], v[244:247], v[132:135], v[0:3]
ds_read_b64_tr_b16 v[242:243], v50 offset:43008
v_mfma_f32_16x16x32_bf16 v[4:7], v[244:247], v[136:139], v[4:7]
v_cvt_pk_bf16_f32 v34, v20, v21
v_cvt_pk_bf16_f32 v35, v22, v23
v_mfma_f32_16x16x32_bf16 v[8:11], v[244:247], v[140:143], v[8:11]
ds_read_b64_tr_b16 v[244:245], v50 offset:45056
s_waitcnt lgkmcnt(5)
v_mfma_f32_16x16x32_bf16 v[0:3], v[232:235], v[144:147], v[0:3]
ds_read_b64_tr_b16 v[246:247], v50 offset:47104
v_mfma_f32_16x16x32_bf16 v[4:7], v[232:235], v[148:151], v[4:7]
buffer_store_dwordx4 v[24:27], v255, s[40:43], s62 offen offset:0 sc0 sc1
v_mfma_f32_16x16x32_bf16 v[8:11], v[232:235], v[152:155], v[8:11]
ds_read_b64_tr_b16 v[232:233], v49 offset:32768
s_waitcnt lgkmcnt(5)
v_mfma_f32_16x16x32_bf16 v[0:3], v[236:239], v[156:159], v[0:3]
ds_read_b64_tr_b16 v[234:235], v49 offset:34816
v_mfma_f32_16x16x32_bf16 v[4:7], v[236:239], v[160:163], v[4:7]
buffer_store_dwordx4 v[28:31], v255, s[40:43], s62 offen offset:2048 sc0 sc1
s_add_u32 s62, s62, 4096
v_mfma_f32_16x16x32_bf16 v[8:11], v[236:239], v[164:167], v[8:11]
ds_read_b64_tr_b16 v[236:237], v49 offset:36864
s_waitcnt lgkmcnt(5)
v_mfma_f32_16x16x32_bf16 v[0:3], v[240:243], v[168:171], v[0:3]
ds_read_b64_tr_b16 v[238:239], v49 offset:38912
v_mfma_f32_16x16x32_bf16 v[4:7], v[240:243], v[172:175], v[4:7]
buffer_store_dwordx4 v[32:35], v255, s[40:43], s62 offen offset:0 sc0 sc1
v_mfma_f32_16x16x32_bf16 v[8:11], v[240:243], v[176:179], v[8:11]
ds_read_b64_tr_b16 v[240:241], v49 offset:40960
s_waitcnt lgkmcnt(5)
v_mfma_f32_16x16x32_bf16 v[0:3], v[244:247], v[180:183], v[0:3]
ds_read_b64_tr_b16 v[242:243], v49 offset:43008
v_mfma_f32_16x16x32_bf16 v[4:7], v[244:247], v[184:187], v[4:7]
s_add_u32 s62, s62, 8192
v_mfma_f32_16x16x32_bf16 v[8:11], v[244:247], v[188:191], v[8:11]
ds_read_b64_tr_b16 v[244:245], v49 offset:45056
s_waitcnt lgkmcnt(5)
v_mfma_f32_16x16x32_bf16 v[12:15], v[232:235], v[96:99], 0
ds_read_b64_tr_b16 v[246:247], v49 offset:47104
v_mfma_f32_16x16x32_bf16 v[16:19], v[232:235], v[100:103], 0
v_mfma_f32_16x16x32_bf16 v[20:23], v[232:235], v[104:107], 0
ds_read_b64_tr_b16 v[232:233], v51 offset:32768
s_waitcnt lgkmcnt(5)
v_mfma_f32_16x16x32_bf16 v[12:15], v[236:239], v[108:111], v[12:15]
ds_read_b64_tr_b16 v[234:235], v51 offset:34816
v_mfma_f32_16x16x32_bf16 v[16:19], v[236:239], v[112:115], v[16:19]
v_cvt_pk_bf16_f32 v24, v0, v1
v_cvt_pk_bf16_f32 v25, v2, v3
v_mfma_f32_16x16x32_bf16 v[20:23], v[236:239], v[116:119], v[20:23]
ds_read_b64_tr_b16 v[236:237], v51 offset:36864
s_waitcnt lgkmcnt(5)
v_mfma_f32_16x16x32_bf16 v[12:15], v[240:243], v[120:123], v[12:15]
ds_read_b64_tr_b16 v[238:239], v51 offset:38912
v_mfma_f32_16x16x32_bf16 v[16:19], v[240:243], v[124:127], v[16:19]
v_cvt_pk_bf16_f32 v28, v4, v5
v_cvt_pk_bf16_f32 v29, v6, v7
v_mfma_f32_16x16x32_bf16 v[20:23], v[240:243], v[128:131], v[20:23]
ds_read_b64_tr_b16 v[240:241], v51 offset:40960
s_waitcnt lgkmcnt(5)
v_mfma_f32_16x16x32_bf16 v[12:15], v[244:247], v[132:135], v[12:15]
ds_read_b64_tr_b16 v[242:243], v51 offset:43008
v_mfma_f32_16x16x32_bf16 v[16:19], v[244:247], v[136:139], v[16:19]
v_cvt_pk_bf16_f32 v32, v8, v9
v_cvt_pk_bf16_f32 v33, v10, v11
v_mfma_f32_16x16x32_bf16 v[20:23], v[244:247], v[140:143], v[20:23]
ds_read_b64_tr_b16 v[244:245], v51 offset:45056
s_waitcnt lgkmcnt(5)
v_mfma_f32_16x16x32_bf16 v[12:15], v[232:235], v[144:147], v[12:15]
ds_read_b64_tr_b16 v[246:247], v51 offset:47104
v_mfma_f32_16x16x32_bf16 v[16:19], v[232:235], v[148:151], v[16:19]
v_mfma_f32_16x16x32_bf16 v[20:23], v[232:235], v[152:155], v[20:23]
ds_read_b64_tr_b16 v[232:233], v56 offset:0
s_waitcnt lgkmcnt(5)
v_mfma_f32_16x16x32_bf16 v[12:15], v[236:239], v[156:159], v[12:15]
ds_read_b64_tr_b16 v[234:235], v56 offset:2048
v_mfma_f32_16x16x32_bf16 v[16:19], v[236:239], v[160:163], v[16:19]
v_mfma_f32_16x16x32_bf16 v[20:23], v[236:239], v[164:167], v[20:23]
ds_read_b64_tr_b16 v[236:237], v56 offset:4096
s_waitcnt lgkmcnt(5)
v_mfma_f32_16x16x32_bf16 v[12:15], v[240:243], v[168:171], v[12:15]
ds_read_b64_tr_b16 v[238:239], v56 offset:6144
v_mfma_f32_16x16x32_bf16 v[16:19], v[240:243], v[172:175], v[16:19]
v_mfma_f32_16x16x32_bf16 v[20:23], v[240:243], v[176:179], v[20:23]
ds_read_b64_tr_b16 v[240:241], v56 offset:8192
s_waitcnt lgkmcnt(5)
v_mfma_f32_16x16x32_bf16 v[12:15], v[244:247], v[180:183], v[12:15]
ds_read_b64_tr_b16 v[242:243], v56 offset:10240
v_mfma_f32_16x16x32_bf16 v[16:19], v[244:247], v[184:187], v[16:19]
v_mfma_f32_16x16x32_bf16 v[20:23], v[244:247], v[188:191], v[20:23]
ds_read_b64_tr_b16 v[244:245], v56 offset:12288
ds_read_b64_tr_b16 v[246:247], v56 offset:14336
s_waitcnt lgkmcnt(6)
v_mfma_f32_16x16x32_bf16 v[0:3], v[232:235], v[96:99], 0
v_mfma_f32_16x16x32_bf16 v[4:7], v[232:235], v[100:103], 0
v_mfma_f32_16x16x32_bf16 v[8:11], v[232:235], v[104:107], 0
ds_read_b64_tr_b16 v[232:233], v58 offset:0
s_waitcnt lgkmcnt(5)
v_mfma_f32_16x16x32_bf16 v[0:3], v[236:239], v[108:111], v[0:3]
ds_read_b64_tr_b16 v[234:235], v58 offset:2048
v_mfma_f32_16x16x32_bf16 v[4:7], v[236:239], v[112:115], v[4:7]
v_cvt_pk_bf16_f32 v26, v12, v13
v_cvt_pk_bf16_f32 v27, v14, v15
v_mfma_f32_16x16x32_bf16 v[8:11], v[236:239], v[116:119], v[8:11]
ds_read_b64_tr_b16 v[236:237], v58 offset:4096
s_waitcnt lgkmcnt(5)
v_mfma_f32_16x16x32_bf16 v[0:3], v[240:243], v[120:123], v[0:3]
ds_read_b64_tr_b16 v[238:239], v58 offset:6144
v_mfma_f32_16x16x32_bf16 v[4:7], v[240:243], v[124:127], v[4:7]
v_cvt_pk_bf16_f32 v30, v16, v17
v_cvt_pk_bf16_f32 v31, v18, v19
v_mfma_f32_16x16x32_bf16 v[8:11], v[240:243], v[128:131], v[8:11]
ds_read_b64_tr_b16 v[240:241], v58 offset:8192
s_waitcnt lgkmcnt(5)
v_mfma_f32_16x16x32_bf16 v[0:3], v[244:247], v[132:135], v[0:3]
ds_read_b64_tr_b16 v[242:243], v58 offset:10240
v_mfma_f32_16x16x32_bf16 v[4:7], v[244:247], v[136:139], v[4:7]
v_cvt_pk_bf16_f32 v34, v20, v21
v_cvt_pk_bf16_f32 v35, v22, v23
v_mfma_f32_16x16x32_bf16 v[8:11], v[244:247], v[140:143], v[8:11]
ds_read_b64_tr_b16 v[244:245], v58 offset:12288
s_waitcnt lgkmcnt(5)
v_mfma_f32_16x16x32_bf16 v[0:3], v[232:235], v[144:147], v[0:3]
ds_read_b64_tr_b16 v[246:247], v58 offset:14336
v_mfma_f32_16x16x32_bf16 v[4:7], v[232:235], v[148:151], v[4:7]
buffer_store_dwordx4 v[24:27], v255, s[40:43], s62 offen offset:0 sc0 sc1
v_mfma_f32_16x16x32_bf16 v[8:11], v[232:235], v[152:155], v[8:11]
ds_read_b64_tr_b16 v[232:233], v57 offset:0
s_waitcnt lgkmcnt(5)
v_mfma_f32_16x16x32_bf16 v[0:3], v[236:239], v[156:159], v[0:3]
ds_read_b64_tr_b16 v[234:235], v57 offset:2048
v_mfma_f32_16x16x32_bf16 v[4:7], v[236:239], v[160:163], v[4:7]
buffer_store_dwordx4 v[28:31], v255, s[40:43], s62 offen offset:2048 sc0 sc1
s_add_u32 s62, s62, 4096
v_mfma_f32_16x16x32_bf16 v[8:11], v[236:239], v[164:167], v[8:11]
ds_read_b64_tr_b16 v[236:237], v57 offset:4096
s_waitcnt lgkmcnt(5)
v_mfma_f32_16x16x32_bf16 v[0:3], v[240:243], v[168:171], v[0:3]
ds_read_b64_tr_b16 v[238:239], v57 offset:6144
v_mfma_f32_16x16x32_bf16 v[4:7], v[240:243], v[172:175], v[4:7]
buffer_store_dwordx4 v[32:35], v255, s[40:43], s62 offen offset:0 sc0 sc1
v_mfma_f32_16x16x32_bf16 v[8:11], v[240:243], v[176:179], v[8:11]
ds_read_b64_tr_b16 v[240:241], v57 offset:8192
s_waitcnt lgkmcnt(5)
v_mfma_f32_16x16x32_bf16 v[0:3], v[244:247], v[180:183], v[0:3]
ds_read_b64_tr_b16 v[242:243], v57 offset:10240
v_mfma_f32_16x16x32_bf16 v[4:7], v[244:247], v[184:187], v[4:7]
s_add_u32 s62, s62, 8192
v_mfma_f32_16x16x32_bf16 v[8:11], v[244:247], v[188:191], v[8:11]
ds_read_b64_tr_b16 v[244:245], v57 offset:12288
s_waitcnt lgkmcnt(5)
v_mfma_f32_16x16x32_bf16 v[12:15], v[232:235], v[96:99], 0
ds_read_b64_tr_b16 v[246:247], v57 offset:14336
v_mfma_f32_16x16x32_bf16 v[16:19], v[232:235], v[100:103], 0
v_mfma_f32_16x16x32_bf16 v[20:23], v[232:235], v[104:107], 0
ds_read_b64_tr_b16 v[232:233], v59 offset:0
s_waitcnt lgkmcnt(5)
v_mfma_f32_16x16x32_bf16 v[12:15], v[236:239], v[108:111], v[12:15]
ds_read_b64_tr_b16 v[234:235], v59 offset:2048
v_mfma_f32_16x16x32_bf16 v[16:19], v[236:239], v[112:115], v[16:19]
v_cvt_pk_bf16_f32 v24, v0, v1
v_cvt_pk_bf16_f32 v25, v2, v3
v_mfma_f32_16x16x32_bf16 v[20:23], v[236:239], v[116:119], v[20:23]
ds_read_b64_tr_b16 v[236:237], v59 offset:4096
s_waitcnt lgkmcnt(5)
v_mfma_f32_16x16x32_bf16 v[12:15], v[240:243], v[120:123], v[12:15]
ds_read_b64_tr_b16 v[238:239], v59 offset:6144
v_mfma_f32_16x16x32_bf16 v[16:19], v[240:243], v[124:127], v[16:19]
v_cvt_pk_bf16_f32 v28, v4, v5
v_cvt_pk_bf16_f32 v29, v6, v7
v_mfma_f32_16x16x32_bf16 v[20:23], v[240:243], v[128:131], v[20:23]
ds_read_b64_tr_b16 v[240:241], v59 offset:8192
s_waitcnt lgkmcnt(5)
v_mfma_f32_16x16x32_bf16 v[12:15], v[244:247], v[132:135], v[12:15]
ds_read_b64_tr_b16 v[242:243], v59 offset:10240
v_mfma_f32_16x16x32_bf16 v[16:19], v[244:247], v[136:139], v[16:19]
v_cvt_pk_bf16_f32 v32, v8, v9
v_cvt_pk_bf16_f32 v33, v10, v11
v_mfma_f32_16x16x32_bf16 v[20:23], v[244:247], v[140:143], v[20:23]
ds_read_b64_tr_b16 v[244:245], v59 offset:12288
s_waitcnt lgkmcnt(5)
v_mfma_f32_16x16x32_bf16 v[12:15], v[232:235], v[144:147], v[12:15]
ds_read_b64_tr_b16 v[246:247], v59 offset:14336
v_mfma_f32_16x16x32_bf16 v[16:19], v[232:235], v[148:151], v[16:19]
v_mfma_f32_16x16x32_bf16 v[20:23], v[232:235], v[152:155], v[20:23]
s_waitcnt lgkmcnt(4)
v_mfma_f32_16x16x32_bf16 v[12:15], v[236:239], v[156:159], v[12:15]
v_mfma_f32_16x16x32_bf16 v[16:19], v[236:239], v[160:163], v[16:19]
v_mfma_f32_16x16x32_bf16 v[20:23], v[236:239], v[164:167], v[20:23]
s_waitcnt lgkmcnt(2)
v_mfma_f32_16x16x32_bf16 v[12:15], v[240:243], v[168:171], v[12:15]
v_mfma_f32_16x16x32_bf16 v[16:19], v[240:243], v[172:175], v[16:19]
v_mfma_f32_16x16x32_bf16 v[20:23], v[240:243], v[176:179], v[20:23]
s_waitcnt lgkmcnt(0)
v_mfma_f32_16x16x32_bf16 v[12:15], v[244:247], v[180:183], v[12:15]
v_mfma_f32_16x16x32_bf16 v[16:19], v[244:247], v[184:187], v[16:19]
v_mfma_f32_16x16x32_bf16 v[20:23], v[244:247], v[188:191], v[20:23]
s_nop 7
s_nop 1
v_cvt_pk_bf16_f32 v26, v12, v13
v_cvt_pk_bf16_f32 v27, v14, v15
v_cvt_pk_bf16_f32 v30, v16, v17
v_cvt_pk_bf16_f32 v31, v18, v19
v_cvt_pk_bf16_f32 v34, v20, v21
v_cvt_pk_bf16_f32 v35, v22, v23
buffer_store_dwordx4 v[24:27], v255, s[40:43], s62 offen offset:0 sc0 sc1
buffer_store_dwordx4 v[28:31], v255, s[40:43], s62 offen offset:2048 sc0 sc1
s_add_u32 s62, s62, 4096
buffer_store_dwordx4 v[32:35], v255, s[40:43], s62 offen offset:0 sc0 sc1
s_add_u32 s62, s62, 8192
L_red:
s_nop 0
s_cmp_lt_u32 s49, 12
s_mov_b32 s61, 0xff984510
s_cmov_b32 s61, 0xfa984510
s_nop 0
s_cmp_lt_u32 s49, 8
s_cmov_b32 s61, 0x6f984510
s_nop 0
s_cmp_lt_u32 s49, 4
s_cmov_b32 s61, 0x5f984210
s_lshl_b32 s58, s50, 2
s_lshr_b32 s61, s61, s58
s_bfe_u32 s60, s61, 0x20002
s_nop 0
s_and_b32 s61, s61, 3
s_and_b32 s58, s49, 3
s_cmp_lt_u32 s61, 2
s_cmov_b32 s58, s49
s_lshl4_add_u32 s58, s61, s58
s_mul_i32 s61, s58, 43
s_lshr_b32 s61, s61, 8
s_add_u32 s61, s61, s60
s_mul_i32 s61, s61, 6
s_add_u32 s61, s61, 30
s_cmp_eq_u32 s60, 0
s_cmov_b32 s61, 0
s_add_u32 s58, s58, s61
s_mul_i32 s59, s48, 1769472
s_nop 0
s_lshl_b32 s52, s58, 10
s_add_u32 s59, s59, s52
s_lshl_b32 s61, s48, 14
s_lshl_b32 s52, s60, 8
s_add_u32 s61, s61, s52
s_add_u32 s61, s61, 67108864
s_lshl_b32 s54, s49, 10
s_add_u32 s54, s54, s61
s_lshr_b32 s52, s50, 2
s_lshl_b32 s52, s52, 3
s_add_u32 s52, s52, 65536
v_mov_b32 v88, s52
s_lshl_b32 s52, s60, 2
s_add_u32 s52, s52, 65536
v_mov_b32 v89, s52
v_lshlrev_b32 v82, 4, v252
v_lshlrev_b32 v83, 10, v252
v_mov_b32 v80, 1
v_mov_b32 v81, 0
s_mul_i32 s52, s58, 43
s_lshr_b32 s52, s52, 9
s_mul_i32 s62, s52, 12
s_sub_u32 s58, s58, s62
v_and_b32 v85, 7, v252
v_mul_u32_u24 v86, 1152, v85
v_lshrrev_b32_e64 v85, 3, v252
v_lshl_add_u32 v87, v85, 4, v86
v_lshrrev_b32_e64 v84, 2, v85
v_lshl_add_u32 v86, v84, 6, v86
v_and_b32_e64 v84, 1, v85
v_lshl_add_u32 v86, v84, 5, v86
v_bfe_u32 v84, v85, 1, 1
v_lshl_add_u32 v86, v84, 4, v86
s_nop 0
s_lshl_b32 s62, s52, 7
s_mul_i32 s58, s58, 9216
s_add_u32 s62, s62, s58
s_add_u32 s62, s62, s65
s_mov_b32 s58, 0xffff0000
s_mov_b32 s51, 0
s_cmp_eq_u32 s60, 3
s_mov_b64 exec, 1
s_waitcnt vmcnt(0)
ds_add_u32 v88, v80
s_cbranch_scc1 L_dn2
s_lshl_b32 s52, 1, s50
s_and_b32 s52, s52, 0x19
s_cbranch_scc0 L_go
L_cnt:
ds_read_b32 v84, v89
s_add_u32 s51, s51, 1
s_waitcnt lgkmcnt(0)
v_cmp_ne_u32 vcc, 4, v84
s_cbranch_vccz L_cnt_ok
s_nop 15
s_nop 15
s_nop 15
s_nop 15
s_cmp_lt_u32 s51, 0x100000
s_cbranch_scc1 L_cnt
L_cnt_ok:
s_nop 0
buffer_store_dword v80, v81, s[40:43], s54 offen sc0 sc1
s_mov_b64 exec, 0xffff
L_poll1:
buffer_load_dword v84, v83, s[40:43], s61 offen sc0 sc1
s_waitcnt vmcnt(0)
v_cmp_ne_u32 vcc, 1, v84
s_add_u32 s51, s51, 1
s_cbranch_vccz L_poll1_ok
s_cmp_lt_u32 s51, 0x200000
s_cbranch_scc1 L_poll1
L_poll1_ok:
s_nop 0
ds_write_b32 v89, v80 offset:16
s_branch L_go_ok
L_dn2:
s_waitcnt lgkmcnt(0)
s_endpgm
L_go:
s_nop 0
ds_read_b32 v84, v89 offset:16
s_add_u32 s51, s51, 1
s_waitcnt lgkmcnt(0)
v_cmp_ne_u32 vcc, 1, v84
s_cbranch_vccz L_go_ok
s_nop 15
s_nop 15
s_nop 15
s_nop 15
s_cmp_lt_u32 s51, 0x1000000
s_cbranch_scc1 L_go
L_go_ok:
s_nop 0
v_mov_b32 v88, 65536
s_mov_b64 exec, 1
L_gate:
s_nop 0
ds_read_b32 v84, v88 offset:12
s_add_u32 s51, s51, 1
s_waitcnt lgkmcnt(0)
v_cmp_ne_u32 vcc, 4, v84
s_cbranch_vccz L_gate_ok
s_nop 15
s_nop 15
s_nop 15
s_nop 15
s_cmp_lt_u32 s51, 0x2000000
s_cbranch_scc1 L_gate
L_gate_ok:
s_mov_b64 exec, -1
buffer_load_dwordx4 v[16:19], v82, s[40:43], s59 offen sc0 sc1
s_add_u32 s59, s59, 110592
buffer_load_dwordx4 v[20:23], v82, s[40:43], s59 offen sc0 sc1
s_add_u32 s59, s59, 110592
buffer_load_dwordx4 v[24:27], v82, s[40:43], s59 offen sc0 sc1
s_add_u32 s59, s59, 110592
buffer_load_dwordx4 v[28:31], v82, s[40:43], s59 offen sc0 sc1
s_add_u32 s59, s59, 110592
buffer_load_dwordx4 v[32:35], v82, s[40:43], s59 offen sc0 sc1
s_add_u32 s59, s59, 110592
buffer_load_dwordx4 v[36:39], v82, s[40:43], s59 offen sc0 sc1
s_add_u32 s59, s59, 110592
buffer_load_dwordx4 v[40:43], v82, s[40:43], s59 offen sc0 sc1
s_add_u32 s59, s59, 110592
buffer_load_dwordx4 v[44:47], v82, s[40:43], s59 offen sc0 sc1
s_add_u32 s59, s59, 110592
buffer_load_dwordx4 v[48:51], v82, s[40:43], s59 offen sc0 sc1
s_add_u32 s59, s59, 110592
buffer_load_dwordx4 v[52:55], v82, s[40:43], s59 offen sc0 sc1
s_add_u32 s59, s59, 110592
buffer_load_dwordx4 v[56:59], v82, s[40:43], s59 offen sc0 sc1
s_add_u32 s59, s59, 110592
buffer_load_dwordx4 v[60:63], v82, s[40:43], s59 offen sc0 sc1
s_add_u32 s59, s59, 110592
buffer_load_dwordx4 v[64:67], v82, s[40:43], s59 offen sc0 sc1
s_add_u32 s59, s59, 110592
buffer_load_dwordx4 v[68:71], v82, s[40:43], s59 offen sc0 sc1
s_add_u32 s59, s59, 110592
buffer_load_dwordx4 v[72:75], v82, s[40:43], s59 offen sc0 sc1
s_add_u32 s59, s59, 110592
buffer_load_dwordx4 v[76:79], v82, s[40:43], s59 offen sc0 sc1
s_cmp_lg_u32 s60, 0
s_waitcnt vmcnt(15)
v_lshlrev_b32 v8, 16, v16
v_and_b32 v9, s58, v16
v_lshlrev_b32 v10, 16, v17
v_and_b32 v11, s58, v17
v_lshlrev_b32 v12, 16, v18
v_and_b32 v13, s58, v18
v_lshlrev_b32 v14, 16, v19
v_and_b32 v15, s58, v19
s_waitcnt vmcnt(14)
v_lshlrev_b32 v2, 16, v20
v_and_b32_e64 v3, s58, v20
v_pk_add_f32 v[8:9], v[8:9], v[2:3]
v_lshlrev_b32 v4, 16, v21
v_and_b32 v5, s58, v21
v_pk_add_f32 v[10:11], v[10:11], v[4:5]
v_lshlrev_b32 v2, 16, v22
v_and_b32 v3, s58, v22
v_pk_add_f32 v[12:13], v[12:13], v[2:3]
v_lshlrev_b32 v4, 16, v23
v_and_b32 v5, s58, v23
v_pk_add_f32 v[14:15], v[14:15], v[4:5]
s_waitcnt vmcnt(13)
v_lshlrev_b32 v2, 16, v24
v_and_b32_e64 v3, s58, v24
v_pk_add_f32 v[8:9], v[8:9], v[2:3]
v_lshlrev_b32 v4, 16, v25
v_and_b32 v5, s58, v25
v_pk_add_f32 v[10:11], v[10:11], v[4:5]
v_lshlrev_b32 v2, 16, v26
v_and_b32 v3, s58, v26
v_pk_add_f32 v[12:13], v[12:13], v[2:3]
v_lshlrev_b32 v4, 16, v27
v_and_b32 v5, s58, v27
v_pk_add_f32 v[14:15], v[14:15], v[4:5]
s_waitcnt vmcnt(12)
v_lshlrev_b32 v2, 16, v28
v_and_b32_e64 v3, s58, v28
v_pk_add_f32 v[8:9], v[8:9], v[2:3]
v_lshlrev_b32 v4, 16, v29
v_and_b32 v5, s58, v29
v_pk_add_f32 v[10:11], v[10:11], v[4:5]
v_lshlrev_b32 v2, 16, v30
v_and_b32 v3, s58, v30
v_pk_add_f32 v[12:13], v[12:13], v[2:3]
v_lshlrev_b32 v4, 16, v31
v_and_b32 v5, s58, v31
v_pk_add_f32 v[14:15], v[14:15], v[4:5]
s_waitcnt vmcnt(11)
v_lshlrev_b32 v2, 16, v32
v_and_b32_e64 v3, s58, v32
v_pk_add_f32 v[8:9], v[8:9], v[2:3]
v_lshlrev_b32 v4, 16, v33
v_and_b32 v5, s58, v33
v_pk_add_f32 v[10:11], v[10:11], v[4:5]
v_lshlrev_b32 v2, 16, v34
v_and_b32 v3, s58, v34
v_pk_add_f32 v[12:13], v[12:13], v[2:3]
v_lshlrev_b32 v4, 16, v35
v_and_b32 v5, s58, v35
v_pk_add_f32 v[14:15], v[14:15], v[4:5]
s_waitcnt vmcnt(10)
v_lshlrev_b32 v2, 16, v36
v_and_b32_e64 v3, s58, v36
v_pk_add_f32 v[8:9], v[8:9], v[2:3]
v_lshlrev_b32 v4, 16, v37
v_and_b32 v5, s58, v37
v_pk_add_f32 v[10:11], v[10:11], v[4:5]
v_lshlrev_b32 v2, 16, v38
v_and_b32 v3, s58, v38
v_pk_add_f32 v[12:13], v[12:13], v[2:3]
v_lshlrev_b32 v4, 16, v39
v_and_b32 v5, s58, v39
v_pk_add_f32 v[14:15], v[14:15], v[4:5]
s_waitcnt vmcnt(9)
v_lshlrev_b32 v2, 16, v40
v_and_b32_e64 v3, s58, v40
v_pk_add_f32 v[8:9], v[8:9], v[2:3]
v_lshlrev_b32 v4, 16, v41
v_and_b32 v5, s58, v41
v_pk_add_f32 v[10:11], v[10:11], v[4:5]
v_lshlrev_b32 v2, 16, v42
v_and_b32 v3, s58, v42
v_pk_add_f32 v[12:13], v[12:13], v[2:3]
v_lshlrev_b32 v4, 16, v43
v_and_b32 v5, s58, v43
v_pk_add_f32 v[14:15], v[14:15], v[4:5]
s_waitcnt vmcnt(8)
v_lshlrev_b32 v2, 16, v44
v_and_b32_e64 v3, s58, v44
v_pk_add_f32 v[8:9], v[8:9], v[2:3]
v_lshlrev_b32 v4, 16, v45
v_and_b32 v5, s58, v45
v_pk_add_f32 v[10:11], v[10:11], v[4:5]
v_lshlrev_b32 v2, 16, v46
v_and_b32 v3, s58, v46
v_pk_add_f32 v[12:13], v[12:13], v[2:3]
v_lshlrev_b32 v4, 16, v47
v_and_b32 v5, s58, v47
v_pk_add_f32 v[14:15], v[14:15], v[4:5]
s_waitcnt vmcnt(7)
v_lshlrev_b32 v2, 16, v48
v_and_b32_e64 v3, s58, v48
v_pk_add_f32 v[8:9], v[8:9], v[2:3]
v_lshlrev_b32 v4, 16, v49
v_and_b32 v5, s58, v49
v_pk_add_f32 v[10:11], v[10:11], v[4:5]
v_lshlrev_b32 v2, 16, v50
v_and_b32 v3, s58, v50
v_pk_add_f32 v[12:13], v[12:13], v[2:3]
v_lshlrev_b32 v4, 16, v51
v_and_b32 v5, s58, v51
v_pk_add_f32 v[14:15], v[14:15], v[4:5]
s_waitcnt vmcnt(6)
v_lshlrev_b32 v2, 16, v52
v_and_b32_e64 v3, s58, v52
v_pk_add_f32 v[8:9], v[8:9], v[2:3]
v_lshlrev_b32 v4, 16, v53
v_and_b32 v5, s58, v53
v_pk_add_f32 v[10:11], v[10:11], v[4:5]
v_lshlrev_b32 v2, 16, v54
v_and_b32 v3, s58, v54
v_pk_add_f32 v[12:13], v[12:13], v[2:3]
v_lshlrev_b32 v4, 16, v55
v_and_b32 v5, s58, v55
v_pk_add_f32 v[14:15], v[14:15], v[4:5]
s_waitcnt vmcnt(5)
v_lshlrev_b32 v2, 16, v56
v_and_b32_e64 v3, s58, v56
v_pk_add_f32 v[8:9], v[8:9], v[2:3]
v_lshlrev_b32 v4, 16, v57
v_and_b32 v5, s58, v57
v_pk_add_f32 v[10:11], v[10:11], v[4:5]
v_lshlrev_b32 v2, 16, v58
v_and_b32 v3, s58, v58
v_pk_add_f32 v[12:13], v[12:13], v[2:3]
v_lshlrev_b32 v4, 16, v59
v_and_b32 v5, s58, v59
v_pk_add_f32 v[14:15], v[14:15], v[4:5]
s_waitcnt vmcnt(4)
v_lshlrev_b32 v2, 16, v60
v_and_b32_e64 v3, s58, v60
v_pk_add_f32 v[8:9], v[8:9], v[2:3]
v_lshlrev_b32 v4, 16, v61
v_and_b32 v5, s58, v61
v_pk_add_f32 v[10:11], v[10:11], v[4:5]
v_lshlrev_b32 v2, 16, v62
v_and_b32 v3, s58, v62
v_pk_add_f32 v[12:13], v[12:13], v[2:3]
v_lshlrev_b32 v4, 16, v63
v_and_b32 v5, s58, v63
v_pk_add_f32 v[14:15], v[14:15], v[4:5]
s_waitcnt vmcnt(3)
v_lshlrev_b32 v2, 16, v64
v_and_b32_e64 v3, s58, v64
v_pk_add_f32 v[8:9], v[8:9], v[2:3]
v_lshlrev_b32 v4, 16, v65
v_and_b32 v5, s58, v65
v_pk_add_f32 v[10:11], v[10:11], v[4:5]
v_lshlrev_b32 v2, 16, v66
v_and_b32 v3, s58, v66
v_pk_add_f32 v[12:13], v[12:13], v[2:3]
v_lshlrev_b32 v4, 16, v67
v_and_b32 v5, s58, v67
v_pk_add_f32 v[14:15], v[14:15], v[4:5]
s_waitcnt vmcnt(2)
v_lshlrev_b32 v2, 16, v68
v_and_b32_e64 v3, s58, v68
v_pk_add_f32 v[8:9], v[8:9], v[2:3]
v_lshlrev_b32 v4, 16, v69
v_and_b32 v5, s58, v69
v_pk_add_f32 v[10:11], v[10:11], v[4:5]
v_lshlrev_b32 v2, 16, v70
v_and_b32 v3, s58, v70
v_pk_add_f32 v[12:13], v[12:13], v[2:3]
v_lshlrev_b32 v4, 16, v71
v_and_b32 v5, s58, v71
v_pk_add_f32 v[14:15], v[14:15], v[4:5]
s_waitcnt vmcnt(1)
v_lshlrev_b32 v2, 16, v72
v_and_b32_e64 v3, s58, v72
v_pk_add_f32 v[8:9], v[8:9], v[2:3]
v_lshlrev_b32 v4, 16, v73
v_and_b32 v5, s58, v73
v_pk_add_f32 v[10:11], v[10:11], v[4:5]
v_lshlrev_b32 v2, 16, v74
v_and_b32 v3, s58, v74
v_pk_add_f32 v[12:13], v[12:13], v[2:3]
v_lshlrev_b32 v4, 16, v75
v_and_b32 v5, s58, v75
v_pk_add_f32 v[14:15], v[14:15], v[4:5]
s_waitcnt vmcnt(0)
v_lshlrev_b32 v2, 16, v76
v_and_b32_e64 v3, s58, v76
v_pk_add_f32 v[8:9], v[8:9], v[2:3]
v_lshlrev_b32 v4, 16, v77
v_and_b32 v5, s58, v77
v_pk_add_f32 v[10:11], v[10:11], v[4:5]
v_lshlrev_b32 v2, 16, v78
v_and_b32 v3, s58, v78
v_pk_add_f32 v[12:13], v[12:13], v[2:3]
v_lshlrev_b32 v4, 16, v79
v_and_b32 v5, s58, v79
v_pk_add_f32 v[14:15], v[14:15], v[4:5]
v_cvt_pk_bf16_f32 v16, v8, v9
v_cvt_pk_bf16_f32 v17, v10, v11
v_cvt_pk_bf16_f32 v18, v12, v13
v_cvt_pk_bf16_f32 v19, v14, v15
s_cbranch_scc1 L_nat
s_nop 0
v_cvt_pk_bf16_f32 v20, v8, v9
v_cvt_pk_bf16_f32 v21, v10, v11
v_mov_b32_e64 v87, v86
v_mov_b32_dpp v16, v18 row_ror:8 row_mask:0xf bank_mask:0xc
v_mov_b32_dpp v17, v19 row_ror:8 row_mask:0xf bank_mask:0xc
v_mov_b32_dpp v18, v20 row_ror:8 row_mask:0xf bank_mask:0x3
v_mov_b32_dpp v19, v21 row_ror:8 row_mask:0xf bank_mask:0x3
L_nat:
buffer_store_dwordx4 v[16:19], v87, s[44:47], s62 offen
s_endpgm
L_slow:
s_waitcnt vmcnt(0)
v_readfirstlane_b32 s89, v144
v_and_b32 v253, 15, v252
v_lshrrev_b32 v254, 4, v252
v_lshlrev_b32 v208, 8, v253
v_lshl_add_u32 v208, v254, 4, v208
v_bfe_u32 v253, v252, 2, 2
v_lshlrev_b32 v209, 8, v253
v_lshl_add_u32 v209, v254, 6, v209
v_and_b32 v253, 3, v252
v_lshl_add_u32 v209, v253, 4, v209
v_xor_b32 v210, 32, v209
v_lshrrev_b32 v253, 4, v252
v_bfe_u32 v254, v252, 2, 2
v_and_b32 v250, 3, v252
v_lshlrev_b32 v248, 3, v250
v_lshl_add_u32 v248, v254, 6, v248
v_lshl_add_u32 v248, v253, 10, v248
v_and_b32 v253, 1, v253
v_lshl_add_u32 v248, v253, 5, v248
v_xor_b32 v249, 32, v248
s_mul_i32 s53, s50, 12288
s_add_u32 s53, s53, 114688
v_add_u32 v248, s53, v248
v_add_u32 v249, s53, v249
v_mov_b32 v204, 0xff800000
v_mov_b32 v205, 0xff800000
v_mov_b32 v206, 0xff800000
v_mov_b32 v0, 0
v_mov_b32 v1, 0
v_mov_b32 v2, 0
v_mov_b32 v3, 0
v_mov_b32 v4, 0
v_mov_b32 v5, 0
v_mov_b32 v6, 0
v_mov_b32 v7, 0
v_mov_b32 v8, 0
v_mov_b32 v9, 0
v_mov_b32 v10, 0
v_mov_b32 v11, 0
v_mov_b32 v12, 0
v_mov_b32 v13, 0
v_mov_b32 v14, 0
v_mov_b32 v15, 0
v_mov_b32 v16, 0
v_mov_b32 v17, 0
v_mov_b32 v18, 0
v_mov_b32 v19, 0
v_mov_b32 v20, 0
v_mov_b32 v21, 0
v_mov_b32 v22, 0
v_mov_b32 v23, 0
v_mov_b32 v24, 0
v_mov_b32 v25, 0
v_mov_b32 v26, 0
v_mov_b32 v27, 0
v_mov_b32 v28, 0
v_mov_b32 v29, 0
v_mov_b32 v30, 0
v_mov_b32 v31, 0
v_mov_b32 v32, 0
v_mov_b32 v33, 0
v_mov_b32 v34, 0
v_mov_b32 v35, 0
v_mov_b32 v36, 0
v_mov_b32 v37, 0
v_mov_b32 v38, 0
v_mov_b32 v39, 0
v_mov_b32 v40, 0
v_mov_b32 v41, 0
v_mov_b32 v42, 0
v_mov_b32 v43, 0
v_mov_b32 v44, 0
v_mov_b32 v45, 0
v_mov_b32 v46, 0
v_mov_b32 v47, 0
v_mov_b32 v48, 0
v_mov_b32 v49, 0
v_mov_b32 v50, 0
v_mov_b32 v51, 0
v_mov_b32 v52, 0
v_mov_b32 v53, 0
v_mov_b32 v54, 0
v_mov_b32 v55, 0
v_mov_b32 v56, 0
v_mov_b32 v57, 0
v_mov_b32 v58, 0
v_mov_b32 v59, 0
v_mov_b32 v60, 0
v_mov_b32 v61, 0
v_mov_b32 v62, 0
v_mov_b32 v63, 0
v_mov_b32 v64, 0
v_mov_b32 v65, 0
v_mov_b32 v66, 0
v_mov_b32 v67, 0
v_mov_b32 v68, 0
v_mov_b32 v69, 0
v_mov_b32 v70, 0
v_mov_b32 v71, 0
v_mov_b32 v72, 0
v_mov_b32 v73, 0
v_mov_b32 v74, 0
v_mov_b32 v75, 0
v_mov_b32 v76, 0
v_mov_b32 v77, 0
v_mov_b32 v78, 0
v_mov_b32 v79, 0
v_mov_b32 v80, 0
v_mov_b32 v81, 0
v_mov_b32 v82, 0
v_mov_b32 v83, 0
v_mov_b32 v84, 0
v_mov_b32 v85, 0
v_mov_b32 v86, 0
v_mov_b32 v87, 0
v_mov_b32 v88, 0
v_mov_b32 v89, 0
v_mov_b32 v90, 0
v_mov_b32 v91, 0
v_mov_b32 v92, 0
v_mov_b32 v93, 0
v_mov_b32 v94, 0
v_mov_b32 v95, 0
v_mov_b32 v216, 0
v_mov_b32 v217, 0
v_mov_b32 v218, 0
v_mov_b32 v219, 0
v_mov_b32 v220, 0
v_mov_b32 v221, 0
v_mov_b32 v222, 0
v_mov_b32 v223, 0
v_mov_b32 v224, 0
v_mov_b32 v225, 0
v_mov_b32 v226, 0
v_mov_b32 v227, 0
s_mov_b32 s61, s64
s_mov_b32 s51, 32
L_slow1:
s_add_u32 s58, s61, 0
buffer_load_dwordx4 v[232:235], v208, s[24:27], s58 offen offset:0
buffer_load_dwordx4 v[236:239], v208, s[24:27], s58 offen offset:64
buffer_load_dwordx4 v[240:243], v208, s[24:27], s58 offen offset:128
buffer_load_dwordx4 v[244:247], v208, s[24:27], s58 offen offset:192
s_waitcnt vmcnt(0)
v_mfma_f32_16x16x32_bf16 v[144:147], v[232:235], v[96:99], 0
v_mfma_f32_16x16x32_bf16 v[148:151], v[232:235], v[112:115], 0
v_mfma_f32_16x16x32_bf16 v[152:155], v[232:235], v[128:131], 0
v_mfma_f32_16x16x32_bf16 v[144:147], v[236:239], v[100:103], v[144:147]
v_mfma_f32_16x16x32_bf16 v[148:151], v[236:239], v[116:119], v[148:151]
v_mfma_f32_16x16x32_bf16 v[152:155], v[236:239], v[132:135], v[152:155]
v_mfma_f32_16x16x32_bf16 v[144:147], v[240:243], v[104:107], v[144:147]
v_mfma_f32_16x16x32_bf16 v[148:151], v[240:243], v[120:123], v[148:151]
v_mfma_f32_16x16x32_bf16 v[152:155], v[240:243], v[136:139], v[152:155]
v_mfma_f32_16x16x32_bf16 v[144:147], v[244:247], v[108:111], v[144:147]
v_mfma_f32_16x16x32_bf16 v[148:151], v[244:247], v[124:127], v[148:151]
v_mfma_f32_16x16x32_bf16 v[152:155], v[244:247], v[140:143], v[152:155]
s_nop 7
s_nop 3
v_max3_f32 v204, v204, v144, v145
v_max3_f32 v204, v204, v146, v147
v_max3_f32 v205, v205, v148, v149
v_max3_f32 v205, v205, v150, v151
v_max3_f32 v206, v206, v152, v153
v_max3_f32 v206, v206, v154, v155
s_add_u32 s61, s61, 4096
s_sub_u32 s51, s51, 1
s_cmp_lg_u32 s51, 0
s_cbranch_scc1 L_slow1
v_xor_b32 v211, 16, v252
v_lshlrev_b32 v211, 2, v211
ds_bpermute_b32 v144, v211, v204
ds_bpermute_b32 v145, v211, v205
ds_bpermute_b32 v146, v211, v206
s_waitcnt lgkmcnt(0)
v_max_f32 v204, v204, v144
v_max_f32 v205, v205, v145
v_max_f32 v206, v206, v146
v_xor_b32 v211, 32, v252
v_lshlrev_b32 v211, 2, v211
ds_bpermute_b32 v144, v211, v204
ds_bpermute_b32 v145, v211, v205
ds_bpermute_b32 v146, v211, v206
s_waitcnt lgkmcnt(0)
v_max_f32 v204, v204, v144
v_max_f32 v205, v205, v145
v_max_f32 v206, v206, v146
s_mov_b32 s61, s64
s_mov_b32 s51, 16
L_slow2:
s_add_u32 m0, s53, 0
s_add_u32 s58, s61, 0
buffer_load_dwordx4 v209, s[28:31], s58 offen lds
s_add_u32 m0, s53, 1024
s_add_u32 s58, s61, 1024
buffer_load_dwordx4 v210, s[28:31], s58 offen lds
s_add_u32 m0, s53, 2048
s_add_u32 s58, s61, 2048
buffer_load_dwordx4 v209, s[28:31], s58 offen lds
s_add_u32 m0, s53, 3072
s_add_u32 s58, s61, 3072
buffer_load_dwordx4 v210, s[28:31], s58 offen lds
s_add_u32 m0, s53, 4096
s_add_u32 s58, s61, 4096
buffer_load_dwordx4 v209, s[28:31], s58 offen lds
s_add_u32 m0, s53, 5120
s_add_u32 s58, s61, 5120
buffer_load_dwordx4 v210, s[28:31], s58 offen lds
s_add_u32 m0, s53, 6144
s_add_u32 s58, s61, 6144
buffer_load_dwordx4 v209, s[28:31], s58 offen lds
s_add_u32 m0, s53, 7168
s_add_u32 s58, s61, 7168
buffer_load_dwordx4 v210, s[28:31], s58 offen lds
s_add_u32 s58, s61, 0
buffer_load_dwordx4 v[232:235], v208, s[24:27], s58 offen offset:0
buffer_load_dwordx4 v[236:239], v208, s[24:27], s58 offen offset:64
buffer_load_dwordx4 v[240:243], v208, s[24:27], s58 offen offset:128
buffer_load_dwordx4 v[244:247], v208, s[24:27], s58 offen offset:192
s_waitcnt vmcnt(0)
v_mfma_f32_16x16x32_bf16 v[144:147], v[232:235], v[96:99], 0
v_mfma_f32_16x16x32_bf16 v[148:151], v[232:235], v[112:115], 0
v_mfma_f32_16x16x32_bf16 v[152:155], v[232:235], v[128:131], 0
v_mfma_f32_16x16x32_bf16 v[144:147], v[236:239], v[100:103], v[144:147]
v_mfma_f32_16x16x32_bf16 v[148:151], v[236:239], v[116:119], v[148:151]
v_mfma_f32_16x16x32_bf16 v[152:155], v[236:239], v[132:135], v[152:155]
v_mfma_f32_16x16x32_bf16 v[144:147], v[240:243], v[104:107], v[144:147]
v_mfma_f32_16x16x32_bf16 v[148:151], v[240:243], v[120:123], v[148:151]
v_mfma_f32_16x16x32_bf16 v[152:155], v[240:243], v[136:139], v[152:155]
v_mfma_f32_16x16x32_bf16 v[144:147], v[244:247], v[108:111], v[144:147]
v_mfma_f32_16x16x32_bf16 v[148:151], v[244:247], v[124:127], v[148:151]
v_mfma_f32_16x16x32_bf16 v[152:155], v[244:247], v[140:143], v[152:155]
s_nop 7
s_nop 3
s_add_u32 s58, s61, 4096
buffer_load_dwordx4 v[232:235], v208, s[24:27], s58 offen offset:0
buffer_load_dwordx4 v[236:239], v208, s[24:27], s58 offen offset:64
buffer_load_dwordx4 v[240:243], v208, s[24:27], s58 offen offset:128
buffer_load_dwordx4 v[244:247], v208, s[24:27], s58 offen offset:192
s_waitcnt vmcnt(0)
v_mfma_f32_16x16x32_bf16 v[156:159], v[232:235], v[96:99], 0
v_mfma_f32_16x16x32_bf16 v[160:163], v[232:235], v[112:115], 0
v_mfma_f32_16x16x32_bf16 v[164:167], v[232:235], v[128:131], 0
v_mfma_f32_16x16x32_bf16 v[156:159], v[236:239], v[100:103], v[156:159]
v_mfma_f32_16x16x32_bf16 v[160:163], v[236:239], v[116:119], v[160:163]
v_mfma_f32_16x16x32_bf16 v[164:167], v[236:239], v[132:135], v[164:167]
v_mfma_f32_16x16x32_bf16 v[156:159], v[240:243], v[104:107], v[156:159]
v_mfma_f32_16x16x32_bf16 v[160:163], v[240:243], v[120:123], v[160:163]
v_mfma_f32_16x16x32_bf16 v[164:167], v[240:243], v[136:139], v[164:167]
v_mfma_f32_16x16x32_bf16 v[156:159], v[244:247], v[108:111], v[156:159]
v_mfma_f32_16x16x32_bf16 v[160:163], v[244:247], v[124:127], v[160:163]
v_mfma_f32_16x16x32_bf16 v[164:167], v[244:247], v[140:143], v[164:167]
s_nop 7
s_nop 3
v_sub_f32 v144, v144, v204
v_sub_f32 v145, v145, v204
v_sub_f32 v146, v146, v204
v_sub_f32 v147, v147, v204
v_exp_f32 v144, v144
v_exp_f32 v145, v145
v_exp_f32 v146, v146
v_exp_f32 v147, v147
s_nop 0
v_cvt_pk_bf16_f32 v192, v144, v145
v_cvt_pk_bf16_f32 v193, v146, v147
v_sub_f32 v148, v148, v205
v_sub_f32 v149, v149, v205
v_sub_f32 v150, v150, v205
v_sub_f32 v151, v151, v205
v_exp_f32 v148, v148
v_exp_f32 v149, v149
v_exp_f32 v150, v150
v_exp_f32 v151, v151
s_nop 0
v_cvt_pk_bf16_f32 v196, v148, v149
v_cvt_pk_bf16_f32 v197, v150, v151
v_sub_f32 v152, v152, v206
v_sub_f32 v153, v153, v206
v_sub_f32 v154, v154, v206
v_sub_f32 v155, v155, v206
v_exp_f32 v152, v152
v_exp_f32 v153, v153
v_exp_f32 v154, v154
v_exp_f32 v155, v155
s_nop 0
v_cvt_pk_bf16_f32 v200, v152, v153
v_cvt_pk_bf16_f32 v201, v154, v155
v_sub_f32 v156, v156, v204
v_sub_f32 v157, v157, v204
v_sub_f32 v158, v158, v204
v_sub_f32 v159, v159, v204
v_exp_f32 v156, v156
v_exp_f32 v157, v157
v_exp_f32 v158, v158
v_exp_f32 v159, v159
s_nop 0
v_cvt_pk_bf16_f32 v194, v156, v157
v_cvt_pk_bf16_f32 v195, v158, v159
v_sub_f32 v160, v160, v205
v_sub_f32 v161, v161, v205
v_sub_f32 v162, v162, v205
v_sub_f32 v163, v163, v205
v_exp_f32 v160, v160
v_exp_f32 v161, v161
v_exp_f32 v162, v162
v_exp_f32 v163, v163
s_nop 0
v_cvt_pk_bf16_f32 v198, v160, v161
v_cvt_pk_bf16_f32 v199, v162, v163
v_sub_f32 v164, v164, v206
v_sub_f32 v165, v165, v206
v_sub_f32 v166, v166, v206
v_sub_f32 v167, v167, v206
v_exp_f32 v164, v164
v_exp_f32 v165, v165
v_exp_f32 v166, v166
v_exp_f32 v167, v167
s_nop 0
v_cvt_pk_bf16_f32 v202, v164, v165
v_cvt_pk_bf16_f32 v203, v166, v167
ds_read_b64_tr_b16 v[232:233], v248 offset:0
ds_read_b64_tr_b16 v[234:235], v248 offset:4096
ds_read_b64_tr_b16 v[236:237], v249 offset:0
ds_read_b64_tr_b16 v[238:239], v249 offset:4096
ds_read_b64_tr_b16 v[240:241], v248 offset:256
ds_read_b64_tr_b16 v[242:243], v248 offset:4352
ds_read_b64_tr_b16 v[244:245], v249 offset:256
ds_read_b64_tr_b16 v[246:247], v249 offset:4352
s_waitcnt lgkmcnt(0)
v_mfma_f32_16x16x32_bf16 v[0:3], v[232:235], v[192:195], v[0:3]
v_mfma_f32_16x16x32_bf16 v[4:7], v[232:235], v[196:199], v[4:7]
v_mfma_f32_16x16x32_bf16 v[8:11], v[232:235], v[200:203], v[8:11]
v_mfma_f32_16x16x32_bf16 v[12:15], v[236:239], v[192:195], v[12:15]
v_mfma_f32_16x16x32_bf16 v[16:19], v[236:239], v[196:199], v[16:19]
v_mfma_f32_16x16x32_bf16 v[20:23], v[236:239], v[200:203], v[20:23]
v_mfma_f32_16x16x32_bf16 v[24:27], v[240:243], v[192:195], v[24:27]
v_mfma_f32_16x16x32_bf16 v[28:31], v[240:243], v[196:199], v[28:31]
v_mfma_f32_16x16x32_bf16 v[32:35], v[240:243], v[200:203], v[32:35]
v_mfma_f32_16x16x32_bf16 v[36:39], v[244:247], v[192:195], v[36:39]
v_mfma_f32_16x16x32_bf16 v[40:43], v[244:247], v[196:199], v[40:43]
v_mfma_f32_16x16x32_bf16 v[44:47], v[244:247], v[200:203], v[44:47]
s_nop 7
ds_read_b64_tr_b16 v[232:233], v248 offset:512
ds_read_b64_tr_b16 v[234:235], v248 offset:4608
ds_read_b64_tr_b16 v[236:237], v249 offset:512
ds_read_b64_tr_b16 v[238:239], v249 offset:4608
ds_read_b64_tr_b16 v[240:241], v248 offset:768
ds_read_b64_tr_b16 v[242:243], v248 offset:4864
ds_read_b64_tr_b16 v[244:245], v249 offset:768
ds_read_b64_tr_b16 v[246:247], v249 offset:4864
s_waitcnt lgkmcnt(0)
v_mfma_f32_16x16x32_bf16 v[48:51], v[232:235], v[192:195], v[48:51]
v_mfma_f32_16x16x32_bf16 v[52:55], v[232:235], v[196:199], v[52:55]
v_mfma_f32_16x16x32_bf16 v[56:59], v[232:235], v[200:203], v[56:59]
v_mfma_f32_16x16x32_bf16 v[60:63], v[236:239], v[192:195], v[60:63]
v_mfma_f32_16x16x32_bf16 v[64:67], v[236:239], v[196:199], v[64:67]
v_mfma_f32_16x16x32_bf16 v[68:71], v[236:239], v[200:203], v[68:71]
v_mfma_f32_16x16x32_bf16 v[72:75], v[240:243], v[192:195], v[72:75]
v_mfma_f32_16x16x32_bf16 v[76:79], v[240:243], v[196:199], v[76:79]
v_mfma_f32_16x16x32_bf16 v[80:83], v[240:243], v[200:203], v[80:83]
v_mfma_f32_16x16x32_bf16 v[84:87], v[244:247], v[192:195], v[84:87]
v_mfma_f32_16x16x32_bf16 v[88:91], v[244:247], v[196:199], v[88:91]
v_mfma_f32_16x16x32_bf16 v[92:95], v[244:247], v[200:203], v[92:95]
s_nop 7
v_mfma_f32_16x16x32_bf16 v[216:219], v[228:231], v[192:195], v[216:219]
v_mfma_f32_16x16x32_bf16 v[220:223], v[228:231], v[196:199], v[220:223]
v_mfma_f32_16x16x32_bf16 v[224:227], v[228:231], v[200:203], v[224:227]
s_nop 7
s_add_u32 s61, s61, 8192
s_sub_u32 s51, s51, 1
s_cmp_lg_u32 s51, 0
s_cbranch_scc1 L_slow2
s_nop 7
v_mov_b32 v144, s89
s_branch L_norm
L_done:
s_endpgm
.section .rodata,"a"
.p2align 6
.amdhsa_kernel standalone__gqa_block_cached__near_ridge_kernel
  .amdhsa_next_free_vgpr 256
  .amdhsa_next_free_sgpr 102
  .amdhsa_accum_offset 256
  .amdhsa_group_segment_fixed_size 0
  .amdhsa_kernarg_size 64
  .amdhsa_user_sgpr_count 2
  .amdhsa_user_sgpr_kernarg_segment_ptr 1
  .amdhsa_system_sgpr_workgroup_id_x 1
.end_amdhsa_kernel
```
